```python
import torch

def _softmax(x, axis=-1):
    return torch.softmax(x, dim=axis)
def _gelu(x):
    return torch.nn.functional.gelu(x, approximate="tanh")
def _silu(x):
    return torch.nn.functional.silu(x)
def _sigmoid(x):
    return torch.sigmoid(x)
def _layernorm(x, axis=-1, eps=1e-5):
    m = x.mean(dim=axis, keepdim=True)
    v = x.var(dim=axis, keepdim=True, unbiased=False)
    return (x - m) / torch.sqrt(v + eps)
def _scatter_add(tgt, idx, src, axis=0):
    return tgt.clone().index_add_(axis, idx, src)
def _segment_sum(src, seg, n):
    out = torch.zeros((n,) + src.shape[1:], dtype=src.dtype)
    return out.index_add_(0, seg, src)
def _pad(x, pw):
    flat = tuple(v for pair in reversed(pw) for v in pair)
    return torch.nn.functional.pad(x, flat)

kernel_name = 'gated_mix__sliding_block__dense_activation_relu__prompt'

def setup_inputs():

    _w = (lambda a: (lambda t: t.to(torch.bfloat16) if t.is_floating_point() else t)(torch.as_tensor(a)))
    def _A_setup():
        B, S, D = 1, 2048, 640
        return {
            "x": _w((lambda *s: torch.randn(*s, dtype=torch.bfloat16) * 0.05)(B, S, D)),
            "wqkv": _w((lambda *s: torch.randn(*s, dtype=torch.bfloat16) * 0.8)(D, 3 * D)),
            "wo": _w((lambda *s: torch.randn(*s, dtype=torch.bfloat16) * 0.05)(D, D)),
        }
    _A_in = _A_setup()

    def _B_setup():
        B, S, D, Dff = 1, 2048, 640, 1728
        return {
            "x": _w((lambda *s: torch.randn(*s, dtype=torch.bfloat16) * 0.05)(B, S, D)),
            "w1": _w((lambda *s: torch.randn(*s, dtype=torch.bfloat16) * 0.1)(D, Dff)),
            "w2": _w((lambda *s: torch.randn(*s, dtype=torch.bfloat16) * 0.1)(Dff, D)),
        }
    _B_in = _B_setup()

    return {
        "A_x": _A_in["x"],
        "A_wqkv": _A_in["wqkv"],
        "A_wo": _A_in["wo"],
        "B_x": _B_in["x"],
        "B_w1": _B_in["w1"],
        "B_w2": _B_in["w2"],
        "gate_w": _w((lambda *s: torch.randn(*s, dtype=torch.bfloat16) * 0.05)(640) * 16.0),
    }

def reference(A_x, A_wqkv, A_wo, B_x, B_w1, B_w2, gate_w):
    def _A_ref(x, wqkv, wo):
        B, S, D = x.shape
        H = 32; Dh = D // H; W = 256
        qkv = (lambda x, *d: x.permute(*d))((x @ wqkv).reshape(B, S, 3, H, Dh), 2, 0, 3, 1, 4)
        q, k, v = qkv[0], qkv[1], qkv[2]
        scores = torch.einsum("bhqd,bhkd->bhqk", q, k) * (Dh ** -0.5)
        idx = torch.arange(S)
        mask = (idx[:, None] - idx[None, :] >= 0) & (idx[:, None] - idx[None, :] < W)
        scores = torch.where(mask[None, None], scores, -1e9)
        p = _softmax(scores, axis=-1)
        o = torch.einsum("bhqk,bhkd->bhqd", p, v)
        return (lambda x, *d: x.permute(*d))(o, 0, 2, 1, 3).reshape(B, S, D) @ wo

    def _B_ref(x, w1, w2):
        h = torch.einsum("bsd,df->bsf", x, w1)
        zero = torch.zeros_like(h)
        h = torch.maximum(h, zero)
        return torch.einsum("bsf,fd->bsd", h, w2)

    x = A_x
    g = _sigmoid((x * gate_w).sum(-1, keepdims=True))
    a = _A_ref(x, A_wqkv, A_wo)
    b = _B_ref(x, B_w1, B_w2)
    return g * a + (1 - g) * b
```

```asm
; @launch grid=(256,1,1) block=(256,1,1) lds=163840
.amdgcn_target "amdgcn-amd-amdhsa--gfx950"
.text
.p2align 12
.globl gated_mix__sliding_block__dense_activation_relu__prompt_kernel
.p2align 8
.type gated_mix__sliding_block__dense_activation_relu__prompt_kernel,@function
gated_mix__sliding_block__dense_activation_relu__prompt_kernel:
    s_cmp_ge_u32 s2, 256
    s_cbranch_scc1 L_done_1
    s_load_dwordx2 s[8:9], s[0:1], 0
    s_load_dwordx2 s[12:13], s[0:1], 8
    s_load_dwordx2 s[40:41], s[0:1], 48
    s_load_dwordx2 s[20:21], s[0:1], 72
    s_load_dwordx2 s[28:29], s[0:1], 16
    s_load_dwordx4 s[56:59], s[0:1], 32
    s_load_dwordx4 s[60:63], s[0:1], 56
    v_and_b32 v1, 63, v0
    v_lshrrev_b32 v2, 6, v0
    s_and_b32 s3, s2, 7
    v_readfirstlane_b32 s5, v2
    s_lshr_b32 s4, s2, 3
    s_mov_b32 s10, 2621440
    s_mov_b32 s11, 0x20000
    s_mov_b32 s14, 2457600
    s_mov_b32 s15, 0x20000
    s_mov_b32 s18, 2211840
    s_mov_b32 s19, 0x20000
    s_mov_b32 s22, 37748736
    s_mov_b32 s23, 0x20000
    s_mov_b32 s26, 2211840
    s_mov_b32 s27, 0x20000
    s_mov_b32 s30, 819200
    s_mov_b32 s31, 0x20000
    s_mov_b32 s34, 2621440
    s_mov_b32 s35, 0x20000
    s_mov_b32 s38, 256
    s_mov_b32 s39, 0x20000
    s_mov_b32 s42, 1280
    s_mov_b32 s43, 0x20000
    s_lshl_b32 s44, s5, 12
    s_and_b32 s76, s3, 3
    s_cmp_ge_u32 s4, 30
    s_cselect_b32 s77, 2, 30
    s_cselect_b32 s78, 90, 0
    s_mul_i32 s77, s77, s76
    s_add_u32 s77, s77, s78
    s_add_u32 s77, s77, s4
    s_lshr_b32 s7, s77, 3
    s_and_b32 s77, s77, 7
    s_lshr_b32 s78, s3, 2
    s_lshl_b32 s78, s78, 3
    s_add_u32 s6, s77, s78
    s_and_b32 s77, s7, 3
    s_lshl_b32 s75, s6, 2
    s_add_u32 s75, s75, s5
    s_cmp_eq_u32 s7, 15
    s_cbranch_scc1 L_helper_2
    s_getpc_b64 s[78:79]
L_pc_6:
    s_lshl_b32 s80, s4, 2
    s_add_u32 s80, s80, s5
    v_min_u32 v3, 3, v1
    v_mul_u32_u24 v3, 120, v3
    v_add_u32 v3, s80, v3
    v_lshlrev_b32 v3, 7, v3
    v_min_u32 v3, L_code_end-L_pc_6-4, v3
    global_load_dword v56, v3, s[78:79]
    s_mov_b32 s82, 0x36120
    s_mov_b32 s83, 0x98754
    s_cmp_eq_u32 s77, 1
    s_cmov_b32 s82, 0x27031
    s_cmov_b32 s83, 0x98654
    s_cmp_eq_u32 s77, 2
    s_cmov_b32 s82, 0x28410
    s_cmov_b32 s83, 0x97653
    s_cmp_eq_u32 s77, 3
    s_cmov_b32 s82, 0x92501
    s_cmov_b32 s83, 0x87643
    s_mul_i32 s76, s76, 3
    s_mul_i32 s77, s6, 1
    s_add_u32 s76, s76, s77
    s_mul_i32 s77, s76, 6554
    s_lshr_b32 s77, s77, 16
    s_mul_i32 s77, s77, 10
    s_sub_u32 s51, s76, s77
    s_bfe_u32 s76, s82, 0x40000
    s_add_u32 s76, s76, s51
    s_sub_u32 s77, s76, 10
    s_cselect_b32 s76, s76, s77
    s_mul_i32 s45, s76, 245760
    s_lshl_b32 s46, s76, 7
    s_bfe_u32 s76, s82, 0x40004
    s_add_u32 s76, s76, s51
    s_sub_u32 s77, s76, 10
    s_cselect_b32 s76, s76, s77
    s_mul_i32 s47, s76, 245760
    s_lshl_b32 s87, s76, 7
    s_bfe_u32 s76, s82, 0x40008
    s_add_u32 s76, s76, s51
    s_sub_u32 s77, s76, 10
    s_cselect_b32 s76, s76, s77
    s_mul_i32 s48, s76, 245760
    s_lshl_b32 s93, s76, 7
    v_lshrrev_b32 v2, 3, v1
    v_and_b32 v3, 7, v1
    v_bfe_u32 v4, v1, 4, 1
    v_lshlrev_b32 v4, 2, v4
    v_xor_b32 v4, v4, v3
    s_lshl_b32 s76, s5, 4
    v_add_u32 v5, s76, v2
    v_mul_u32_u24 v6, 3840, v5
    v_lshl_add_u32 v6, v4, 4, v6
    s_lshl_b32 s76, s7, 8
    v_add_u32 v20, s76, v6
    v_xor_b32 v21, 16, v20
    v_add_u32 v21, 29696, v21
    v_mul_u32_u24 v6, 1280, v2
    v_lshrrev_b32 v7, 4, v1
    v_xor_b32 v7, v7, v3
    v_lshl_add_u32 v6, v7, 4, v6
    s_mul_i32 s76, s75, 40960
    v_add_u32 v24, s76, v6
    v_xor_b32 v26, 64, v24
    v_add_u32 v25, 9216, v24
    v_add_u32 v27, 27648, v26
    v_add_u32 v26, 18432, v26
    v_lshlrev_b32 v7, 4, v1
    s_mul_i32 s76, s5, 320
    s_waitcnt lgkmcnt(0)
    s_add_u32 m0, s44, 0
    s_nop 0
    buffer_load_dwordx4 v20, s[12:15], s45 offen offset:0 lds
    buffer_load_dwordx4 v21, s[12:15], s45 offen offset:1024 lds
    s_add_u32 m0, s44, 65536
    s_nop 0
    buffer_load_dwordx4 v24, s[8:11], s46 offen offset:0 lds
    buffer_load_dwordx4 v25, s[8:11], s46 offen offset:1024 lds
    buffer_load_dwordx4 v26, s[8:11], s46 offen offset:2048 lds
    buffer_load_dwordx4 v27, s[8:11], s46 offen offset:3072 lds
    s_add_u32 m0, s76, 147456
    s_cmp_lg_u32 s7, 10
    s_cmov_b32 s76, 0x80000000
    buffer_load_dwordx4 v7, s[40:43], s76 offen lds
    s_add_u32 m0, s44, 2048
    s_nop 0
    buffer_load_dwordx4 v20, s[12:15], s47 offen offset:0 lds
    buffer_load_dwordx4 v21, s[12:15], s47 offen offset:1024 lds
    s_add_u32 m0, s44, 81920
    s_nop 0
    buffer_load_dwordx4 v24, s[8:11], s87 offen offset:0 lds
    buffer_load_dwordx4 v25, s[8:11], s87 offen offset:1024 lds
    buffer_load_dwordx4 v26, s[8:11], s87 offen offset:2048 lds
    buffer_load_dwordx4 v27, s[8:11], s87 offen offset:3072 lds
    s_mov_b64 s[16:17], s[56:57]
    s_mov_b64 s[24:25], s[58:59]
    s_mov_b64 s[32:33], s[60:61]
    s_mov_b64 s[36:37], s[62:63]
    s_cmp_ge_u32 s7, 12
    s_cselect_b32 s77, 7, 8
    s_cselect_b32 s79, 1536, 0
    s_mov_b32 s52, 0x80
    s_cmov_b32 s52, 0x80000000
    s_lshl_b32 s81, s7, s77
    s_add_u32 s81, s81, s79
    v_mul_u32_u24 v6, 3456, v5
    v_lshl_add_u32 v6, v4, 4, v6
    v_add_u32 v22, s81, v6
    v_xor_b32 v23, 16, v22
    v_add_u32 v23, 26624, v23
    v_lshrrev_b32 v2, 5, v1
    v_lshlrev_b32 v2, 12, v2
    v_bfe_u32 v3, v1, 4, 1
    v_lshl_add_u32 v2, v3, 10, v2
    v_bfe_u32 v4, v1, 2, 2
    v_lshl_add_u32 v2, v4, 7, v2
    v_bfe_u32 v4, v1, 3, 1
    v_lshl_add_u32 v2, v4, 6, v2
    v_and_b32 v4, 1, v1
    v_lshl_add_u32 v2, v4, 3, v2
    v_and_b32 v5, 3, v1
    v_xor_b32 v5, v5, v3
    v_lshl_add_u32 v5, v5, 4, v2
    v_and_b32 v6, 2, v1
    v_xor_b32 v6, v6, v3
    v_lshl_add_u32 v6, v6, 4, v2
    s_cmp_ge_u32 s7, 10
    s_cselect_b64 vcc, -1, 0
    s_cselect_b32 s76, 16, 8
    v_cndmask_b32 v8, v5, v6, vcc
    v_xor_b32 v9, s76, v8
    v_xor_b32 v10, 64, v8
    v_xor_b32 v11, 64, v9
    v_add_u32 v12, 0x10000, v5
    v_xor_b32 v13, 8, v12
    v_xor_b32 v14, 64, v12
    v_xor_b32 v15, 72, v12
    v_add_u32 v16, 0x10000, v12
    v_add_u32 v17, 0x10000, v13
    v_add_u32 v18, 0x10000, v14
    v_add_u32 v19, 0x10000, v15
    v_lshrrev_b32 v2, 4, v1
    v_bfe_u32 v3, v1, 1, 3
    v_xor_b32 v3, v3, v2
    v_lshlrev_b32 v3, 4, v3
    v_and_b32 v4, 7, v1
    v_lshl_add_u32 v3, v4, 7, v3
    v_bfe_u32 v4, v1, 3, 1
    v_lshl_add_u32 v3, v4, 11, v3
    s_add_u32 s76, s44, 65536
    v_add_u32 v28, s76, v3
    v_xor_b32 v29, 64, v28
    v_lshlrev_b32 v3, 4, v2
    v_add_u32 v34, 147456, v3
    v_add_u32 v33, s46, v34
    s_bfe_u32 s76, s82, 0x4000c
    s_add_u32 s76, s76, s51
    s_sub_u32 s77, s76, 10
    s_cselect_b32 s76, s76, s77
    s_mul_i32 s65, s76, 245760
    s_lshl_b32 s100, s76, 7
    s_bfe_u32 s76, s82, 0x40010
    s_add_u32 s76, s76, s51
    s_sub_u32 s77, s76, 10
    s_cselect_b32 s76, s76, s77
    s_mul_i32 s84, s76, 245760
    s_lshl_b32 s101, s76, 7
    s_bfe_u32 s76, s83, 0x40000
    s_add_u32 s76, s76, s51
    s_sub_u32 s77, s76, 10
    s_cselect_b32 s76, s76, s77
    s_mul_i32 s85, s76, 245760
    s_lshl_b32 s41, s76, 7
    s_bfe_u32 s76, s83, 0x40004
    s_add_u32 s76, s76, s51
    s_sub_u32 s77, s76, 10
    s_cselect_b32 s76, s76, s77
    s_mul_i32 s86, s76, 245760
    s_lshl_b32 s42, s76, 7
    s_bfe_u32 s76, s83, 0x40008
    s_add_u32 s76, s76, s51
    s_sub_u32 s77, s76, 10
    s_cselect_b32 s76, s76, s77
    s_mul_i32 s0, s76, 245760
    s_lshl_b32 s43, s76, 7
    s_bfe_u32 s76, s83, 0x4000c
    s_add_u32 s76, s76, s51
    s_sub_u32 s77, s76, 10
    s_cselect_b32 s76, s76, s77
    s_mul_i32 s1, s76, 245760
    s_lshl_b32 s54, s76, 7
    s_bfe_u32 s76, s83, 0x40010
    s_add_u32 s76, s76, s51
    s_sub_u32 s77, s76, 10
    s_cselect_b32 s76, s76, s77
    s_mul_i32 s40, s76, 245760
    s_lshl_b32 s55, s76, 7
    v_lshrrev_b32 v2, 4, v1
    v_bfe_u32 v3, v1, 3, 1
    v_and_b32 v4, 7, v1
    v_lshlrev_b32 v5, 4, v4
    v_lshl_add_u32 v6, v2, 7, v5
    s_mov_b32 s92, 1
    s_cmp_eq_u32 s5, 0
    s_cbranch_scc1 L_pad0
    s_cmp_eq_u32 s5, 1
    s_cbranch_scc1 L_pad1
    s_cmp_eq_u32 s5, 2
    s_cbranch_scc1 L_pad2
    s_branch L_pad3
L_helper_2:
    s_mov_b32 s92, 0
    s_add_u32 s76, s6, 1
    s_lshl_b32 s76, s76, 21
    s_lshr_b32 s77, s6, 3
    s_lshr_b32 s78, s6, 1
    s_xor_b32 s77, s77, s6
    s_xor_b32 s77, s77, s78
    s_and_b32 s77, s77, 1
    s_lshl_b32 s77, s77, 13
    s_add_u32 s76, s76, s77
    s_add_u32 s76, s76, 1835008
    s_xor_b32 s77, s76, 8192
    v_mov_b32 v4, 0x80000000
    v_cmp_eq_u32 vcc, 0, v0
    s_nop 1
    v_cndmask_b32 v5, v4, 0, vcc
    s_waitcnt lgkmcnt(0)
    buffer_store_dword v1, v5, s[20:23], s76 offen sc1
    buffer_store_dword v1, v5, s[20:23], s77 offen sc1
    s_barrier
    s_mov_b64 s[16:17], s[56:57]
    s_mov_b64 s[24:25], s[58:59]
    s_mov_b64 s[32:33], s[60:61]
    s_mov_b64 s[36:37], s[62:63]
    s_lshr_b32 s77, s75, 4
    s_and_b32 s78, s75, 15
    s_lshl_b32 s78, s78, 10
    s_mul_i32 s76, s77, 552960
    s_add_u32 s76, s76, s78
    v_lshl_add_u32 v2, v1, 4, s76
    s_mov_b32 s76, 0
    buffer_load_dwordx4 v[84:87], v2, s[16:19], s76 offen
    s_add_u32 s76, s76, 16384
    buffer_load_dwordx4 v[84:87], v2, s[16:19], s76 offen
    s_add_u32 s76, s76, 16384
    buffer_load_dwordx4 v[84:87], v2, s[16:19], s76 offen
    s_add_u32 s76, s76, 16384
    buffer_load_dwordx4 v[84:87], v2, s[16:19], s76 offen
    s_add_u32 s76, s76, 16384
    s_waitcnt vmcnt(5)
    v_min_u32 v6, 47, v1
    v_subrev_u32 v3, 45, v6
    v_cmp_gt_u32 vcc, 2, v3
    s_nop 1
    v_cndmask_b32 v3, 0, 1, vcc
    v_lshlrev_b32 v6, 7, v6
    s_lshr_b32 s80, s6, 3
    s_and_b32 s79, s6, 7
    s_lshl_b32 s79, s79, 1
    s_sub_u32 s79, s79, s80
    s_lshl_b32 s79, s79, 13
    s_add_u32 s79, s79, 1581056
    s_cmp_lg_u32 s5, 0
    s_cmov_b32 s79, 0x80000000
    s_add_u32 s80, s79, 2097152
    s_bitcmp1_b32 s6, 1
    s_cselect_b32 s81, 5, 3
    s_getreg_b32 s82, hwreg(HW_REG_IB_STS, 0, 4)
    s_cmp_le_u32 s82, 4
    s_cmov_b32 s81, 1
    buffer_store_dword v3, v6, s[20:23], s79 offen sc1
    buffer_store_dword v3, v6, s[20:23], s80 offen sc1
    buffer_load_dwordx4 v[84:87], v2, s[16:19], s76 offen
    s_add_u32 s76, s76, 16384
    buffer_load_dwordx4 v[84:87], v2, s[16:19], s76 offen
    s_add_u32 s76, s76, 16384
    buffer_load_dwordx4 v[84:87], v2, s[16:19], s76 offen
    s_add_u32 s76, s76, 16384
    buffer_load_dwordx4 v[84:87], v2, s[16:19], s76 offen
    s_add_u32 s76, s76, 16384
    buffer_load_dwordx4 v[84:87], v2, s[16:19], s76 offen
    s_add_u32 s76, s76, 16384
    buffer_load_dwordx4 v[84:87], v2, s[16:19], s76 offen
    s_add_u32 s76, s76, 16384
    buffer_load_dwordx4 v[84:87], v2, s[16:19], s76 offen
    s_add_u32 s76, s76, 16384
    v_mov_b32 v4, s81
    s_lshl_b32 s79, s6, 2
    s_waitcnt vmcnt(7)
    buffer_store_dword v4, v5, s[36:39], s79 offen sc1
L_warm_33:
    buffer_load_dwordx4 v[84:87], v2, s[16:19], s76 offen
    s_add_u32 s76, s76, 16384
    s_waitcnt vmcnt(9)
    s_barrier
    s_cmp_lt_u32 s76, 552960
    s_cbranch_scc1 L_warm_33
    s_mul_i32 s76, s77, 552960
    s_add_u32 s76, s76, s78
    v_lshl_add_u32 v2, v1, 4, s76
    s_mov_b32 s76, 0
    v_and_b32 v63, 60, v1
    buffer_load_dword v56, v63, s[36:39], 0 offen sc1
L_warm_34:
    buffer_load_dwordx4 v[84:87], v2, s[24:27], s76 offen
    s_add_u32 s76, s76, 16384
    s_waitcnt vmcnt(9)
    s_barrier
    s_cmp_lt_u32 s76, 552960
    s_cbranch_scc1 L_warm_34
    s_mul_i32 s76, s77, 204800
    s_add_u32 s76, s76, s78
    v_lshl_add_u32 v2, v1, 4, s76
    s_mov_b32 s76, 0
    s_branch L_helper_rest
.p2align 12
L_main:
    s_mov_b32 s92, 0
    s_add_u32 m0, s44, 16384
    s_nop 0
    buffer_load_dwordx4 v20, s[12:15], s48 offen offset:0 lds
    buffer_load_dwordx4 v21, s[12:15], s48 offen offset:1024 lds
    s_add_u32 m0, s44, 98304
    s_waitcnt vmcnt(8)
    s_barrier
    ds_read_b128 a[0:3], v28 offset:0
    ds_read_b128 a[8:11], v29 offset:0
    ds_read_b128 v[136:139], v33 offset:0
    ds_read_b128 a[4:7], v28 offset:1024
    ds_read_b128 a[12:15], v29 offset:1024
    ds_read_b128 v[140:143], v33 offset:64
    v_add_u32 v33, s87, v34
    ds_read_b64_tr_b16 v[64:65], v8 offset:0
    ds_read_b64_tr_b16 v[66:67], v8 offset:512
    ds_read_b64_tr_b16 v[68:69], v8 offset:8192
    ds_read_b64_tr_b16 v[70:71], v8 offset:8704
    ds_read_b64_tr_b16 v[72:73], v9 offset:0
    ds_read_b64_tr_b16 v[74:75], v9 offset:512
    ds_read_b64_tr_b16 v[76:77], v9 offset:8192
    ds_read_b64_tr_b16 v[78:79], v9 offset:8704
    ds_read_b64_tr_b16 v[80:81], v10 offset:0
    s_waitcnt lgkmcnt(8)
    ds_read_b64_tr_b16 v[82:83], v10 offset:512
    ds_read_b64_tr_b16 v[84:85], v10 offset:8192
    ds_read_b64_tr_b16 v[86:87], v10 offset:8704
    s_cmp_ge_u32 s7, 10
    s_cbranch_scc1 L_vrole_9
    s_waitcnt lgkmcnt(10)
    v_mfma_f32_16x16x32_bf16 v[96:99], v[64:67], a[0:3], 0
    s_waitcnt lgkmcnt(6)
    ds_read_b64_tr_b16 v[88:89], v11 offset:0
    ds_read_b64_tr_b16 v[90:91], v11 offset:512
    v_mfma_f32_16x16x32_bf16 v[96:99], v[68:71], a[8:11], v[96:99]
    buffer_load_dwordx4 v24, s[8:11], s93 offen offset:0 lds
    v_lshl_add_u32 v31, v3, 10, v6
    v_lshlrev_b32 v6, 1, v3
    s_lshr_b32 s76, s6, 3
    s_xor_b32 s76, s76, 1
    s_lshl_b32 s76, s76, 13
    s_and_b32 s49, s6, 7
    v_mfma_f32_16x16x32_bf16 v[104:107], v[68:71], a[12:15], 0
    s_waitcnt lgkmcnt(6)
    ds_read_b64_tr_b16 v[92:93], v11 offset:8192
    ds_read_b64_tr_b16 v[94:95], v11 offset:8704
    v_mfma_f32_16x16x32_bf16 v[104:107], v[64:67], a[4:7], v[104:107]
    s_waitcnt vmcnt(3)
    s_barrier
    buffer_load_dwordx4 v25, s[8:11], s93 offen offset:1024 lds
    s_lshl_b32 s49, s49, 22
    s_add_u32 s49, s49, s76
    s_add_u32 s49, s49, 4195840
    s_lshr_b32 s76, s5, 1
    s_mul_i32 s76, s76, 11264
    v_mfma_f32_16x16x32_bf16 v[108:111], v[72:75], a[4:7], 0
    s_waitcnt lgkmcnt(6)
    ds_read_b64_tr_b16 v[64:65], v8 offset:2048
    ds_read_b64_tr_b16 v[66:67], v8 offset:2560
    v_mfma_f32_16x16x32_bf16 v[108:111], v[76:79], a[12:15], v[108:111]
    s_nop 0
    ds_read_b128 a[16:19], v28 offset:16384
    ds_read_b128 a[24:27], v29 offset:16384
    buffer_load_dwordx4 v26, s[8:11], s93 offen offset:2048 lds
    s_add_u32 s66, s49, s76
    s_mul_i32 s76, s5, 2560
    s_add_u32 s49, s66, s76
    s_lshr_b32 s76, s6, 3
    s_lshl_b32 s76, s76, 13
    s_and_b32 s68, s6, 7
    v_mfma_f32_16x16x32_bf16 v[100:103], v[76:79], a[8:11], 0
    s_waitcnt lgkmcnt(8)
    ds_read_b64_tr_b16 v[68:69], v8 offset:10240
    ds_read_b64_tr_b16 v[70:71], v8 offset:10752
    v_mfma_f32_16x16x32_bf16 v[100:103], v[72:75], a[0:3], v[100:103]
    buffer_load_dwordx4 v27, s[8:11], s93 offen offset:3072 lds
    s_lshl_b32 s68, s68, 22
    s_add_u32 s68, s68, s76
    s_add_u32 s68, s68, 2097152
    s_lshl_b32 s76, s5, 11
    s_add_u32 s68, s68, s76
    v_mfma_f32_16x16x32_bf16 v[112:115], v[80:83], a[0:3], 0
    s_add_u32 m0, s44, 18432
    ds_read_b64_tr_b16 v[72:73], v9 offset:2048
    ds_read_b64_tr_b16 v[74:75], v9 offset:2560
    v_mfma_f32_16x16x32_bf16 v[112:115], v[84:87], a[8:11], v[112:115]
    s_nop 0
    ds_read_b128 a[20:23], v28 offset:17408
    ds_read_b128 a[28:31], v29 offset:17408
    buffer_load_dwordx4 v20, s[12:15], s65 offen offset:0 lds
    s_cmp_ge_u32 s7, 10
    s_cselect_b64 vcc, -1, 0
    s_cselect_b32 s53, 1, 0
    s_cselect_b32 s79, 0, 640
    s_add_u32 s50, s49, s79
    v_cndmask_b32 v238, v2, v6, vcc
    v_cndmask_b32 v6, v6, v2, vcc
    s_lshl_b32 s76, s7, 4
    v_mfma_f32_16x16x32_bf16 v[120:123], v[84:87], a[12:15], 0
    s_waitcnt lgkmcnt(10)
    ds_read_b64_tr_b16 v[76:77], v9 offset:10240
    ds_read_b64_tr_b16 v[78:79], v9 offset:10752
    v_mfma_f32_16x16x32_bf16 v[120:123], v[80:83], a[4:7], v[120:123]
    buffer_load_dwordx4 v21, s[12:15], s65 offen offset:1024 lds
    v_add_u32 v238, s76, v238
    v_mul_u32_u24 v6, 640, v6
    v_add_u32 v239, v6, v5
    s_mov_b32 s64, 32128
    s_lshl_b32 s76, s81, 8
    s_add_u32 s94, s68, s76
    v_mfma_f32_16x16x32_bf16 v[124:127], v[88:91], a[4:7], 0
    s_add_u32 m0, s44, 114688
    ds_read_b64_tr_b16 v[80:81], v10 offset:2048
    ds_read_b64_tr_b16 v[82:83], v10 offset:2560
    v_mfma_f32_16x16x32_bf16 v[124:127], v[92:95], a[12:15], v[124:127]
    buffer_load_dwordx4 v24, s[8:11], s100 offen offset:0 lds
    s_add_u32 s95, s94, 16384
    s_and_b32 s76, s52, 0x80000000
    s_add_u32 s76, s76, 32768
    s_add_u32 s96, s94, s76
    s_add_u32 s97, s95, s76
    v_mfma_f32_16x16x32_bf16 v[116:119], v[92:95], a[8:11], 0
    s_waitcnt lgkmcnt(4)
    ds_read_b64_tr_b16 v[84:85], v10 offset:10240
    ds_read_b64_tr_b16 v[86:87], v10 offset:10752
    v_mfma_f32_16x16x32_bf16 v[116:119], v[88:91], a[0:3], v[116:119]
    buffer_load_dwordx4 v25, s[8:11], s100 offen offset:1024 lds
    s_lshl_b32 s76, s75, 7
    s_add_u32 s76, s76, 1703936
    s_cmp_lg_u32 s7, 10
    s_cmov_b32 s76, 0x80000000
    v_lshl_add_u32 v4, v3, 4, v4
    v_lshl_add_u32 v4, v2, 3, v4
    v_mfma_f32_16x16x32_bf16 v[96:99], v[64:67], a[16:19], v[96:99]
    ds_read_b64_tr_b16 v[88:89], v11 offset:2048
    ds_read_b64_tr_b16 v[90:91], v11 offset:2560
    v_mfma_f32_16x16x32_bf16 v[96:99], v[68:71], a[24:27], v[96:99]
    buffer_load_dwordx4 v26, s[8:11], s100 offen offset:2048 lds
    v_lshl_add_u32 v4, v4, 2, s76
    v_lshrrev_b32 v5, 5, v1
    v_lshlrev_b32 v5, 31, v5
    v_or_b32 v32, v4, v5
    s_cmp_ge_u32 s4, 30
    s_cselect_b32 s73, 0x80000000, 0
    s_lshl_b32 s76, s7, 15
    v_mfma_f32_16x16x32_bf16 v[104:107], v[68:71], a[28:31], v[104:107]
    s_waitcnt lgkmcnt(6)
    ds_read_b64_tr_b16 v[92:93], v11 offset:10240
    ds_read_b64_tr_b16 v[94:95], v11 offset:10752
    v_mfma_f32_16x16x32_bf16 v[104:107], v[64:67], a[20:23], v[104:107]
    s_waitcnt vmcnt(5)
    s_barrier
    buffer_load_dwordx4 v27, s[8:11], s100 offen offset:3072 lds
    s_add_u32 s66, s66, s76
    s_add_u32 s68, s68, 884736
    s_cmp_ge_u32 s5, 2
    s_mov_b32 s78, 0x80000
    s_cmov_b32 s78, 0x100000
    s_mov_b32 s80, 0x1400
    s_cmov_b32 s80, 0x1410
    s_mov_b32 s81, 0x0
    s_cmov_b32 s81, 0x8000
    s_and_b32 s82, s5, 1
    s_add_u32 s78, s78, s76
    v_mfma_f32_16x16x32_bf16 v[108:111], v[72:75], a[20:23], v[108:111]
    s_add_u32 m0, s44, 32768
    ds_read_b64_tr_b16 v[64:65], v8 offset:16384
    ds_read_b64_tr_b16 v[66:67], v8 offset:16896
    v_mfma_f32_16x16x32_bf16 v[108:111], v[76:79], a[28:31], v[108:111]
    s_nop 0
    ds_read_b128 a[32:35], v28 offset:32768
    ds_read_b128 a[40:43], v29 offset:32768
    buffer_load_dwordx4 v20, s[12:15], s84 offen offset:0 lds
    s_lshl_b32 s76, s82, 14
    s_add_u32 s78, s78, s76
    s_mul_i32 s83, s6, 86
    s_lshr_b32 s83, s83, 8
    s_mul_i32 s83, s83, 3
    v_mfma_f32_16x16x32_bf16 v[100:103], v[76:79], a[24:27], v[100:103]
    s_waitcnt lgkmcnt(8)
    ds_read_b64_tr_b16 v[68:69], v8 offset:24576
    ds_read_b64_tr_b16 v[70:71], v8 offset:25088
    v_mfma_f32_16x16x32_bf16 v[100:103], v[72:75], a[16:19], v[100:103]
    buffer_load_dwordx4 v21, s[12:15], s84 offen offset:1024 lds
    s_sub_u32 s83, s6, s83
    s_sub_u32 s79, s6, s83
    s_lshr_b32 s76, s79, 3
    s_xor_b32 s76, s76, 1
    s_lshl_b32 s76, s76, 13
    s_and_b32 s79, s79, 7
    v_mfma_f32_16x16x32_bf16 v[112:115], v[80:83], a[16:19], v[112:115]
    s_add_u32 m0, s44, 65536
    ds_read_b64_tr_b16 v[72:73], v9 offset:16384
    ds_read_b64_tr_b16 v[74:75], v9 offset:16896
    v_mfma_f32_16x16x32_bf16 v[112:115], v[84:87], a[24:27], v[112:115]
    s_nop 0
    ds_read_b128 a[36:39], v28 offset:33792
    ds_read_b128 a[44:47], v29 offset:33792
    buffer_load_dwordx4 v24, s[8:11], s101 offen offset:0 lds
    s_lshl_b32 s79, s79, 22
    s_add_u32 s79, s79, s76
    s_add_u32 s79, s79, 4195840
    s_add_u32 s58, s79, s78
    s_cmp_lt_u32 s6, s83
    s_cmov_b32 s58, 0x80000000
    v_mfma_f32_16x16x32_bf16 v[120:123], v[84:87], a[28:31], v[120:123]
    s_waitcnt lgkmcnt(10)
    ds_read_b64_tr_b16 v[76:77], v9 offset:24576
    ds_read_b64_tr_b16 v[78:79], v9 offset:25088
    v_mfma_f32_16x16x32_bf16 v[120:123], v[80:83], a[20:23], v[120:123]
    buffer_load_dwordx4 v25, s[8:11], s101 offen offset:1024 lds
    s_lshl_b32 s79, s83, 1
    s_sub_u32 s79, s82, s79
    s_add_u32 s79, s79, 4
    s_mul_i32 s79, s79, s80
    s_add_u32 s61, s79, s81
    v_mfma_f32_16x16x32_bf16 v[124:127], v[88:91], a[20:23], v[124:127]
    s_waitcnt lgkmcnt(9)
    ds_read_b64_tr_b16 v[80:81], v10 offset:16384
    ds_read_b64_tr_b16 v[82:83], v10 offset:16896
    v_mfma_f32_16x16x32_bf16 v[124:127], v[92:95], a[28:31], v[124:127]
    buffer_load_dwordx4 v26, s[8:11], s101 offen offset:2048 lds
    s_sub_u32 s83, s83, 1
    s_cmov_b32 s83, 2
    s_sub_u32 s79, s6, s83
    s_lshr_b32 s76, s79, 3
    s_xor_b32 s76, s76, 1
    s_lshl_b32 s76, s76, 13
    s_and_b32 s79, s79, 7
    v_mfma_f32_16x16x32_bf16 v[116:119], v[92:95], a[24:27], v[116:119]
    s_waitcnt lgkmcnt(4)
    ds_read_b64_tr_b16 v[84:85], v10 offset:24576
    ds_read_b64_tr_b16 v[86:87], v10 offset:25088
    v_mfma_f32_16x16x32_bf16 v[116:119], v[88:91], a[16:19], v[116:119]
    buffer_load_dwordx4 v27, s[8:11], s101 offen offset:3072 lds
    s_lshl_b32 s79, s79, 22
    s_add_u32 s79, s79, s76
    s_add_u32 s79, s79, 4195840
    s_add_u32 s59, s79, s78
    s_cmp_lt_u32 s6, s83
    s_cmov_b32 s59, 0x80000000
    v_mfma_f32_16x16x32_bf16 v[96:99], v[64:67], a[32:35], v[96:99]
    s_add_u32 m0, s44, 34816
    ds_read_b64_tr_b16 v[88:89], v11 offset:16384
    ds_read_b64_tr_b16 v[90:91], v11 offset:16896
    v_mfma_f32_16x16x32_bf16 v[96:99], v[68:71], a[40:43], v[96:99]
    buffer_load_dwordx4 v20, s[12:15], s85 offen offset:0 lds
    s_lshl_b32 s79, s83, 1
    s_sub_u32 s79, s82, s79
    s_add_u32 s79, s79, 4
    s_mul_i32 s79, s79, s80
    s_add_u32 s62, s79, s81
    v_mfma_f32_16x16x32_bf16 v[104:107], v[68:71], a[44:47], v[104:107]
    s_waitcnt lgkmcnt(6)
    ds_read_b64_tr_b16 v[92:93], v11 offset:24576
    ds_read_b64_tr_b16 v[94:95], v11 offset:25088
    v_mfma_f32_16x16x32_bf16 v[104:107], v[64:67], a[36:39], v[104:107]
    s_waitcnt vmcnt(7)
    s_barrier
    buffer_load_dwordx4 v21, s[12:15], s85 offen offset:1024 lds
    s_sub_u32 s83, s83, 1
    s_cmov_b32 s83, 2
    s_sub_u32 s79, s6, s83
    s_lshr_b32 s76, s79, 3
    s_xor_b32 s76, s76, 1
    s_lshl_b32 s76, s76, 13
    s_and_b32 s79, s79, 7
    v_mfma_f32_16x16x32_bf16 v[108:111], v[72:75], a[36:39], v[108:111]
    s_add_u32 m0, s44, 81920
    ds_read_b64_tr_b16 v[64:65], v8 offset:18432
    ds_read_b64_tr_b16 v[66:67], v8 offset:18944
    v_mfma_f32_16x16x32_bf16 v[108:111], v[76:79], a[44:47], v[108:111]
    s_nop 0
    ds_read_b128 a[48:51], v28 offset:49152
    ds_read_b128 a[56:59], v29 offset:49152
    buffer_load_dwordx4 v24, s[8:11], s41 offen offset:0 lds
    s_lshl_b32 s79, s79, 22
    s_add_u32 s79, s79, s76
    s_add_u32 s79, s79, 4195840
    s_add_u32 s60, s79, s78
    s_cmp_lt_u32 s6, s83
    s_cmov_b32 s60, 0x80000000
    v_mfma_f32_16x16x32_bf16 v[100:103], v[76:79], a[40:43], v[100:103]
    s_waitcnt lgkmcnt(8)
    ds_read_b64_tr_b16 v[68:69], v8 offset:26624
    ds_read_b64_tr_b16 v[70:71], v8 offset:27136
    v_mfma_f32_16x16x32_bf16 v[100:103], v[72:75], a[32:35], v[100:103]
    buffer_load_dwordx4 v25, s[8:11], s41 offen offset:1024 lds
    s_lshl_b32 s79, s83, 1
    s_sub_u32 s79, s82, s79
    s_add_u32 s79, s79, 4
    s_mul_i32 s79, s79, s80
    s_add_u32 s63, s79, s81
    v_mfma_f32_16x16x32_bf16 v[112:115], v[80:83], a[32:35], v[112:115]
    s_waitcnt lgkmcnt(8)
    ds_read_b64_tr_b16 v[72:73], v9 offset:18432
    ds_read_b64_tr_b16 v[74:75], v9 offset:18944
    v_mfma_f32_16x16x32_bf16 v[112:115], v[84:87], a[40:43], v[112:115]
    s_nop 0
    ds_read_b128 a[52:55], v28 offset:50176
    ds_read_b128 a[60:63], v29 offset:50176
    buffer_load_dwordx4 v26, s[8:11], s41 offen offset:2048 lds
    s_lshl_b32 s67, s75, 7
    s_add_u32 s67, s67, 1703936
    s_lshr_b32 s78, s3, 1
    s_mul_i32 s78, s78, 30
    s_add_u32 s78, s78, s4
    s_mul_i32 s56, s78, 205
    v_mfma_f32_16x16x32_bf16 v[120:123], v[84:87], a[44:47], v[120:123]
    s_waitcnt lgkmcnt(10)
    ds_read_b64_tr_b16 v[76:77], v9 offset:26624
    ds_read_b64_tr_b16 v[78:79], v9 offset:27136
    v_mfma_f32_16x16x32_bf16 v[120:123], v[80:83], a[36:39], v[120:123]
    buffer_load_dwordx4 v27, s[8:11], s41 offen offset:3072 lds
    s_lshr_b32 s56, s56, 10
    s_mul_i32 s77, s56, 5
    s_sub_u32 s77, s78, s77
    s_and_b32 s78, s3, 1
    s_mul_i32 s78, s78, 5
    v_mfma_f32_16x16x32_bf16 v[124:127], v[88:91], a[36:39], v[124:127]
    s_add_u32 m0, s44, 49152
    ds_read_b64_tr_b16 v[80:81], v10 offset:18432
    ds_read_b64_tr_b16 v[82:83], v10 offset:18944
    v_mfma_f32_16x16x32_bf16 v[124:127], v[92:95], a[44:47], v[124:127]
    buffer_load_dwordx4 v20, s[12:15], s86 offen offset:0 lds
    s_add_u32 s57, s78, s77
    s_mul_i32 s76, s5, 14
    s_min_u32 s76, s76, 41
    s_mul_i32 s69, s76, 40960
    s_mul_i32 s70, s5, 204800
    v_mfma_f32_16x16x32_bf16 v[116:119], v[92:95], a[40:43], v[116:119]
    s_waitcnt lgkmcnt(4)
    ds_read_b64_tr_b16 v[84:85], v10 offset:26624
    ds_read_b64_tr_b16 v[86:87], v10 offset:27136
    v_mfma_f32_16x16x32_bf16 v[116:119], v[88:91], a[32:35], v[116:119]
    buffer_load_dwordx4 v21, s[12:15], s86 offen offset:1024 lds
    s_lshl_b32 s71, s76, 14
    s_add_u32 s72, s71, 16384
    s_lshr_b32 s74, s5, 1
    s_lshl_b32 s74, s74, 30
    v_lshrrev_b32 v2, 3, v1
    v_bfe_u32 v3, v1, 4, 1
    v_mfma_f32_16x16x32_bf16 v[96:99], v[64:67], a[48:51], v[96:99]
    s_add_u32 m0, s44, 98304
    ds_read_b64_tr_b16 v[88:89], v11 offset:18432
    ds_read_b64_tr_b16 v[90:91], v11 offset:18944
    v_mfma_f32_16x16x32_bf16 v[96:99], v[68:71], a[56:59], v[96:99]
    buffer_load_dwordx4 v24, s[8:11], s42 offen offset:0 lds
    v_lshlrev_b32 v3, 2, v3
    v_and_b32 v4, 7, v1
    v_xor_b32 v3, v3, v4
    v_mul_u32_u24 v5, 1280, v2
    v_lshl_add_u32 v5, v3, 4, v5
    v_mfma_f32_16x16x32_bf16 v[104:107], v[68:71], a[60:63], v[104:107]
    s_waitcnt lgkmcnt(6)
    ds_read_b64_tr_b16 v[92:93], v11 offset:26624
    ds_read_b64_tr_b16 v[94:95], v11 offset:27136
    v_mfma_f32_16x16x32_bf16 v[104:107], v[64:67], a[52:55], v[104:107]
    s_waitcnt vmcnt(9)
    s_barrier
    buffer_load_dwordx4 v25, s[8:11], s42 offen offset:1024 lds
    s_lshl_b32 s76, s57, 7
    s_or_b32 s76, s76, s73
    v_add_u32 v35, s76, v5
    v_add_u32 v37, 18432, v35
    v_xor_b32 v2, 4, v2
    v_mfma_f32_16x16x32_bf16 v[108:111], v[72:75], a[52:55], v[108:111]
    s_waitcnt lgkmcnt(6)
    ds_read_b64_tr_b16 v[64:65], v8 offset:32768
    ds_read_b64_tr_b16 v[66:67], v8 offset:33280
    v_mfma_f32_16x16x32_bf16 v[108:111], v[76:79], a[60:63], v[108:111]
    s_nop 0
    ds_read_b128 a[64:67], v28 offset:0
    ds_read_b128 a[72:75], v29 offset:0
    buffer_load_dwordx4 v26, s[8:11], s42 offen offset:2048 lds
    v_xor_b32 v3, 2, v3
    v_mul_u32_u24 v5, 1280, v2
    v_lshl_add_u32 v5, v3, 4, v5
    v_add_u32 v5, s76, v5
    v_xor_b32 v6, 32, v35
    v_add_u32 v36, 9216, v5
    v_mfma_f32_16x16x32_bf16 v[100:103], v[76:79], a[56:59], v[100:103]
    s_waitcnt lgkmcnt(8)
    ds_read_b64_tr_b16 v[68:69], v8 offset:40960
    ds_read_b64_tr_b16 v[70:71], v8 offset:41472
    v_mfma_f32_16x16x32_bf16 v[100:103], v[72:75], a[48:51], v[100:103]
    buffer_load_dwordx4 v27, s[8:11], s42 offen offset:3072 lds
    v_add_u32 v39, 9216, v6
    v_add_u32 v38, 27648, v5
    v_add_u32 v40, 27648, v6
    v_lshrrev_b32 v2, 4, v1
    v_bfe_u32 v3, v1, 2, 2
    v_mfma_f32_16x16x32_bf16 v[112:115], v[80:83], a[48:51], v[112:115]
    s_add_u32 m0, s44, 51200
    ds_read_b64_tr_b16 v[72:73], v9 offset:32768
    ds_read_b64_tr_b16 v[74:75], v9 offset:33280
    v_mfma_f32_16x16x32_bf16 v[112:115], v[84:87], a[56:59], v[112:115]
    s_nop 0
    ds_read_b128 a[68:71], v28 offset:1024
    ds_read_b128 a[76:79], v29 offset:1024
    buffer_load_dwordx4 v20, s[12:15], s0 offen offset:0 lds
    v_lshl_add_u32 v5, v2, 3, v3
    v_lshlrev_b32 v5, 7, v5
    v_bfe_u32 v6, v1, 3, 1
    v_lshl_add_u32 v5, v6, 6, v5
    v_and_b32 v6, 3, v1
    v_mfma_f32_16x16x32_bf16 v[120:123], v[84:87], a[60:63], v[120:123]
    s_waitcnt lgkmcnt(10)
    ds_read_b64_tr_b16 v[76:77], v9 offset:40960
    ds_read_b64_tr_b16 v[78:79], v9 offset:41472
    v_mfma_f32_16x16x32_bf16 v[120:123], v[80:83], a[52:55], v[120:123]
    buffer_load_dwordx4 v21, s[12:15], s0 offen offset:1024 lds
    v_lshl_add_u32 v5, v6, 3, v5
    v_bfe_u32 v6, v1, 4, 1
    v_lshl_add_u32 v5, v6, 5, v5
    s_add_u32 s76, s44, 0x10000
    v_add_u32 v41, s76, v5
    v_xor_b32 v42, 32, v41
    v_mfma_f32_16x16x32_bf16 v[124:127], v[88:91], a[52:55], v[124:127]
    s_add_u32 m0, s44, 114688
    ds_read_b64_tr_b16 v[80:81], v10 offset:32768
    ds_read_b64_tr_b16 v[82:83], v10 offset:33280
    v_mfma_f32_16x16x32_bf16 v[124:127], v[92:95], a[60:63], v[124:127]
    buffer_load_dwordx4 v24, s[8:11], s43 offen offset:0 lds
    v_xor_b32 v43, 64, v41
    v_xor_b32 v44, 96, v41
    v_add_u32 v45, 0x10000, v41
    v_add_u32 v46, 0x10000, v42
    v_add_u32 v241, 0x10000, v43
    v_mfma_f32_16x16x32_bf16 v[116:119], v[92:95], a[56:59], v[116:119]
    s_waitcnt lgkmcnt(4)
    ds_read_b64_tr_b16 v[84:85], v10 offset:40960
    ds_read_b64_tr_b16 v[86:87], v10 offset:41472
    v_mfma_f32_16x16x32_bf16 v[116:119], v[88:91], a[48:51], v[116:119]
    buffer_load_dwordx4 v25, s[8:11], s43 offen offset:1024 lds
    v_add_u32 v242, 0x10000, v44
    v_lshlrev_b32 v4, 4, v4
    v_lshl_add_u32 v6, v2, 7, v4
    v_bfe_u32 v5, v1, 3, 1
    s_mul_i32 s77, s56, 11
    v_mfma_f32_16x16x32_bf16 v[96:99], v[64:67], a[64:67], v[96:99]
    ds_read_b64_tr_b16 v[88:89], v11 offset:32768
    ds_read_b64_tr_b16 v[90:91], v11 offset:33280
    v_mfma_f32_16x16x32_bf16 v[96:99], v[68:71], a[72:75], v[96:99]
    buffer_load_dwordx4 v26, s[8:11], s43 offen offset:2048 lds
    s_lshr_b32 s80, s77, 4
    s_lshr_b32 s76, s80, 3
    s_lshl_b32 s76, s76, 13
    s_and_b32 s78, s80, 7
    s_lshl_b32 s78, s78, 22
    s_add_u32 s78, s78, s76
    v_mfma_f32_16x16x32_bf16 v[104:107], v[68:71], a[76:79], v[104:107]
    s_waitcnt lgkmcnt(6)
    ds_read_b64_tr_b16 v[92:93], v11 offset:40960
    ds_read_b64_tr_b16 v[94:95], v11 offset:41472
    v_mfma_f32_16x16x32_bf16 v[104:107], v[64:67], a[68:71], v[104:107]
    s_waitcnt vmcnt(11)
    s_barrier
    buffer_load_dwordx4 v27, s[8:11], s43 offen offset:3072 lds
    s_add_u32 s78, s78, 2097152
    s_or_b32 s78, s78, s73
    s_add_u32 s80, s80, 1
    s_lshr_b32 s76, s80, 3
    s_lshl_b32 s76, s76, 13
    v_mfma_f32_16x16x32_bf16 v[108:111], v[72:75], a[68:71], v[108:111]
    s_add_u32 m0, s44, 0
    ds_read_b64_tr_b16 v[64:65], v8 offset:34816
    ds_read_b64_tr_b16 v[66:67], v8 offset:35328
    v_mfma_f32_16x16x32_bf16 v[108:111], v[76:79], a[76:79], v[108:111]
    s_nop 0
    ds_read_b128 a[80:83], v28 offset:16384
    ds_read_b128 a[88:91], v29 offset:16384
    s_and_b32 s79, s80, 7
    s_lshl_b32 s79, s79, 22
    s_add_u32 s79, s79, s76
    s_add_u32 s79, s79, 2097152
    s_sub_u32 s79, s79, 8192
    v_mfma_f32_16x16x32_bf16 v[100:103], v[76:79], a[72:75], v[100:103]
    s_waitcnt lgkmcnt(8)
    ds_read_b64_tr_b16 v[68:69], v8 offset:43008
    ds_read_b64_tr_b16 v[70:71], v8 offset:43520
    v_mfma_f32_16x16x32_bf16 v[100:103], v[72:75], a[64:67], v[100:103]
    buffer_load_dwordx4 v20, s[12:15], s1 offen offset:0 lds
    s_or_b32 s79, s79, s73
    s_cmp_ge_u32 s80, 16
    s_cmov_b32 s79, 0x80000000
    s_and_b32 s76, s77, 15
    v_add_u32 v3, s76, v5
    v_lshl_add_u32 v6, v3, 9, v6
    v_add_u32 v7, s79, v6
    v_mfma_f32_16x16x32_bf16 v[112:115], v[80:83], a[64:67], v[112:115]
    s_waitcnt lgkmcnt(8)
    ds_read_b64_tr_b16 v[72:73], v9 offset:34816
    ds_read_b64_tr_b16 v[74:75], v9 offset:35328
    v_mfma_f32_16x16x32_bf16 v[112:115], v[84:87], a[72:75], v[112:115]
    s_nop 0
    ds_read_b128 a[84:87], v28 offset:17408
    ds_read_b128 a[92:95], v29 offset:17408
    v_add_u32 v6, s78, v6
    v_cmp_le_u32 vcc, 16, v3
    s_nop 1
    v_cndmask_b32 v48, v6, v7, vcc
    v_cmp_le_u32 vcc, 14, v3
    s_nop 1
    v_cndmask_b32 v49, v6, v7, vcc
    v_mfma_f32_16x16x32_bf16 v[120:123], v[84:87], a[76:79], v[120:123]
    s_waitcnt lgkmcnt(10)
    ds_read_b64_tr_b16 v[76:77], v9 offset:43008
    ds_read_b64_tr_b16 v[78:79], v9 offset:43520
    v_mfma_f32_16x16x32_bf16 v[120:123], v[80:83], a[68:71], v[120:123]
    buffer_load_dwordx4 v21, s[12:15], s1 offen offset:1024 lds
    v_cmp_le_u32 vcc, 12, v3
    s_nop 1
    v_cndmask_b32 v50, v6, v7, vcc
    v_cmp_le_u32 vcc, 10, v3
    s_nop 1
    v_cndmask_b32 v52, v6, v7, vcc
    v_cmp_le_u32 vcc, 8, v3
    v_mfma_f32_16x16x32_bf16 v[124:127], v[88:91], a[68:71], v[124:127]
    s_add_u32 m0, s44, 65536
    ds_read_b64_tr_b16 v[80:81], v10 offset:34816
    ds_read_b64_tr_b16 v[82:83], v10 offset:35328
    v_mfma_f32_16x16x32_bf16 v[124:127], v[92:95], a[76:79], v[124:127]
    buffer_load_dwordx4 v24, s[8:11], s54 offen offset:0 lds
    v_add_u32 v6, 4096, v6
    v_add_u32 v7, 4096, v7
    v_cndmask_b32 v222, v6, v7, vcc
    v_cmp_le_u32 vcc, 6, v3
    s_nop 1
    v_cndmask_b32 v223, v6, v7, vcc
    v_lshlrev_b32 v5, 31, v5
    v_mfma_f32_16x16x32_bf16 v[116:119], v[92:95], a[72:75], v[116:119]
    s_waitcnt lgkmcnt(4)
    ds_read_b64_tr_b16 v[84:85], v10 offset:43008
    ds_read_b64_tr_b16 v[86:87], v10 offset:43520
    v_mfma_f32_16x16x32_bf16 v[116:119], v[88:91], a[64:67], v[116:119]
    buffer_load_dwordx4 v25, s[8:11], s54 offen offset:1024 lds
    v_or_b32 v223, v5, v223
    v_lshrrev_b32 v2, 5, v1
    v_bfe_u32 v5, v1, 3, 2
    v_lshl_add_u32 v6, v5, 9, v4
    s_mul_i32 s76, s7, 5
    v_mfma_f32_16x16x32_bf16 v[96:99], v[64:67], a[80:83], v[96:99]
    ds_read_b64_tr_b16 v[88:89], v11 offset:34816
    ds_read_b64_tr_b16 v[90:91], v11 offset:35328
    v_mfma_f32_16x16x32_bf16 v[96:99], v[68:71], a[88:91], v[96:99]
    buffer_load_dwordx4 v26, s[8:11], s54 offen offset:2048 lds
    v_add3_u32 v3, v2, s76, 0
    v_and_b32 v7, 3, v3
    v_lshl_add_u32 v7, v7, 7, v6
    v_lshrrev_b32 v3, 2, v3
    v_lshl_add_u32 v57, v3, 14, v7
    v_mfma_f32_16x16x32_bf16 v[104:107], v[68:71], a[92:95], v[104:107]
    s_waitcnt lgkmcnt(6)
    ds_read_b64_tr_b16 v[92:93], v11 offset:43008
    ds_read_b64_tr_b16 v[94:95], v11 offset:43520
    v_mfma_f32_16x16x32_bf16 v[104:107], v[64:67], a[84:87], v[104:107]
    s_waitcnt vmcnt(11)
    s_barrier
    buffer_load_dwordx4 v27, s[8:11], s54 offen offset:3072 lds
    v_add3_u32 v3, v2, s76, 3
    v_and_b32 v7, 3, v3
    v_lshl_add_u32 v7, v7, 7, v6
    v_lshrrev_b32 v3, 2, v3
    v_lshl_add_u32 v59, v3, 14, v7
    v_add3_u32 v3, v2, s76, 2
    v_mfma_f32_16x16x32_bf16 v[108:111], v[72:75], a[84:87], v[108:111]
    s_add_u32 m0, s44, 2048
    ds_read_b64_tr_b16 v[64:65], v8 offset:49152
    ds_read_b64_tr_b16 v[66:67], v8 offset:49664
    v_mfma_f32_16x16x32_bf16 v[108:111], v[76:79], a[92:95], v[108:111]
    s_nop 0
    ds_read_b128 a[96:99], v28 offset:32768
    ds_read_b128 a[104:107], v29 offset:32768
    v_and_b32 v7, 3, v3
    v_lshl_add_u32 v7, v7, 7, v6
    v_lshrrev_b32 v3, 2, v3
    v_lshl_add_u32 v60, v3, 14, v7
    v_mov_b32 v7, 0x80000000
    v_mfma_f32_16x16x32_bf16 v[100:103], v[76:79], a[88:91], v[100:103]
    s_waitcnt lgkmcnt(8)
    ds_read_b64_tr_b16 v[68:69], v8 offset:57344
    ds_read_b64_tr_b16 v[70:71], v8 offset:57856
    v_mfma_f32_16x16x32_bf16 v[100:103], v[72:75], a[80:83], v[100:103]
    buffer_load_dwordx4 v20, s[12:15], s40 offen offset:0 lds
    v_mul_u32_u24 v6, 640, v5
    s_mul_i32 s78, s5, 2560
    v_add3_u32 v6, v6, v4, s78
    v_lshl_add_u32 v220, v2, 7, v6
    v_lshl_add_u32 v221, v2, 3, v6
    v_mfma_f32_16x16x32_bf16 v[112:115], v[80:83], a[80:83], v[112:115]
    s_waitcnt lgkmcnt(8)
    ds_read_b64_tr_b16 v[72:73], v9 offset:49152
    ds_read_b64_tr_b16 v[74:75], v9 offset:49664
    v_mfma_f32_16x16x32_bf16 v[112:115], v[84:87], a[88:91], v[112:115]
    s_nop 0
    ds_read_b128 a[100:103], v28 offset:33792
    ds_read_b128 a[108:111], v29 offset:33792
    v_cmp_eq_u32 vcc, 0, v0
    s_lshr_b32 s76, s6, 3
    s_and_b32 s78, s6, 7
    s_lshl_b32 s78, s78, 1
    s_sub_u32 s78, s78, s76
    s_lshl_b32 s78, s78, 13
    v_mfma_f32_16x16x32_bf16 v[120:123], v[84:87], a[92:95], v[120:123]
    s_waitcnt lgkmcnt(10)
    ds_read_b64_tr_b16 v[76:77], v9 offset:57344
    ds_read_b64_tr_b16 v[78:79], v9 offset:57856
    v_mfma_f32_16x16x32_bf16 v[120:123], v[80:83], a[84:87], v[120:123]
    buffer_load_dwordx4 v21, s[12:15], s40 offen offset:1024 lds
    v_add_u32 v20, 128, v20
    v_add_u32 v21, 128, v21
    s_add_u32 s78, s78, 1581056
    s_mul_i32 s76, s7, 384
    s_add_u32 s76, s76, s78
    v_mov_b32 v4, s76
    v_cndmask_b32 v51, v7, v4, vcc
    v_mfma_f32_16x16x32_bf16 v[124:127], v[88:91], a[84:87], v[124:127]
    s_add_u32 m0, s44, 81920
    ds_read_b64_tr_b16 v[80:81], v10 offset:49152
    ds_read_b64_tr_b16 v[82:83], v10 offset:49664
    v_mfma_f32_16x16x32_bf16 v[124:127], v[92:95], a[92:95], v[124:127]
    buffer_load_dwordx4 v24, s[8:11], s55 offen offset:0 lds
    v_mov_b32 v53, 1
    s_min_u32 s78, s5, 2
    s_sub_u32 s78, s6, s78
    s_max_i32 s78, s78, 0
    s_lshr_b32 s76, s78, 3
    v_mfma_f32_16x16x32_bf16 v[116:119], v[92:95], a[88:91], v[116:119]
    s_waitcnt lgkmcnt(4)
    ds_read_b64_tr_b16 v[84:85], v10 offset:57344
    ds_read_b64_tr_b16 v[86:87], v10 offset:57856
    v_mfma_f32_16x16x32_bf16 v[116:119], v[88:91], a[80:83], v[116:119]
    buffer_load_dwordx4 v25, s[8:11], s55 offen offset:1024 lds
    s_and_b32 s78, s78, 7
    s_lshl_b32 s78, s78, 1
    s_sub_u32 s78, s78, s76
    s_lshl_b32 s78, s78, 13
    s_add_u32 s78, s78, 1581056
L_pad0:
    s_cmp_eq_u32 s92, 1
    s_cbranch_scc1 L_pad4
    s_cmp_eq_u32 s5, 3
    s_cselect_b32 s76, 0, 384
    v_mfma_f32_16x16x32_bf16 v[96:99], v[64:67], a[96:99], v[96:99]
    ds_read_b64_tr_b16 v[88:89], v11 offset:49152
    ds_read_b64_tr_b16 v[90:91], v11 offset:49664
    v_mfma_f32_16x16x32_bf16 v[96:99], v[68:71], a[104:107], v[96:99]
    buffer_load_dwordx4 v26, s[8:11], s55 offen offset:2048 lds
    v_lshrrev_b32 v4, 2, v1
    v_mul_u32_u24 v4, s76, v4
    v_add_u32 v54, s78, v4
    s_bitcmp1_b32 s7, 0
    s_cselect_b32 s98, 0, -1
    s_cselect_b32 s99, -1, 0
    s_lshr_b32 s76, s5, 1
    v_mfma_f32_16x16x32_bf16 v[104:107], v[68:71], a[108:111], v[104:107]
    s_waitcnt lgkmcnt(6)
    ds_read_b64_tr_b16 v[92:93], v11 offset:57344
    ds_read_b64_tr_b16 v[94:95], v11 offset:57856
    v_mfma_f32_16x16x32_bf16 v[104:107], v[64:67], a[100:103], v[104:107]
    s_waitcnt vmcnt(11)
    s_barrier
    buffer_load_dwordx4 v27, s[8:11], s55 offen offset:3072 lds
    s_mul_i32 s76, s76, 10
    s_add_u32 s76, s76, s77
    s_lshr_b32 s76, s76, 4
    s_min_u32 s76, s76, 15
    s_lshr_b32 s78, s76, 3
    v_mfma_f32_16x16x32_bf16 v[108:111], v[72:75], a[100:103], v[108:111]
    s_add_u32 m0, s44, 16384
    ds_read_b64_tr_b16 v[64:65], v8 offset:51200
    ds_read_b64_tr_b16 v[66:67], v8 offset:51712
    v_mfma_f32_16x16x32_bf16 v[108:111], v[76:79], a[108:111], v[108:111]
    s_nop 0
    ds_read_b128 a[112:115], v28 offset:49152
    ds_read_b128 a[120:123], v29 offset:49152
    buffer_load_dwordx4 v20, s[12:15], s45 offen offset:0 lds
    s_and_b32 s76, s76, 7
    s_lshl_b32 s76, s76, 1
    s_sub_u32 s76, s76, s78
    s_lshl_b32 s76, s76, 13
    s_add_u32 s76, s76, 1581056
    s_and_b32 s78, s5, 1
    v_mfma_f32_16x16x32_bf16 v[100:103], v[76:79], a[104:107], v[100:103]
    s_waitcnt lgkmcnt(8)
    ds_read_b64_tr_b16 v[68:69], v8 offset:59392
    ds_read_b64_tr_b16 v[70:71], v8 offset:59904
    v_mfma_f32_16x16x32_bf16 v[100:103], v[72:75], a[96:99], v[100:103]
    s_mul_i32 s78, s78, 3072
    s_add_u32 s76, s76, s78
    v_lshrrev_b32 v4, 3, v1
    v_mul_u32_u24 v4, 384, v4
    v_add_u32 v55, s76, v4
    v_mfma_f32_16x16x32_bf16 v[112:115], v[80:83], a[96:99], v[112:115]
    s_waitcnt lgkmcnt(8)
    ds_read_b64_tr_b16 v[72:73], v9 offset:51200
    ds_read_b64_tr_b16 v[74:75], v9 offset:51712
    v_mfma_f32_16x16x32_bf16 v[112:115], v[84:87], a[104:107], v[112:115]
    s_nop 0
    ds_read_b128 a[116:119], v28 offset:50176
    ds_read_b128 a[124:127], v29 offset:50176
    buffer_load_dwordx4 v21, s[12:15], s45 offen offset:1024 lds
    v_and_b32 v63, 60, v1
    v_add_u32 v30, 0, v238
    v_mul_u32_u24 v255, 205, v30
    v_lshl_add_u32 v30, v30, 7, v239
    v_lshrrev_b32 v255, 10, v255
    v_mfma_f32_16x16x32_bf16 v[120:123], v[84:87], a[108:111], v[120:123]
    s_waitcnt lgkmcnt(10)
    ds_read_b64_tr_b16 v[76:77], v9 offset:59392
    ds_read_b64_tr_b16 v[78:79], v9 offset:59904
    v_mfma_f32_16x16x32_bf16 v[120:123], v[80:83], a[100:103], v[120:123]
    v_mad_u32_u24 v30, v255, s64, v30
    v_add3_u32 v240, v238, s53, 0
    v_mul_u32_u24 v255, 205, v240
    v_lshl_add_u32 v240, v240, 7, v239
    v_lshrrev_b32 v255, 10, v255
    v_mad_u32_u24 v240, v255, s64, v240
    v_mfma_f32_16x16x32_bf16 v[124:127], v[88:91], a[100:103], v[124:127]
    s_add_u32 m0, s44, 18432
    ds_read_b64_tr_b16 v[80:81], v10 offset:51200
    ds_read_b64_tr_b16 v[82:83], v10 offset:51712
    v_mfma_f32_16x16x32_bf16 v[124:127], v[92:95], a[108:111], v[124:127]
    buffer_load_dwordx4 v20, s[12:15], s47 offen offset:0 lds
    v_add_u32 v243, 4, v238
    v_mul_u32_u24 v255, 205, v243
    v_lshl_add_u32 v243, v243, 7, v239
    v_lshrrev_b32 v255, 10, v255
    v_mad_u32_u24 v243, v255, s64, v243
    v_mfma_f32_16x16x32_bf16 v[116:119], v[92:95], a[104:107], v[116:119]
    s_waitcnt lgkmcnt(4)
    ds_read_b64_tr_b16 v[84:85], v10 offset:59392
    ds_read_b64_tr_b16 v[86:87], v10 offset:59904
    v_mfma_f32_16x16x32_bf16 v[116:119], v[88:91], a[96:99], v[116:119]
    v_add3_u32 v254, v238, s53, 4
    v_mul_u32_u24 v255, 205, v254
    v_lshl_add_u32 v254, v254, 7, v239
    v_lshrrev_b32 v255, 10, v255
    v_mad_u32_u24 v254, v255, s64, v254
    v_mfma_f32_16x16x32_bf16 v[96:99], v[64:67], a[112:115], v[96:99]
    ds_read_b64_tr_b16 v[88:89], v11 offset:51200
    ds_read_b64_tr_b16 v[90:91], v11 offset:51712
    v_mfma_f32_16x16x32_bf16 v[96:99], v[68:71], a[120:123], v[96:99]
    buffer_load_dwordx4 v21, s[12:15], s47 offen offset:1024 lds
    v_mfma_f32_16x16x32_bf16 v[104:107], v[68:71], a[124:127], v[104:107]
    s_waitcnt lgkmcnt(6)
    ds_read_b64_tr_b16 v[92:93], v11 offset:59392
    ds_read_b64_tr_b16 v[94:95], v11 offset:59904
    v_mfma_f32_16x16x32_bf16 v[104:107], v[64:67], a[116:119], v[104:107]
    s_waitcnt vmcnt(10)
    s_barrier
    v_mfma_f32_16x16x32_bf16 v[108:111], v[72:75], a[116:119], v[108:111]
    s_add_u32 m0, s44, 32768
    ds_read_b64_tr_b16 v[64:65], v8 offset:0
    ds_read_b64_tr_b16 v[66:67], v8 offset:512
    v_mfma_f32_16x16x32_bf16 v[108:111], v[76:79], a[124:127], v[108:111]
    s_nop 0
    ds_read_b128 a[128:131], v28 offset:0
    ds_read_b128 a[136:139], v29 offset:0
    buffer_load_dwordx4 v20, s[12:15], s48 offen offset:0 lds
    v_mfma_f32_16x16x32_bf16 v[100:103], v[76:79], a[120:123], v[100:103]
    s_waitcnt lgkmcnt(8)
    ds_read_b64_tr_b16 v[68:69], v8 offset:8192
    ds_read_b64_tr_b16 v[70:71], v8 offset:8704
    v_mfma_f32_16x16x32_bf16 v[100:103], v[72:75], a[112:115], v[100:103]
    v_mfma_f32_16x16x32_bf16 v[112:115], v[80:83], a[112:115], v[112:115]
    s_waitcnt lgkmcnt(8)
    ds_read_b64_tr_b16 v[72:73], v9 offset:0
    ds_read_b64_tr_b16 v[74:75], v9 offset:512
    v_mfma_f32_16x16x32_bf16 v[112:115], v[84:87], a[120:123], v[112:115]
    s_nop 0
    ds_read_b128 a[132:135], v28 offset:1024
    ds_read_b128 a[140:143], v29 offset:1024
    buffer_load_dwordx4 v21, s[12:15], s48 offen offset:1024 lds
    v_mfma_f32_16x16x32_bf16 v[120:123], v[84:87], a[124:127], v[120:123]
    s_waitcnt lgkmcnt(10)
    ds_read_b64_tr_b16 v[76:77], v9 offset:8192
    ds_read_b64_tr_b16 v[78:79], v9 offset:8704
    v_mfma_f32_16x16x32_bf16 v[120:123], v[80:83], a[116:119], v[120:123]
    v_mfma_f32_16x16x32_bf16 v[124:127], v[88:91], a[116:119], v[124:127]
    s_add_u32 m0, s44, 34816
    ds_read_b64_tr_b16 v[80:81], v10 offset:0
    ds_read_b64_tr_b16 v[82:83], v10 offset:512
    v_mfma_f32_16x16x32_bf16 v[124:127], v[92:95], a[124:127], v[124:127]
    buffer_load_dwordx4 v20, s[12:15], s65 offen offset:0 lds
    v_mfma_f32_16x16x32_bf16 v[116:119], v[92:95], a[120:123], v[116:119]
    s_waitcnt lgkmcnt(4)
    ds_read_b64_tr_b16 v[84:85], v10 offset:8192
    ds_read_b64_tr_b16 v[86:87], v10 offset:8704
    v_mfma_f32_16x16x32_bf16 v[116:119], v[88:91], a[112:115], v[116:119]
    v_mfma_f32_16x16x32_bf16 v[96:99], v[64:67], a[128:131], v[96:99]
    ds_read_b64_tr_b16 v[88:89], v11 offset:0
    ds_read_b64_tr_b16 v[90:91], v11 offset:512
    v_mfma_f32_16x16x32_bf16 v[96:99], v[68:71], a[136:139], v[96:99]
    buffer_load_dwordx4 v21, s[12:15], s65 offen offset:1024 lds
    v_mfma_f32_16x16x32_bf16 v[104:107], v[68:71], a[140:143], v[104:107]
    s_waitcnt lgkmcnt(6)
    ds_read_b64_tr_b16 v[92:93], v11 offset:8192
    ds_read_b64_tr_b16 v[94:95], v11 offset:8704
    v_mfma_f32_16x16x32_bf16 v[104:107], v[64:67], a[132:135], v[104:107]
    s_waitcnt vmcnt(8)
    s_barrier
    v_mfma_f32_16x16x32_bf16 v[108:111], v[72:75], a[132:135], v[108:111]
    s_add_u32 m0, s44, 49152
    ds_read_b64_tr_b16 v[64:65], v8 offset:2048
    ds_read_b64_tr_b16 v[66:67], v8 offset:2560
    v_mfma_f32_16x16x32_bf16 v[108:111], v[76:79], a[140:143], v[108:111]
    s_nop 0
    ds_read_b128 a[144:147], v28 offset:16384
    ds_read_b128 a[152:155], v29 offset:16384
    buffer_load_dwordx4 v20, s[12:15], s84 offen offset:0 lds
    v_mfma_f32_16x16x32_bf16 v[100:103], v[76:79], a[136:139], v[100:103]
    s_waitcnt lgkmcnt(8)
    ds_read_b64_tr_b16 v[68:69], v8 offset:10240
    ds_read_b64_tr_b16 v[70:71], v8 offset:10752
    v_mfma_f32_16x16x32_bf16 v[100:103], v[72:75], a[128:131], v[100:103]
    buffer_load_dword v56, v63, s[36:39], 0 offen sc1
    v_mfma_f32_16x16x32_bf16 v[112:115], v[80:83], a[128:131], v[112:115]
    s_waitcnt lgkmcnt(8)
    ds_read_b64_tr_b16 v[72:73], v9 offset:2048
    ds_read_b64_tr_b16 v[74:75], v9 offset:2560
    v_mfma_f32_16x16x32_bf16 v[112:115], v[84:87], a[136:139], v[112:115]
    s_nop 0
    ds_read_b128 a[148:151], v28 offset:17408
    ds_read_b128 a[156:159], v29 offset:17408
    buffer_load_dwordx4 v21, s[12:15], s84 offen offset:1024 lds
    v_mfma_f32_16x16x32_bf16 v[120:123], v[84:87], a[140:143], v[120:123]
    s_waitcnt lgkmcnt(10)
    ds_read_b64_tr_b16 v[76:77], v9 offset:10240
    ds_read_b64_tr_b16 v[78:79], v9 offset:10752
    v_mfma_f32_16x16x32_bf16 v[120:123], v[80:83], a[132:135], v[120:123]
    v_mfma_f32_16x16x32_bf16 v[124:127], v[88:91], a[132:135], v[124:127]
    s_add_u32 m0, s44, 51200
    ds_read_b64_tr_b16 v[80:81], v10 offset:2048
    ds_read_b64_tr_b16 v[82:83], v10 offset:2560
    v_mfma_f32_16x16x32_bf16 v[124:127], v[92:95], a[140:143], v[124:127]
    buffer_load_dwordx4 v20, s[12:15], s85 offen offset:0 lds
    v_mfma_f32_16x16x32_bf16 v[116:119], v[92:95], a[136:139], v[116:119]
    s_waitcnt lgkmcnt(4)
    ds_read_b64_tr_b16 v[84:85], v10 offset:10240
    ds_read_b64_tr_b16 v[86:87], v10 offset:10752
    v_mfma_f32_16x16x32_bf16 v[116:119], v[88:91], a[128:131], v[116:119]
    v_mfma_f32_16x16x32_bf16 v[96:99], v[64:67], a[144:147], v[96:99]
    ds_read_b64_tr_b16 v[88:89], v11 offset:2048
    ds_read_b64_tr_b16 v[90:91], v11 offset:2560
    v_mfma_f32_16x16x32_bf16 v[96:99], v[68:71], a[152:155], v[96:99]
    buffer_load_dwordx4 v21, s[12:15], s85 offen offset:1024 lds
    v_mfma_f32_16x16x32_bf16 v[104:107], v[68:71], a[156:159], v[104:107]
    s_waitcnt lgkmcnt(6)
    ds_read_b64_tr_b16 v[92:93], v11 offset:10240
    ds_read_b64_tr_b16 v[94:95], v11 offset:10752
    v_mfma_f32_16x16x32_bf16 v[104:107], v[64:67], a[148:151], v[104:107]
    s_waitcnt vmcnt(9)
    s_barrier
    v_mfma_f32_16x16x32_bf16 v[108:111], v[72:75], a[148:151], v[108:111]
    s_add_u32 m0, s44, 0
    ds_read_b64_tr_b16 v[64:65], v8 offset:16384
    ds_read_b64_tr_b16 v[66:67], v8 offset:16896
    v_mfma_f32_16x16x32_bf16 v[108:111], v[76:79], a[156:159], v[108:111]
    buffer_load_dwordx4 v20, s[12:15], s86 offen offset:0 lds
    v_mfma_f32_16x16x32_bf16 v[100:103], v[76:79], a[152:155], v[100:103]
    s_waitcnt lgkmcnt(6)
    ds_read_b64_tr_b16 v[68:69], v8 offset:24576
    ds_read_b64_tr_b16 v[70:71], v8 offset:25088
    v_mfma_f32_16x16x32_bf16 v[100:103], v[72:75], a[144:147], v[100:103]
    v_mfma_f32_16x16x32_bf16 v[112:115], v[80:83], a[144:147], v[112:115]
    s_waitcnt lgkmcnt(6)
    ds_read_b64_tr_b16 v[72:73], v9 offset:16384
    ds_read_b64_tr_b16 v[74:75], v9 offset:16896
    v_mfma_f32_16x16x32_bf16 v[112:115], v[84:87], a[152:155], v[112:115]
    buffer_load_dwordx4 v21, s[12:15], s86 offen offset:1024 lds
    v_mfma_f32_16x16x32_bf16 v[120:123], v[84:87], a[156:159], v[120:123]
    s_waitcnt lgkmcnt(6)
    ds_read_b64_tr_b16 v[76:77], v9 offset:24576
    ds_read_b64_tr_b16 v[78:79], v9 offset:25088
    v_mfma_f32_16x16x32_bf16 v[120:123], v[80:83], a[148:151], v[120:123]
    s_mul_i32 s46, s46, 1728
    v_mfma_f32_16x16x32_bf16 v[124:127], v[88:91], a[148:151], v[124:127]
    s_add_u32 m0, s44, 131072
    ds_read_b64_tr_b16 v[80:81], v10 offset:16384
    ds_read_b64_tr_b16 v[82:83], v10 offset:16896
    v_mfma_f32_16x16x32_bf16 v[124:127], v[92:95], a[156:159], v[124:127]
    buffer_load_dwordx4 v22, s[16:19], s46 offen offset:0 lds
    v_mfma_f32_16x16x32_bf16 v[116:119], v[92:95], a[152:155], v[116:119]
    s_waitcnt lgkmcnt(6)
    ds_read_b64_tr_b16 v[84:85], v10 offset:24576
    ds_read_b64_tr_b16 v[86:87], v10 offset:25088
    v_mfma_f32_16x16x32_bf16 v[116:119], v[88:91], a[144:147], v[116:119]
    v_mfma_f32_16x16x32_bf16 v[128:131], v[64:67], a[0:3], 0
    s_waitcnt lgkmcnt(6)
    ds_read_b64_tr_b16 v[88:89], v11 offset:16384
    ds_read_b64_tr_b16 v[90:91], v11 offset:16896
    v_mfma_f32_16x16x32_bf16 v[128:131], v[68:71], a[8:11], v[128:131]
    buffer_load_dwordx4 v23, s[16:19], s46 offen offset:1024 lds
    v_mfma_f32_16x16x32_bf16 v[136:139], v[68:71], a[12:15], 0
    s_waitcnt lgkmcnt(6)
    ds_read_b64_tr_b16 v[92:93], v11 offset:24576
    ds_read_b64_tr_b16 v[94:95], v11 offset:25088
    v_mfma_f32_16x16x32_bf16 v[136:139], v[64:67], a[4:7], v[136:139]
    s_mul_i32 s87, s87, 1728
    v_cvt_pk_bf16_f32 v192, v96, v97
    v_mfma_f32_16x16x32_bf16 v[140:143], v[72:75], a[4:7], 0
    s_add_u32 m0, s44, 133120
    ds_read_b64_tr_b16 v[64:65], v8 offset:18432
    ds_read_b64_tr_b16 v[66:67], v8 offset:18944
    v_mfma_f32_16x16x32_bf16 v[140:143], v[76:79], a[12:15], v[140:143]
    buffer_load_dwordx4 v22, s[16:19], s87 offen offset:0 lds
    v_mfma_f32_16x16x32_bf16 v[132:135], v[76:79], a[8:11], 0
    s_waitcnt lgkmcnt(6)
    ds_read_b64_tr_b16 v[68:69], v8 offset:26624
    ds_read_b64_tr_b16 v[70:71], v8 offset:27136
    v_mfma_f32_16x16x32_bf16 v[132:135], v[72:75], a[0:3], v[132:135]
    s_waitcnt vmcnt(8)
    v_cmp_eq_u32 vcc, 0, v56
    s_nop 0
    s_cbranch_vccnz L_spin_11
L_ok_12:
    v_cmp_eq_u32 vcc, 3, v56
    s_nop 0
    s_bcnt1_i32_b64 s76, vcc
    v_cmp_eq_u32 vcc, 5, v56
    s_nop 0
    s_bcnt1_i32_b64 s77, vcc
    s_cmp_lt_u32 s76, s77
    s_cselect_b32 s3, 0x200000, 0
    s_add_u32 s20, s20, s3
    s_addc_u32 s21, s21, 0
    v_cvt_pk_bf16_f32 v193, v98, v99
    v_cvt_pk_bf16_f32 v194, v100, v101
    v_mfma_f32_16x16x32_bf16 v[144:147], v[80:83], a[0:3], 0
    s_waitcnt lgkmcnt(6)
    ds_read_b64_tr_b16 v[72:73], v9 offset:18432
    ds_read_b64_tr_b16 v[74:75], v9 offset:18944
    v_mfma_f32_16x16x32_bf16 v[144:147], v[84:87], a[8:11], v[144:147]
    buffer_load_dwordx4 v23, s[16:19], s87 offen offset:1024 lds
    v_subrev_u32 v24, 0x10000, v41
    v_subrev_u32 v25, 0x10000, v42
    v_subrev_u32 v26, 0x10000, v43
    v_subrev_u32 v27, 0x10000, v44
    v_mfma_f32_16x16x32_bf16 v[152:155], v[84:87], a[12:15], 0
    s_waitcnt lgkmcnt(6)
    ds_read_b64_tr_b16 v[76:77], v9 offset:26624
    ds_read_b64_tr_b16 v[78:79], v9 offset:27136
    v_mfma_f32_16x16x32_bf16 v[152:155], v[80:83], a[4:7], v[152:155]
    v_cvt_pk_bf16_f32 v195, v102, v103
    v_cvt_pk_bf16_f32 v196, v104, v105
    v_lshlrev_b32 v236, 4, v1
    v_add_u32 v237, 4096, v236
    v_and_b32 v3, 31, v1
    v_mfma_f32_16x16x32_bf16 v[156:159], v[88:91], a[4:7], 0
    s_waitcnt lgkmcnt(6)
    ds_read_b64_tr_b16 v[80:81], v10 offset:18432
    ds_read_b64_tr_b16 v[82:83], v10 offset:18944
    v_mfma_f32_16x16x32_bf16 v[156:159], v[92:95], a[12:15], v[156:159]
    buffer_store_dwordx4 v[192:195], v30, s[20:23], s49 offen sc1
    v_lshlrev_b32 v61, 2, v3
    v_min_u32 v6, 5, v1
    v_lshrrev_b32 v4, 1, v6
    v_mfma_f32_16x16x32_bf16 v[148:151], v[92:95], a[8:11], 0
    s_waitcnt lgkmcnt(6)
    ds_read_b64_tr_b16 v[84:85], v10 offset:26624
    ds_read_b64_tr_b16 v[86:87], v10 offset:27136
    v_mfma_f32_16x16x32_bf16 v[148:151], v[88:91], a[0:3], v[148:151]
    v_cvt_pk_bf16_f32 v197, v106, v107
    v_cvt_pk_bf16_f32 v198, v108, v109
    v_add_u32 v4, s6, v4
    v_cmp_le_u32 s[78:79], 2, v4
    v_mov_b32 v5, 0x3f803f80
    v_mfma_f32_16x16x32_bf16 v[128:131], v[64:67], a[16:19], v[128:131]
    s_waitcnt lgkmcnt(6)
    ds_read_b64_tr_b16 v[88:89], v11 offset:18432
    ds_read_b64_tr_b16 v[90:91], v11 offset:18944
    v_mfma_f32_16x16x32_bf16 v[128:131], v[68:71], a[24:27], v[128:131]
    v_cvt_pk_bf16_f32 v199, v110, v111
    v_cvt_pk_bf16_f32 v200, v112, v113
    v_mul_u32_u24 v62, 5136, v6
    v_cndmask_b32 v232, 0, v5, s[78:79]
    v_cndmask_b32 v233, 0, v5, s[78:79]
    v_mfma_f32_16x16x32_bf16 v[136:139], v[68:71], a[28:31], v[136:139]
    s_waitcnt lgkmcnt(6)
    ds_read_b64_tr_b16 v[92:93], v11 offset:26624
    ds_read_b64_tr_b16 v[94:95], v11 offset:27136
    v_mfma_f32_16x16x32_bf16 v[136:139], v[64:67], a[20:23], v[136:139]
    s_barrier
    v_cndmask_b32 v234, 0, v5, s[78:79]
    v_cndmask_b32 v235, 0, v5, s[78:79]
    v_lshrrev_b32 v2, 5, v1
    v_mfma_f32_16x16x32_bf16 v[140:143], v[72:75], a[20:23], v[140:143]
    s_add_u32 m0, s44, 2048
    ds_read_b64_tr_b16 v[64:65], v8 offset:32768
    ds_read_b64_tr_b16 v[66:67], v8 offset:33280
    v_mfma_f32_16x16x32_bf16 v[140:143], v[76:79], a[28:31], v[140:143]
    buffer_load_dwordx4 v20, s[12:15], s0 offen offset:0 lds
    v_and_b32 v3, 31, v1
    v_cmp_gt_u32 s[78:79], 16, v3
    v_and_b32 v6, 3, v1
    v_bfe_u32 v7, v1, 2, 1
    v_mfma_f32_16x16x32_bf16 v[132:135], v[76:79], a[24:27], v[132:135]
    s_waitcnt lgkmcnt(6)
    ds_read_b64_tr_b16 v[68:69], v8 offset:40960
    ds_read_b64_tr_b16 v[70:71], v8 offset:41472
    v_mfma_f32_16x16x32_bf16 v[132:135], v[72:75], a[16:19], v[132:135]
    buffer_store_dwordx4 v[196:199], v240, s[20:23], s50 offen sc1
    v_lshl_add_u32 v7, v7, 3, v6
    v_bfe_u32 v4, v1, 3, 1
    v_lshl_add_u32 v7, v4, 2, v7
    v_mfma_f32_16x16x32_bf16 v[144:147], v[80:83], a[16:19], v[144:147]
    s_waitcnt lgkmcnt(6)
    ds_read_b64_tr_b16 v[72:73], v9 offset:32768
    ds_read_b64_tr_b16 v[74:75], v9 offset:33280
    v_mfma_f32_16x16x32_bf16 v[144:147], v[84:87], a[24:27], v[144:147]
    buffer_load_dwordx4 v21, s[12:15], s0 offen offset:1024 lds
    v_add_u32 v5, 16, v6
    v_cndmask_b32 v7, v5, v7, s[78:79]
    v_cndmask_b32 v4, 4, 24, s[78:79]
    v_mfma_f32_16x16x32_bf16 v[152:155], v[84:87], a[28:31], v[152:155]
    s_waitcnt lgkmcnt(6)
    ds_read_b64_tr_b16 v[76:77], v9 offset:40960
    ds_read_b64_tr_b16 v[78:79], v9 offset:41472
    v_mfma_f32_16x16x32_bf16 v[152:155], v[80:83], a[20:23], v[152:155]
    v_cvt_pk_bf16_f32 v201, v114, v115
    v_cvt_pk_bf16_f32 v202, v116, v117
    v_mul_u32_u24 v5, 640, v2
    v_cmp_gt_u32 s[78:79], 24, v3
    v_lshl_add_u32 v6, v7, 4, v5
    v_mfma_f32_16x16x32_bf16 v[156:159], v[88:91], a[20:23], v[156:159]
    s_add_u32 m0, s44, 16384
    ds_read_b64_tr_b16 v[80:81], v10 offset:32768
    ds_read_b64_tr_b16 v[82:83], v10 offset:33280
    v_mfma_f32_16x16x32_bf16 v[156:159], v[92:95], a[28:31], v[156:159]
    buffer_load_dwordx4 v20, s[12:15], s1 offen offset:0 lds
    v_lshl_add_u32 v7, v4, 4, v6
    v_mov_b32 v5, 1280
    v_cndmask_b32 v5, 0, v5, s[78:79]
    v_mfma_f32_16x16x32_bf16 v[148:151], v[92:95], a[24:27], v[148:151]
    s_waitcnt lgkmcnt(6)
    ds_read_b64_tr_b16 v[84:85], v10 offset:40960
    ds_read_b64_tr_b16 v[86:87], v10 offset:41472
    v_mfma_f32_16x16x32_bf16 v[148:151], v[88:91], a[16:19], v[148:151]
    v_cvt_pk_bf16_f32 v203, v118, v119
    v_cvt_pk_bf16_f32 v204, v120, v121
    s_add_u32 s80, s5, 0
    s_lshr_b32 s81, s80, 1
    s_mul_i32 s81, s81, 5136
    v_mfma_f32_16x16x32_bf16 v[128:131], v[64:67], a[32:35], v[128:131]
    s_waitcnt lgkmcnt(6)
    ds_read_b64_tr_b16 v[88:89], v11 offset:32768
    ds_read_b64_tr_b16 v[90:91], v11 offset:33280
    v_mfma_f32_16x16x32_bf16 v[128:131], v[68:71], a[40:43], v[128:131]
    buffer_load_dwordx4 v21, s[12:15], s1 offen offset:1024 lds
    s_and_b32 s80, s80, 1
    s_mul_i32 s80, s80, 2560
    s_add_u32 s80, s80, s81
    s_add_u32 s81, s81, 5120
    v_mfma_f32_16x16x32_bf16 v[136:139], v[68:71], a[44:47], v[136:139]
    s_waitcnt lgkmcnt(6)
    ds_read_b64_tr_b16 v[92:93], v11 offset:40960
    ds_read_b64_tr_b16 v[94:95], v11 offset:41472
    v_mfma_f32_16x16x32_bf16 v[136:139], v[64:67], a[36:39], v[136:139]
    buffer_store_dwordx4 v[200:203], v243, s[20:23], s49 offen sc1
    v_mov_b32 v0, s81
    v_add_u32 v4, s80, v6
    v_cndmask_b32 v224, v0, v4, s[78:79]
    v_mfma_f32_16x16x32_bf16 v[140:143], v[72:75], a[36:39], v[140:143]
    s_waitcnt lgkmcnt(6)
    ds_read_b64_tr_b16 v[64:65], v8 offset:34816
    ds_read_b64_tr_b16 v[66:67], v8 offset:35328
    v_mfma_f32_16x16x32_bf16 v[140:143], v[76:79], a[44:47], v[140:143]
    v_cvt_pk_bf16_f32 v205, v122, v123
    v_cvt_pk_bf16_f32 v206, v124, v125
    v_add_u32 v225, v5, v224
    v_add_u32 v4, s80, v7
    v_cndmask_b32 v228, v0, v4, s[78:79]
    v_mfma_f32_16x16x32_bf16 v[132:135], v[76:79], a[40:43], v[132:135]
    s_waitcnt lgkmcnt(6)
    ds_read_b64_tr_b16 v[68:69], v8 offset:43008
    ds_read_b64_tr_b16 v[70:71], v8 offset:43520
    v_mfma_f32_16x16x32_bf16 v[132:135], v[72:75], a[32:35], v[132:135]
    s_mul_i32 s93, s93, 1728
    v_cvt_pk_bf16_f32 v207, v126, v127
    v_add_u32 v229, v5, v228
    s_add_u32 s80, s5, 1
    s_lshr_b32 s81, s80, 1
    v_mfma_f32_16x16x32_bf16 v[144:147], v[80:83], a[32:35], v[144:147]
    s_add_u32 m0, s44, 98304
    ds_read_b64_tr_b16 v[72:73], v9 offset:34816
    ds_read_b64_tr_b16 v[74:75], v9 offset:35328
    v_mfma_f32_16x16x32_bf16 v[144:147], v[84:87], a[40:43], v[144:147]
    buffer_load_dwordx4 v22, s[16:19], s93 offen offset:0 lds
    s_mul_i32 s81, s81, 5136
    s_and_b32 s80, s80, 1
    s_mul_i32 s80, s80, 2560
    v_mfma_f32_16x16x32_bf16 v[152:155], v[84:87], a[44:47], v[152:155]
    s_waitcnt lgkmcnt(6)
    ds_read_b64_tr_b16 v[76:77], v9 offset:43008
    ds_read_b64_tr_b16 v[78:79], v9 offset:43520
    v_mfma_f32_16x16x32_bf16 v[152:155], v[80:83], a[36:39], v[152:155]
    buffer_store_dwordx4 v[204:207], v254, s[20:23], s50 offen sc1
    s_add_u32 s80, s80, s81
    s_add_u32 s81, s81, 5120
    v_mov_b32 v0, s81
    v_mfma_f32_16x16x32_bf16 v[156:159], v[88:91], a[36:39], v[156:159]
    s_waitcnt lgkmcnt(6)
    ds_read_b64_tr_b16 v[80:81], v10 offset:34816
    ds_read_b64_tr_b16 v[82:83], v10 offset:35328
    v_mfma_f32_16x16x32_bf16 v[156:159], v[92:95], a[44:47], v[156:159]
    buffer_load_dwordx4 v23, s[16:19], s93 offen offset:1024 lds
    v_add_u32 v4, s80, v6
    v_cndmask_b32 v226, v0, v4, s[78:79]
    v_add_u32 v227, v5, v226
    v_add_u32 v4, s80, v7
    v_mfma_f32_16x16x32_bf16 v[148:151], v[92:95], a[40:43], v[148:151]
    s_waitcnt lgkmcnt(6)
    ds_read_b64_tr_b16 v[84:85], v10 offset:43008
    ds_read_b64_tr_b16 v[86:87], v10 offset:43520
    v_mfma_f32_16x16x32_bf16 v[148:151], v[88:91], a[32:35], v[148:151]
    v_cmp_gt_u32 vcc, 16, v1
    s_nop 1
    v_cndmask_b32 v252, v248, v244, vcc
    v_cndmask_b32 v230, v0, v4, s[78:79]
    v_add_u32 v231, v5, v230
    v_lshlrev_b32 v4, 2, v2
    v_mfma_f32_16x16x32_bf16 v[128:131], v[64:67], a[48:51], v[128:131]
    s_waitcnt lgkmcnt(6)
    ds_read_b64_tr_b16 v[88:89], v11 offset:34816
    ds_read_b64_tr_b16 v[90:91], v11 offset:35328
    v_mfma_f32_16x16x32_bf16 v[128:131], v[68:71], a[56:59], v[128:131]
    v_mul_f32 v252, 0xbfb8aa3b, v252
    v_add_u32 v30, 8, v238
    v_sub_u32 v4, v3, v4
    v_mov_b32 v5, 0xf1800000
    v_cmp_le_i32 s[78:79], 0, v4
    v_mfma_f32_16x16x32_bf16 v[136:139], v[68:71], a[60:63], v[136:139]
    s_waitcnt lgkmcnt(6)
    ds_read_b64_tr_b16 v[92:93], v11 offset:43008
    ds_read_b64_tr_b16 v[94:95], v11 offset:43520
    v_mfma_f32_16x16x32_bf16 v[136:139], v[64:67], a[52:55], v[136:139]
    s_waitcnt vmcnt(16)
    s_barrier
    v_cmp_le_i32 s[80:81], 1, v4
    v_cndmask_b32 v160, 0, v5, s[78:79]
    v_cndmask_b32 v176, v5, 0, s[78:79]
    v_mfma_f32_16x16x32_bf16 v[140:143], v[72:75], a[52:55], v[140:143]
    s_add_u32 m0, s44, 18432
    ds_read_b64_tr_b16 v[64:65], v8 offset:49152
    ds_read_b64_tr_b16 v[66:67], v8 offset:49664
    v_mfma_f32_16x16x32_bf16 v[140:143], v[76:79], a[60:63], v[140:143]
    buffer_load_dwordx4 v20, s[12:15], s40 offen offset:0 lds
    v_cmp_le_i32 s[78:79], 2, v4
    v_cndmask_b32 v161, 0, v5, s[80:81]
    v_cndmask_b32 v177, v5, 0, s[80:81]
    v_mfma_f32_16x16x32_bf16 v[132:135], v[76:79], a[56:59], v[132:135]
    s_waitcnt lgkmcnt(6)
    ds_read_b64_tr_b16 v[68:69], v8 offset:57344
    ds_read_b64_tr_b16 v[70:71], v8 offset:57856
    v_mfma_f32_16x16x32_bf16 v[132:135], v[72:75], a[48:51], v[132:135]
    v_exp_f32 v252, v252
    v_cmp_le_i32 s[80:81], 3, v4
    v_cndmask_b32 v162, 0, v5, s[78:79]
    v_cndmask_b32 v178, v5, 0, s[78:79]
    v_mfma_f32_16x16x32_bf16 v[144:147], v[80:83], a[48:51], v[144:147]
    s_waitcnt lgkmcnt(6)
    ds_read_b64_tr_b16 v[72:73], v9 offset:49152
    ds_read_b64_tr_b16 v[74:75], v9 offset:49664
    v_mfma_f32_16x16x32_bf16 v[144:147], v[84:87], a[56:59], v[144:147]
    buffer_load_dwordx4 v21, s[12:15], s40 offen offset:1024 lds
    v_cmp_le_i32 s[78:79], 8, v4
    v_cndmask_b32 v163, 0, v5, s[80:81]
    v_cndmask_b32 v179, v5, 0, s[80:81]
    v_cmp_le_i32 s[80:81], 9, v4
    v_mfma_f32_16x16x32_bf16 v[152:155], v[84:87], a[60:63], v[152:155]
    s_waitcnt lgkmcnt(6)
    ds_read_b64_tr_b16 v[76:77], v9 offset:57344
    ds_read_b64_tr_b16 v[78:79], v9 offset:57856
    v_mfma_f32_16x16x32_bf16 v[152:155], v[80:83], a[52:55], v[152:155]
    s_mul_i32 s100, s100, 1728
    v_add_f32 v252, 1.0, v252
    v_cndmask_b32 v164, 0, v5, s[78:79]
    v_cndmask_b32 v180, v5, 0, s[78:79]
    v_cmp_le_i32 s[78:79], 10, v4
    v_mfma_f32_16x16x32_bf16 v[156:159], v[88:91], a[52:55], v[156:159]
    s_add_u32 m0, s44, 100352
    ds_read_b64_tr_b16 v[80:81], v10 offset:49152
    ds_read_b64_tr_b16 v[82:83], v10 offset:49664
    v_mfma_f32_16x16x32_bf16 v[156:159], v[92:95], a[60:63], v[156:159]
    buffer_load_dwordx4 v22, s[16:19], s100 offen offset:0 lds
    v_cndmask_b32 v165, 0, v5, s[80:81]
    v_cndmask_b32 v181, v5, 0, s[80:81]
    v_cmp_le_i32 s[80:81], 11, v4
    v_mfma_f32_16x16x32_bf16 v[148:151], v[92:95], a[56:59], v[148:151]
    s_waitcnt lgkmcnt(6)
    ds_read_b64_tr_b16 v[84:85], v10 offset:57344
    ds_read_b64_tr_b16 v[86:87], v10 offset:57856
    v_mfma_f32_16x16x32_bf16 v[148:151], v[88:91], a[48:51], v[148:151]
    v_rcp_f32 v252, v252
    v_cndmask_b32 v166, 0, v5, s[78:79]
    v_cndmask_b32 v182, v5, 0, s[78:79]
    v_cmp_le_i32 s[78:79], 16, v4
    v_mfma_f32_16x16x32_bf16 v[128:131], v[64:67], a[64:67], v[128:131]
    s_waitcnt lgkmcnt(6)
    ds_read_b64_tr_b16 v[88:89], v11 offset:49152
    ds_read_b64_tr_b16 v[90:91], v11 offset:49664
    v_mfma_f32_16x16x32_bf16 v[128:131], v[68:71], a[72:75], v[128:131]
    buffer_load_dwordx4 v23, s[16:19], s100 offen offset:1024 lds
    v_cndmask_b32 v167, 0, v5, s[80:81]
    v_cndmask_b32 v183, v5, 0, s[80:81]
    v_cmp_le_i32 s[80:81], 17, v4
    v_mfma_f32_16x16x32_bf16 v[136:139], v[68:71], a[76:79], v[136:139]
    s_waitcnt lgkmcnt(6)
    ds_read_b64_tr_b16 v[92:93], v11 offset:57344
    ds_read_b64_tr_b16 v[94:95], v11 offset:57856
    v_mfma_f32_16x16x32_bf16 v[136:139], v[64:67], a[68:71], v[136:139]
    buffer_store_dword v252, v32, s[20:23], 0 offen sc1
    v_cndmask_b32 v168, 0, v5, s[78:79]
    v_cndmask_b32 v184, v5, 0, s[78:79]
    v_cmp_le_i32 s[78:79], 18, v4
    v_mfma_f32_16x16x32_bf16 v[140:143], v[72:75], a[68:71], v[140:143]
    s_waitcnt lgkmcnt(6)
    ds_read_b64_tr_b16 v[64:65], v8 offset:51200
    ds_read_b64_tr_b16 v[66:67], v8 offset:51712
    v_mfma_f32_16x16x32_bf16 v[140:143], v[76:79], a[76:79], v[140:143]
    v_mul_u32_u24 v255, 205, v30
    v_lshl_add_u32 v30, v30, 7, v239
    v_cndmask_b32 v169, 0, v5, s[80:81]
    v_cndmask_b32 v185, v5, 0, s[80:81]
    v_cmp_le_i32 s[80:81], 19, v4
L_pad1:
    s_cmp_eq_u32 s92, 1
    s_cbranch_scc1 L_pad5
    v_cndmask_b32 v170, 0, v5, s[78:79]
    v_mfma_f32_16x16x32_bf16 v[132:135], v[76:79], a[72:75], v[132:135]
    s_waitcnt lgkmcnt(6)
    ds_read_b64_tr_b16 v[68:69], v8 offset:59392
    ds_read_b64_tr_b16 v[70:71], v8 offset:59904
    v_mfma_f32_16x16x32_bf16 v[132:135], v[72:75], a[64:67], v[132:135]
    v_lshrrev_b32 v255, 10, v255
    v_mad_u32_u24 v30, v255, s64, v30
    v_cndmask_b32 v186, v5, 0, s[78:79]
    v_cmp_le_i32 s[78:79], 24, v4
    v_cndmask_b32 v171, 0, v5, s[80:81]
    v_mfma_f32_16x16x32_bf16 v[144:147], v[80:83], a[64:67], v[144:147]
    s_waitcnt lgkmcnt(6)
    ds_read_b64_tr_b16 v[72:73], v9 offset:51200
    ds_read_b64_tr_b16 v[74:75], v9 offset:51712
    v_mfma_f32_16x16x32_bf16 v[144:147], v[84:87], a[72:75], v[144:147]
    v_add3_u32 v240, v238, s53, 8
    v_mul_u32_u24 v255, 205, v240
    v_cndmask_b32 v187, v5, 0, s[80:81]
    v_cmp_le_i32 s[80:81], 25, v4
    v_cndmask_b32 v172, 0, v5, s[78:79]
    v_mfma_f32_16x16x32_bf16 v[152:155], v[84:87], a[76:79], v[152:155]
    s_waitcnt lgkmcnt(6)
    ds_read_b64_tr_b16 v[76:77], v9 offset:59392
    ds_read_b64_tr_b16 v[78:79], v9 offset:59904
    v_mfma_f32_16x16x32_bf16 v[152:155], v[80:83], a[68:71], v[152:155]
    v_lshl_add_u32 v240, v240, 7, v239
    v_lshrrev_b32 v255, 10, v255
    v_cndmask_b32 v188, v5, 0, s[78:79]
    v_cmp_le_i32 s[78:79], 26, v4
    v_cndmask_b32 v173, 0, v5, s[80:81]
    v_mfma_f32_16x16x32_bf16 v[156:159], v[88:91], a[68:71], v[156:159]
    s_waitcnt lgkmcnt(6)
    ds_read_b64_tr_b16 v[80:81], v10 offset:51200
    ds_read_b64_tr_b16 v[82:83], v10 offset:51712
    v_mfma_f32_16x16x32_bf16 v[156:159], v[92:95], a[76:79], v[156:159]
    v_mad_u32_u24 v240, v255, s64, v240
    v_add_u32 v243, 12, v238
    v_cndmask_b32 v189, v5, 0, s[80:81]
    v_cmp_le_i32 s[80:81], 27, v4
    v_cndmask_b32 v174, 0, v5, s[78:79]
    v_mfma_f32_16x16x32_bf16 v[148:151], v[92:95], a[72:75], v[148:151]
    s_waitcnt lgkmcnt(6)
    ds_read_b64_tr_b16 v[84:85], v10 offset:59392
    ds_read_b64_tr_b16 v[86:87], v10 offset:59904
    v_mfma_f32_16x16x32_bf16 v[148:151], v[88:91], a[64:67], v[148:151]
    s_mul_i32 s101, s101, 1728
    v_mul_u32_u24 v255, 205, v243
    v_cndmask_b32 v190, v5, 0, s[78:79]
    v_cndmask_b32 v175, 0, v5, s[80:81]
    v_cndmask_b32 v191, v5, 0, s[80:81]
    v_mfma_f32_16x16x32_bf16 v[128:131], v[64:67], a[80:83], v[128:131]
    s_add_u32 m0, s44, 114688
    ds_read_b64_tr_b16 v[88:89], v11 offset:51200
    ds_read_b64_tr_b16 v[90:91], v11 offset:51712
    v_mfma_f32_16x16x32_bf16 v[128:131], v[68:71], a[88:91], v[128:131]
    buffer_load_dwordx4 v22, s[16:19], s101 offen offset:0 lds
    v_mfma_f32_16x16x32_bf16 v[136:139], v[68:71], a[92:95], v[136:139]
    s_waitcnt lgkmcnt(6)
    ds_read_b64_tr_b16 v[92:93], v11 offset:59392
    ds_read_b64_tr_b16 v[94:95], v11 offset:59904
    v_mfma_f32_16x16x32_bf16 v[136:139], v[64:67], a[84:87], v[136:139]
    s_waitcnt vmcnt(12)
    s_barrier
    v_lshl_add_u32 v243, v243, 7, v239
    v_mfma_f32_16x16x32_bf16 v[140:143], v[72:75], a[84:87], v[140:143]
    s_waitcnt lgkmcnt(6)
    ds_read_b64_tr_b16 v[64:65], v8 offset:0
    ds_read_b64_tr_b16 v[66:67], v8 offset:512
    v_mfma_f32_16x16x32_bf16 v[140:143], v[76:79], a[92:95], v[140:143]
    buffer_load_dwordx4 v23, s[16:19], s101 offen offset:1024 lds
    v_mfma_f32_16x16x32_bf16 v[132:135], v[76:79], a[88:91], v[132:135]
    s_waitcnt lgkmcnt(6)
    ds_read_b64_tr_b16 v[68:69], v8 offset:8192
    ds_read_b64_tr_b16 v[70:71], v8 offset:8704
    v_mfma_f32_16x16x32_bf16 v[132:135], v[72:75], a[80:83], v[132:135]
    s_mul_i32 s41, s41, 1728
    v_lshrrev_b32 v255, 10, v255
    v_mfma_f32_16x16x32_bf16 v[144:147], v[80:83], a[80:83], v[144:147]
    s_add_u32 m0, s44, 116736
    ds_read_b64_tr_b16 v[72:73], v9 offset:0
    ds_read_b64_tr_b16 v[74:75], v9 offset:512
    v_mfma_f32_16x16x32_bf16 v[144:147], v[84:87], a[88:91], v[144:147]
    buffer_load_dwordx4 v22, s[16:19], s41 offen offset:0 lds
    v_mfma_f32_16x16x32_bf16 v[152:155], v[84:87], a[92:95], v[152:155]
    s_waitcnt lgkmcnt(6)
    ds_read_b64_tr_b16 v[76:77], v9 offset:8192
    ds_read_b64_tr_b16 v[78:79], v9 offset:8704
    v_mfma_f32_16x16x32_bf16 v[152:155], v[80:83], a[84:87], v[152:155]
    v_mad_u32_u24 v243, v255, s64, v243
    v_add3_u32 v254, v238, s53, 12
    v_mfma_f32_16x16x32_bf16 v[156:159], v[88:91], a[84:87], v[156:159]
    s_waitcnt lgkmcnt(6)
    ds_read_b64_tr_b16 v[80:81], v10 offset:0
    ds_read_b64_tr_b16 v[82:83], v10 offset:512
    v_mfma_f32_16x16x32_bf16 v[156:159], v[92:95], a[92:95], v[156:159]
    buffer_load_dwordx4 v23, s[16:19], s41 offen offset:1024 lds
    v_mfma_f32_16x16x32_bf16 v[148:151], v[92:95], a[88:91], v[148:151]
    s_waitcnt lgkmcnt(6)
    ds_read_b64_tr_b16 v[84:85], v10 offset:8192
    ds_read_b64_tr_b16 v[86:87], v10 offset:8704
    v_mfma_f32_16x16x32_bf16 v[148:151], v[88:91], a[80:83], v[148:151]
    v_mul_u32_u24 v255, 205, v254
    v_lshl_add_u32 v254, v254, 7, v239
    v_mfma_f32_16x16x32_bf16 v[128:131], v[64:67], a[96:99], v[128:131]
    s_waitcnt lgkmcnt(6)
    ds_read_b64_tr_b16 v[88:89], v11 offset:0
    ds_read_b64_tr_b16 v[90:91], v11 offset:512
    v_mfma_f32_16x16x32_bf16 v[128:131], v[68:71], a[104:107], v[128:131]
    v_lshrrev_b32 v255, 10, v255
    v_mad_u32_u24 v254, v255, s64, v254
    v_mfma_f32_16x16x32_bf16 v[136:139], v[68:71], a[108:111], v[136:139]
    s_waitcnt lgkmcnt(6)
    ds_read_b64_tr_b16 v[92:93], v11 offset:8192
    ds_read_b64_tr_b16 v[94:95], v11 offset:8704
    v_mfma_f32_16x16x32_bf16 v[136:139], v[64:67], a[100:103], v[136:139]
    v_mfma_f32_16x16x32_bf16 v[140:143], v[72:75], a[100:103], v[140:143]
    s_add_u32 m0, s44, 32768
    ds_read_b64_tr_b16 v[64:65], v8 offset:2048
    ds_read_b64_tr_b16 v[66:67], v8 offset:2560
    v_mfma_f32_16x16x32_bf16 v[140:143], v[76:79], a[108:111], v[140:143]
    buffer_load_dwordx4 v35, s[24:27], s69 offen offset:0 lds
    v_mfma_f32_16x16x32_bf16 v[132:135], v[76:79], a[104:107], v[132:135]
    s_waitcnt lgkmcnt(6)
    ds_read_b64_tr_b16 v[68:69], v8 offset:10240
    ds_read_b64_tr_b16 v[70:71], v8 offset:10752
    v_mfma_f32_16x16x32_bf16 v[132:135], v[72:75], a[96:99], v[132:135]
    v_mfma_f32_16x16x32_bf16 v[144:147], v[80:83], a[96:99], v[144:147]
    s_waitcnt lgkmcnt(6)
    ds_read_b64_tr_b16 v[72:73], v9 offset:2048
    ds_read_b64_tr_b16 v[74:75], v9 offset:2560
    v_mfma_f32_16x16x32_bf16 v[144:147], v[84:87], a[104:107], v[144:147]
    buffer_load_dwordx4 v36, s[24:27], s69 offen offset:1024 lds
    v_mfma_f32_16x16x32_bf16 v[152:155], v[84:87], a[108:111], v[152:155]
    s_waitcnt lgkmcnt(6)
    ds_read_b64_tr_b16 v[76:77], v9 offset:10240
    ds_read_b64_tr_b16 v[78:79], v9 offset:10752
    v_mfma_f32_16x16x32_bf16 v[152:155], v[80:83], a[100:103], v[152:155]
    v_mfma_f32_16x16x32_bf16 v[156:159], v[88:91], a[100:103], v[156:159]
    s_waitcnt lgkmcnt(6)
    ds_read_b64_tr_b16 v[80:81], v10 offset:2048
    ds_read_b64_tr_b16 v[82:83], v10 offset:2560
    v_mfma_f32_16x16x32_bf16 v[156:159], v[92:95], a[108:111], v[156:159]
    buffer_load_dwordx4 v37, s[24:27], s69 offen offset:2048 lds
    v_mfma_f32_16x16x32_bf16 v[148:151], v[92:95], a[104:107], v[148:151]
    s_waitcnt lgkmcnt(6)
    ds_read_b64_tr_b16 v[84:85], v10 offset:10240
    ds_read_b64_tr_b16 v[86:87], v10 offset:10752
    v_mfma_f32_16x16x32_bf16 v[148:151], v[88:91], a[96:99], v[148:151]
    v_mfma_f32_16x16x32_bf16 v[128:131], v[64:67], a[112:115], v[128:131]
    s_waitcnt lgkmcnt(6)
    ds_read_b64_tr_b16 v[88:89], v11 offset:2048
    ds_read_b64_tr_b16 v[90:91], v11 offset:2560
    v_mfma_f32_16x16x32_bf16 v[128:131], v[68:71], a[120:123], v[128:131]
    buffer_load_dwordx4 v38, s[24:27], s69 offen offset:3072 lds
    v_mfma_f32_16x16x32_bf16 v[136:139], v[68:71], a[124:127], v[136:139]
    s_waitcnt lgkmcnt(6)
    ds_read_b64_tr_b16 v[92:93], v11 offset:10240
    ds_read_b64_tr_b16 v[94:95], v11 offset:10752
    v_mfma_f32_16x16x32_bf16 v[136:139], v[64:67], a[116:119], v[136:139]
    s_waitcnt vmcnt(11)
    s_barrier
    s_add_u32 s69, s69, 40960
    v_mfma_f32_16x16x32_bf16 v[140:143], v[72:75], a[116:119], v[140:143]
    s_waitcnt lgkmcnt(6)
    ds_read_b64_tr_b16 v[64:65], v8 offset:16384
    ds_read_b64_tr_b16 v[66:67], v8 offset:16896
    v_mfma_f32_16x16x32_bf16 v[140:143], v[76:79], a[124:127], v[140:143]
    v_mfma_f32_16x16x32_bf16 v[132:135], v[76:79], a[120:123], v[132:135]
    s_waitcnt lgkmcnt(6)
    ds_read_b64_tr_b16 v[68:69], v8 offset:24576
    ds_read_b64_tr_b16 v[70:71], v8 offset:25088
    v_mfma_f32_16x16x32_bf16 v[132:135], v[72:75], a[112:115], v[132:135]
    s_mul_i32 s42, s42, 1728
    v_mfma_f32_16x16x32_bf16 v[144:147], v[80:83], a[112:115], v[144:147]
    s_add_u32 m0, s44, 65536
    ds_read_b64_tr_b16 v[72:73], v9 offset:16384
    ds_read_b64_tr_b16 v[74:75], v9 offset:16896
    v_mfma_f32_16x16x32_bf16 v[144:147], v[84:87], a[120:123], v[144:147]
    buffer_load_dwordx4 v22, s[16:19], s42 offen offset:0 lds
    v_mfma_f32_16x16x32_bf16 v[152:155], v[84:87], a[124:127], v[152:155]
    s_waitcnt lgkmcnt(6)
    ds_read_b64_tr_b16 v[76:77], v9 offset:24576
    ds_read_b64_tr_b16 v[78:79], v9 offset:25088
    v_mfma_f32_16x16x32_bf16 v[152:155], v[80:83], a[116:119], v[152:155]
    v_mfma_f32_16x16x32_bf16 v[156:159], v[88:91], a[116:119], v[156:159]
    s_waitcnt lgkmcnt(6)
    ds_read_b64_tr_b16 v[80:81], v8 offset:18432
    ds_read_b64_tr_b16 v[82:83], v8 offset:18944
    v_mfma_f32_16x16x32_bf16 v[156:159], v[92:95], a[124:127], v[156:159]
    buffer_load_dwordx4 v23, s[16:19], s42 offen offset:1024 lds
    v_mfma_f32_16x16x32_bf16 v[148:151], v[92:95], a[120:123], v[148:151]
    s_waitcnt lgkmcnt(6)
    ds_read_b64_tr_b16 v[84:85], v8 offset:26624
    ds_read_b64_tr_b16 v[86:87], v8 offset:27136
    v_mfma_f32_16x16x32_bf16 v[148:151], v[88:91], a[112:115], v[148:151]
    s_mul_i32 s43, s43, 1728
    v_mfma_f32_16x16x32_bf16 v[128:131], v[64:67], a[128:131], v[128:131]
    s_add_u32 m0, s44, 67584
    ds_read_b64_tr_b16 v[88:89], v9 offset:18432
    ds_read_b64_tr_b16 v[90:91], v9 offset:18944
    v_mfma_f32_16x16x32_bf16 v[128:131], v[68:71], a[136:139], v[128:131]
    buffer_load_dwordx4 v22, s[16:19], s43 offen offset:0 lds
    v_mfma_f32_16x16x32_bf16 v[136:139], v[68:71], a[140:143], v[136:139]
    s_waitcnt lgkmcnt(6)
    ds_read_b64_tr_b16 v[92:93], v9 offset:26624
    ds_read_b64_tr_b16 v[94:95], v9 offset:27136
    v_mfma_f32_16x16x32_bf16 v[136:139], v[64:67], a[132:135], v[136:139]
    v_mfma_f32_16x16x32_bf16 v[140:143], v[72:75], a[132:135], v[140:143]
    s_waitcnt lgkmcnt(6)
    ds_read_b64_tr_b16 v[64:65], v10 offset:16384
    ds_read_b64_tr_b16 v[66:67], v10 offset:16896
    v_mfma_f32_16x16x32_bf16 v[140:143], v[76:79], a[140:143], v[140:143]
    buffer_load_dwordx4 v23, s[16:19], s43 offen offset:1024 lds
    v_mfma_f32_16x16x32_bf16 v[132:135], v[76:79], a[136:139], v[132:135]
    s_waitcnt lgkmcnt(6)
    ds_read_b64_tr_b16 v[68:69], v10 offset:24576
    ds_read_b64_tr_b16 v[70:71], v10 offset:25088
    v_mfma_f32_16x16x32_bf16 v[132:135], v[72:75], a[128:131], v[132:135]
    v_mfma_f32_16x16x32_bf16 v[128:131], v[80:83], a[144:147], v[128:131]
    s_waitcnt lgkmcnt(6)
    ds_read_b64_tr_b16 v[72:73], v11 offset:16384
    ds_read_b64_tr_b16 v[74:75], v11 offset:16896
    v_mfma_f32_16x16x32_bf16 v[128:131], v[84:87], a[152:155], v[128:131]
    v_mfma_f32_16x16x32_bf16 v[136:139], v[84:87], a[156:159], v[136:139]
    s_waitcnt lgkmcnt(6)
    ds_read_b64_tr_b16 v[76:77], v11 offset:24576
    ds_read_b64_tr_b16 v[78:79], v11 offset:25088
    v_mfma_f32_16x16x32_bf16 v[136:139], v[80:83], a[148:151], v[136:139]
    v_mfma_f32_16x16x32_bf16 v[140:143], v[88:91], a[148:151], v[140:143]
    s_add_u32 m0, s44, 49152
    ds_read_b64_tr_b16 v[80:81], v10 offset:18432
    ds_read_b64_tr_b16 v[82:83], v10 offset:18944
    v_mfma_f32_16x16x32_bf16 v[140:143], v[92:95], a[156:159], v[140:143]
    buffer_load_dwordx4 v35, s[24:27], s69 offen offset:0 lds
    v_mfma_f32_16x16x32_bf16 v[132:135], v[92:95], a[152:155], v[132:135]
    s_waitcnt lgkmcnt(6)
    ds_read_b64_tr_b16 v[84:85], v10 offset:26624
    ds_read_b64_tr_b16 v[86:87], v10 offset:27136
    v_mfma_f32_16x16x32_bf16 v[132:135], v[88:91], a[144:147], v[132:135]
    v_mfma_f32_16x16x32_bf16 v[144:147], v[64:67], a[128:131], v[144:147]
    s_waitcnt lgkmcnt(6)
    ds_read_b64_tr_b16 v[88:89], v11 offset:18432
    ds_read_b64_tr_b16 v[90:91], v11 offset:18944
    v_mfma_f32_16x16x32_bf16 v[144:147], v[68:71], a[136:139], v[144:147]
    buffer_load_dwordx4 v36, s[24:27], s69 offen offset:1024 lds
    v_mfma_f32_16x16x32_bf16 v[152:155], v[68:71], a[140:143], v[152:155]
    s_waitcnt lgkmcnt(6)
    ds_read_b64_tr_b16 v[92:93], v11 offset:26624
    ds_read_b64_tr_b16 v[94:95], v11 offset:27136
    v_mfma_f32_16x16x32_bf16 v[152:155], v[64:67], a[132:135], v[152:155]
    s_barrier
    v_cvt_pk_bf16_f32 v192, v128, v129
    v_mfma_f32_16x16x32_bf16 v[156:159], v[72:75], a[132:135], v[156:159]
    s_waitcnt lgkmcnt(6)
    ds_read_b64_tr_b16 v[64:65], v16 offset:0
    ds_read_b64_tr_b16 v[66:67], v16 offset:512
    v_mfma_f32_16x16x32_bf16 v[156:159], v[76:79], a[140:143], v[156:159]
    buffer_load_dwordx4 v37, s[24:27], s69 offen offset:2048 lds
    v_mfma_f32_16x16x32_bf16 v[148:151], v[76:79], a[136:139], v[148:151]
    s_waitcnt lgkmcnt(6)
    ds_read_b64_tr_b16 v[68:69], v16 offset:8192
    ds_read_b64_tr_b16 v[70:71], v16 offset:8704
    v_mfma_f32_16x16x32_bf16 v[148:151], v[72:75], a[128:131], v[148:151]
    v_cvt_pk_bf16_f32 v193, v130, v131
    v_cvt_pk_bf16_f32 v194, v132, v133
    v_mfma_f32_16x16x32_bf16 v[144:147], v[80:83], a[144:147], v[144:147]
    s_waitcnt lgkmcnt(6)
    ds_read_b64_tr_b16 v[72:73], v17 offset:0
    ds_read_b64_tr_b16 v[74:75], v17 offset:512
    v_mfma_f32_16x16x32_bf16 v[144:147], v[84:87], a[152:155], v[144:147]
    buffer_load_dwordx4 v38, s[24:27], s69 offen offset:3072 lds
    v_mfma_f32_16x16x32_bf16 v[152:155], v[84:87], a[156:159], v[152:155]
    s_waitcnt lgkmcnt(6)
    ds_read_b64_tr_b16 v[76:77], v17 offset:8192
    ds_read_b64_tr_b16 v[78:79], v17 offset:8704
    v_mfma_f32_16x16x32_bf16 v[152:155], v[80:83], a[148:151], v[152:155]
    s_add_u32 s69, s69, 40960
    v_cvt_pk_bf16_f32 v195, v134, v135
    v_cvt_pk_bf16_f32 v196, v136, v137
    v_mfma_f32_16x16x32_bf16 v[156:159], v[88:91], a[148:151], v[156:159]
    s_waitcnt lgkmcnt(6)
    ds_read_b64_tr_b16 v[80:81], v18 offset:0
    ds_read_b64_tr_b16 v[82:83], v18 offset:512
    v_mfma_f32_16x16x32_bf16 v[156:159], v[92:95], a[156:159], v[156:159]
    buffer_store_dwordx4 v[192:195], v30, s[20:23], s49 offen sc1
    v_mfma_f32_16x16x32_bf16 v[148:151], v[92:95], a[152:155], v[148:151]
    s_waitcnt lgkmcnt(6)
    ds_read_b64_tr_b16 v[84:85], v18 offset:8192
    ds_read_b64_tr_b16 v[86:87], v18 offset:8704
    v_mfma_f32_16x16x32_bf16 v[148:151], v[88:91], a[144:147], v[148:151]
    v_cvt_pk_bf16_f32 v197, v138, v139
    v_cvt_pk_bf16_f32 v198, v140, v141
L_partb_10:
    v_mfma_f32_16x16x32_bf16 v[96:99], v[64:67], a[0:3], 0
    s_waitcnt lgkmcnt(6)
    ds_read_b64_tr_b16 v[88:89], v19 offset:0
    ds_read_b64_tr_b16 v[90:91], v19 offset:512
    v_mfma_f32_16x16x32_bf16 v[96:99], v[68:71], a[8:11], v[96:99]
    v_cvt_pk_bf16_f32 v199, v142, v143
    v_cvt_pk_bf16_f32 v200, v144, v145
    v_mfma_f32_16x16x32_bf16 v[104:107], v[68:71], a[12:15], 0
    s_waitcnt lgkmcnt(6)
    ds_read_b64_tr_b16 v[92:93], v19 offset:8192
    ds_read_b64_tr_b16 v[94:95], v19 offset:8704
    v_mfma_f32_16x16x32_bf16 v[104:107], v[64:67], a[4:7], v[104:107]
    buffer_store_dwordx4 v[196:199], v240, s[20:23], s50 offen sc1
    v_mfma_f32_16x16x32_bf16 v[108:111], v[72:75], a[4:7], 0
    s_waitcnt lgkmcnt(6)
    ds_read_b64_tr_b16 v[64:65], v16 offset:2048
    ds_read_b64_tr_b16 v[66:67], v16 offset:2560
    v_mfma_f32_16x16x32_bf16 v[108:111], v[76:79], a[12:15], v[108:111]
    v_cvt_pk_bf16_f32 v201, v146, v147
    v_cvt_pk_bf16_f32 v202, v148, v149
    v_mfma_f32_16x16x32_bf16 v[100:103], v[76:79], a[8:11], 0
    s_waitcnt lgkmcnt(6)
    ds_read_b64_tr_b16 v[68:69], v16 offset:10240
    ds_read_b64_tr_b16 v[70:71], v16 offset:10752
    v_mfma_f32_16x16x32_bf16 v[100:103], v[72:75], a[0:3], v[100:103]
    v_cvt_pk_bf16_f32 v203, v150, v151
    v_cvt_pk_bf16_f32 v204, v152, v153
    v_mfma_f32_16x16x32_bf16 v[112:115], v[80:83], a[0:3], 0
    s_waitcnt lgkmcnt(6)
    ds_read_b64_tr_b16 v[72:73], v17 offset:2048
    ds_read_b64_tr_b16 v[74:75], v17 offset:2560
    v_mfma_f32_16x16x32_bf16 v[112:115], v[84:87], a[8:11], v[112:115]
    buffer_store_dwordx4 v[200:203], v243, s[20:23], s49 offen sc1
    v_mfma_f32_16x16x32_bf16 v[120:123], v[84:87], a[12:15], 0
    s_waitcnt lgkmcnt(6)
    ds_read_b64_tr_b16 v[76:77], v17 offset:10240
    ds_read_b64_tr_b16 v[78:79], v17 offset:10752
    v_mfma_f32_16x16x32_bf16 v[120:123], v[80:83], a[4:7], v[120:123]
    v_cvt_pk_bf16_f32 v205, v154, v155
    v_cvt_pk_bf16_f32 v206, v156, v157
    v_mfma_f32_16x16x32_bf16 v[124:127], v[88:91], a[4:7], 0
    s_waitcnt lgkmcnt(6)
    ds_read_b64_tr_b16 v[80:81], v18 offset:2048
    ds_read_b64_tr_b16 v[82:83], v18 offset:2560
    v_mfma_f32_16x16x32_bf16 v[124:127], v[92:95], a[12:15], v[124:127]
    v_cvt_pk_bf16_f32 v207, v158, v159
    v_mfma_f32_16x16x32_bf16 v[116:119], v[92:95], a[8:11], 0
    s_waitcnt lgkmcnt(6)
    ds_read_b64_tr_b16 v[84:85], v18 offset:10240
    ds_read_b64_tr_b16 v[86:87], v18 offset:10752
    v_mfma_f32_16x16x32_bf16 v[116:119], v[88:91], a[0:3], v[116:119]
    buffer_store_dwordx4 v[204:207], v254, s[20:23], s50 offen sc1
    v_mfma_f32_16x16x32_bf16 v[96:99], v[64:67], a[16:19], v[96:99]
    s_waitcnt lgkmcnt(6)
    ds_read_b64_tr_b16 v[88:89], v19 offset:2048
    ds_read_b64_tr_b16 v[90:91], v19 offset:2560
    v_mfma_f32_16x16x32_bf16 v[96:99], v[68:71], a[24:27], v[96:99]
    v_mfma_f32_16x16x32_bf16 v[104:107], v[68:71], a[28:31], v[104:107]
    s_waitcnt lgkmcnt(6)
    ds_read_b64_tr_b16 v[92:93], v19 offset:10240
    ds_read_b64_tr_b16 v[94:95], v19 offset:10752
    v_mfma_f32_16x16x32_bf16 v[104:107], v[64:67], a[20:23], v[104:107]
    s_waitcnt vmcnt(21)
    s_barrier
    v_mfma_f32_16x16x32_bf16 v[108:111], v[72:75], a[20:23], v[108:111]
    s_waitcnt lgkmcnt(6)
    ds_read_b64_tr_b16 v[64:65], v12 offset:32768
    ds_read_b64_tr_b16 v[66:67], v12 offset:33280
    v_mfma_f32_16x16x32_bf16 v[108:111], v[76:79], a[28:31], v[108:111]
    v_mfma_f32_16x16x32_bf16 v[100:103], v[76:79], a[24:27], v[100:103]
    s_waitcnt lgkmcnt(6)
    ds_read_b64_tr_b16 v[68:69], v12 offset:40960
    ds_read_b64_tr_b16 v[70:71], v12 offset:41472
    v_mfma_f32_16x16x32_bf16 v[100:103], v[72:75], a[16:19], v[100:103]
    s_mul_i32 s54, s54, 1728
    v_mfma_f32_16x16x32_bf16 v[112:115], v[80:83], a[16:19], v[112:115]
    s_add_u32 m0, s44, 81920
    ds_read_b64_tr_b16 v[72:73], v13 offset:32768
    ds_read_b64_tr_b16 v[74:75], v13 offset:33280
    v_mfma_f32_16x16x32_bf16 v[112:115], v[84:87], a[24:27], v[112:115]
    buffer_load_dwordx4 v22, s[16:19], s54 offen offset:0 lds
    v_mfma_f32_16x16x32_bf16 v[120:123], v[84:87], a[28:31], v[120:123]
    s_waitcnt lgkmcnt(6)
    ds_read_b64_tr_b16 v[76:77], v13 offset:40960
    ds_read_b64_tr_b16 v[78:79], v13 offset:41472
    v_mfma_f32_16x16x32_bf16 v[120:123], v[80:83], a[20:23], v[120:123]
    v_mfma_f32_16x16x32_bf16 v[124:127], v[88:91], a[20:23], v[124:127]
    s_waitcnt lgkmcnt(6)
    ds_read_b64_tr_b16 v[80:81], v14 offset:32768
    ds_read_b64_tr_b16 v[82:83], v14 offset:33280
    v_mfma_f32_16x16x32_bf16 v[124:127], v[92:95], a[28:31], v[124:127]
    buffer_load_dwordx4 v23, s[16:19], s54 offen offset:1024 lds
    v_mfma_f32_16x16x32_bf16 v[116:119], v[92:95], a[24:27], v[116:119]
    s_waitcnt lgkmcnt(6)
    ds_read_b64_tr_b16 v[84:85], v14 offset:40960
    ds_read_b64_tr_b16 v[86:87], v14 offset:41472
    v_mfma_f32_16x16x32_bf16 v[116:119], v[88:91], a[16:19], v[116:119]
    s_mul_i32 s55, s55, 1728
    v_mfma_f32_16x16x32_bf16 v[96:99], v[64:67], a[32:35], v[96:99]
    s_add_u32 m0, s44, 83968
    ds_read_b64_tr_b16 v[88:89], v15 offset:32768
    ds_read_b64_tr_b16 v[90:91], v15 offset:33280
    v_mfma_f32_16x16x32_bf16 v[96:99], v[68:71], a[40:43], v[96:99]
    buffer_load_dwordx4 v22, s[16:19], s55 offen offset:0 lds
    v_mfma_f32_16x16x32_bf16 v[104:107], v[68:71], a[44:47], v[104:107]
    s_waitcnt lgkmcnt(6)
    ds_read_b64_tr_b16 v[92:93], v15 offset:40960
    ds_read_b64_tr_b16 v[94:95], v15 offset:41472
    v_mfma_f32_16x16x32_bf16 v[104:107], v[64:67], a[36:39], v[104:107]
    s_waitcnt vmcnt(15)
    ds_read_b64_tr_b16 a[160:161], v24 offset:32768
    ds_read_b64_tr_b16 a[162:163], v24 offset:33280
    v_mfma_f32_16x16x32_bf16 v[108:111], v[72:75], a[36:39], v[108:111]
    s_waitcnt lgkmcnt(8)
    ds_read_b64_tr_b16 v[64:65], v12 offset:34816
    ds_read_b64_tr_b16 v[66:67], v12 offset:35328
    v_mfma_f32_16x16x32_bf16 v[108:111], v[76:79], a[44:47], v[108:111]
    buffer_load_dwordx4 v23, s[16:19], s55 offen offset:1024 lds
    v_mfma_f32_16x16x32_bf16 v[100:103], v[76:79], a[40:43], v[100:103]
    s_waitcnt lgkmcnt(8)
    ds_read_b64_tr_b16 v[68:69], v12 offset:43008
    ds_read_b64_tr_b16 v[70:71], v12 offset:43520
    v_mfma_f32_16x16x32_bf16 v[100:103], v[72:75], a[32:35], v[100:103]
    v_add_u32 v22, s52, v22
    v_add_u32 v23, s52, v23
    v_mfma_f32_16x16x32_bf16 v[112:115], v[80:83], a[32:35], v[112:115]
    s_add_u32 m0, s44, 0
    ds_read_b64_tr_b16 v[72:73], v13 offset:34816
    ds_read_b64_tr_b16 v[74:75], v13 offset:35328
    v_mfma_f32_16x16x32_bf16 v[112:115], v[84:87], a[40:43], v[112:115]
    buffer_load_dwordx4 v35, s[24:27], s69 offen offset:0 lds
    v_mfma_f32_16x16x32_bf16 v[120:123], v[84:87], a[44:47], v[120:123]
    s_waitcnt lgkmcnt(8)
    ds_read_b64_tr_b16 v[76:77], v13 offset:43008
    ds_read_b64_tr_b16 v[78:79], v13 offset:43520
    v_mfma_f32_16x16x32_bf16 v[120:123], v[80:83], a[36:39], v[120:123]
    s_nop 0
    ds_read_b64_tr_b16 a[164:165], v25 offset:32768
    ds_read_b64_tr_b16 a[166:167], v25 offset:33280
    v_mfma_f32_16x16x32_bf16 v[124:127], v[88:91], a[36:39], v[124:127]
    s_waitcnt lgkmcnt(8)
    ds_read_b64_tr_b16 v[80:81], v14 offset:34816
    ds_read_b64_tr_b16 v[82:83], v14 offset:35328
    v_mfma_f32_16x16x32_bf16 v[124:127], v[92:95], a[44:47], v[124:127]
    buffer_load_dwordx4 v36, s[24:27], s69 offen offset:1024 lds
    v_mfma_f32_16x16x32_bf16 v[116:119], v[92:95], a[40:43], v[116:119]
    s_waitcnt lgkmcnt(8)
    ds_read_b64_tr_b16 v[84:85], v14 offset:43008
    ds_read_b64_tr_b16 v[86:87], v14 offset:43520
    v_mfma_f32_16x16x32_bf16 v[116:119], v[88:91], a[32:35], v[116:119]
    s_nop 0
    ds_read_b64_tr_b16 a[168:169], v26 offset:32768
    ds_read_b64_tr_b16 a[170:171], v26 offset:33280
    v_mfma_f32_16x16x32_bf16 v[96:99], v[64:67], a[48:51], v[96:99]
    s_waitcnt lgkmcnt(10)
    ds_read_b64_tr_b16 v[88:89], v15 offset:34816
    ds_read_b64_tr_b16 v[90:91], v15 offset:35328
    v_mfma_f32_16x16x32_bf16 v[96:99], v[68:71], a[56:59], v[96:99]
    buffer_load_dwordx4 v37, s[24:27], s69 offen offset:2048 lds
    v_mfma_f32_16x16x32_bf16 v[104:107], v[68:71], a[60:63], v[104:107]
    s_waitcnt lgkmcnt(10)
    ds_read_b64_tr_b16 v[92:93], v15 offset:43008
    ds_read_b64_tr_b16 v[94:95], v15 offset:43520
    v_mfma_f32_16x16x32_bf16 v[104:107], v[64:67], a[52:55], v[104:107]
    s_waitcnt vmcnt(7)
    s_barrier
    ds_read_b64_tr_b16 a[172:173], v27 offset:32768
    v_mfma_f32_16x16x32_bf16 v[108:111], v[72:75], a[52:55], v[108:111]
    s_waitcnt lgkmcnt(9)
    ds_read_b64_tr_b16 v[64:65], v12 offset:49152
    ds_read_b64_tr_b16 v[66:67], v12 offset:49664
    v_mfma_f32_16x16x32_bf16 v[108:111], v[76:79], a[60:63], v[108:111]
    buffer_store_dword v53, v51, s[20:23], 0 offen offset:0 sc1
    buffer_load_dwordx4 v38, s[24:27], s69 offen offset:3072 lds
    v_mfma_f32_16x16x32_bf16 v[100:103], v[76:79], a[56:59], v[100:103]
    s_waitcnt lgkmcnt(9)
    ds_read_b64_tr_b16 v[68:69], v12 offset:57344
    ds_read_b64_tr_b16 v[70:71], v12 offset:57856
    v_mfma_f32_16x16x32_bf16 v[100:103], v[72:75], a[48:51], v[100:103]
    s_add_u32 s69, s69, 40960
    s_add_u32 m0, s44, 147456
    ds_read_b64_tr_b16 a[174:175], v27 offset:33280
    v_mfma_f32_16x16x32_bf16 v[112:115], v[80:83], a[48:51], v[112:115]
    s_waitcnt lgkmcnt(8)
    ds_read_b64_tr_b16 v[72:73], v13 offset:49152
    ds_read_b64_tr_b16 v[74:75], v13 offset:49664
    v_mfma_f32_16x16x32_bf16 v[112:115], v[84:87], a[56:59], v[112:115]
    buffer_load_dwordx4 v22, s[16:19], s46 offen offset:0 lds
    v_mfma_f32_16x16x32_bf16 v[120:123], v[84:87], a[60:63], v[120:123]
    s_waitcnt lgkmcnt(8)
    ds_read_b64_tr_b16 v[76:77], v13 offset:57344
    ds_read_b64_tr_b16 v[78:79], v13 offset:57856
    v_mfma_f32_16x16x32_bf16 v[120:123], v[80:83], a[52:55], v[120:123]
    ds_read_b64_tr_b16 a[176:177], v24 offset:49152
    ds_read_b64_tr_b16 a[178:179], v24 offset:49664
    v_mfma_f32_16x16x32_bf16 v[124:127], v[88:91], a[52:55], v[124:127]
    s_waitcnt lgkmcnt(9)
    ds_read_b64_tr_b16 v[80:81], v14 offset:49152
    ds_read_b64_tr_b16 v[82:83], v14 offset:49664
    v_mfma_f32_16x16x32_bf16 v[124:127], v[92:95], a[60:63], v[124:127]
    buffer_load_dwordx4 v23, s[16:19], s46 offen offset:1024 lds
    v_mfma_f32_16x16x32_bf16 v[116:119], v[92:95], a[56:59], v[116:119]
    s_waitcnt lgkmcnt(9)
    ds_read_b64_tr_b16 v[84:85], v14 offset:57344
    ds_read_b64_tr_b16 v[86:87], v14 offset:57856
    v_mfma_f32_16x16x32_bf16 v[116:119], v[88:91], a[48:51], v[116:119]
    s_add_u32 m0, s44, 149504
    ds_read_b64_tr_b16 a[180:181], v25 offset:49152
    ds_read_b64_tr_b16 a[182:183], v25 offset:49664
    v_mfma_f32_16x16x32_bf16 v[96:99], v[64:67], a[64:67], v[96:99]
    s_waitcnt lgkmcnt(10)
    ds_read_b64_tr_b16 v[88:89], v15 offset:49152
    ds_read_b64_tr_b16 v[90:91], v15 offset:49664
    v_mfma_f32_16x16x32_bf16 v[96:99], v[68:71], a[72:75], v[96:99]
    buffer_load_dwordx4 v22, s[16:19], s87 offen offset:0 lds
    v_mfma_f32_16x16x32_bf16 v[104:107], v[68:71], a[76:79], v[104:107]
    s_waitcnt lgkmcnt(10)
    ds_read_b64_tr_b16 v[92:93], v15 offset:57344
    ds_read_b64_tr_b16 v[94:95], v15 offset:57856
    v_mfma_f32_16x16x32_bf16 v[104:107], v[64:67], a[68:71], v[104:107]
    s_nop 0
    ds_read_b64_tr_b16 a[184:185], v26 offset:49152
    ds_read_b64_tr_b16 a[186:187], v26 offset:49664
    v_mfma_f32_16x16x32_bf16 v[108:111], v[72:75], a[68:71], v[108:111]
    s_waitcnt lgkmcnt(10)
    ds_read_b64_tr_b16 v[64:65], v12 offset:51200
    ds_read_b64_tr_b16 v[66:67], v12 offset:51712
    v_mfma_f32_16x16x32_bf16 v[108:111], v[76:79], a[76:79], v[108:111]
    buffer_load_dwordx4 v23, s[16:19], s87 offen offset:1024 lds
    v_mfma_f32_16x16x32_bf16 v[100:103], v[76:79], a[72:75], v[100:103]
    s_waitcnt lgkmcnt(10)
    ds_read_b64_tr_b16 v[68:69], v12 offset:59392
    ds_read_b64_tr_b16 v[70:71], v12 offset:59904
    v_mfma_f32_16x16x32_bf16 v[100:103], v[72:75], a[64:67], v[100:103]
    s_add_u32 m0, s44, 131072
    ds_read_b64_tr_b16 a[188:189], v27 offset:49152
    ds_read_b64_tr_b16 a[190:191], v27 offset:49664
    v_mfma_f32_16x16x32_bf16 v[112:115], v[80:83], a[64:67], v[112:115]
    s_waitcnt lgkmcnt(10)
    ds_read_b64_tr_b16 v[72:73], v13 offset:51200
    ds_read_b64_tr_b16 v[74:75], v13 offset:51712
    v_mfma_f32_16x16x32_bf16 v[112:115], v[84:87], a[72:75], v[112:115]
    buffer_load_dwordx4 v22, s[16:19], s93 offen offset:0 lds
    v_mfma_f32_16x16x32_bf16 v[120:123], v[84:87], a[76:79], v[120:123]
    s_waitcnt lgkmcnt(10)
    ds_read_b64_tr_b16 v[76:77], v13 offset:59392
    ds_read_b64_tr_b16 v[78:79], v13 offset:59904
    v_mfma_f32_16x16x32_bf16 v[120:123], v[80:83], a[68:71], v[120:123]
    v_mfma_f32_16x16x32_bf16 v[124:127], v[88:91], a[68:71], v[124:127]
    s_waitcnt lgkmcnt(8)
    ds_read_b64_tr_b16 v[80:81], v14 offset:51200
    ds_read_b64_tr_b16 v[82:83], v14 offset:51712
    v_mfma_f32_16x16x32_bf16 v[124:127], v[92:95], a[76:79], v[124:127]
    buffer_load_dwordx4 v23, s[16:19], s93 offen offset:1024 lds
    v_mfma_f32_16x16x32_bf16 v[116:119], v[92:95], a[72:75], v[116:119]
    s_waitcnt lgkmcnt(8)
    ds_read_b64_tr_b16 v[84:85], v14 offset:59392
    ds_read_b64_tr_b16 v[86:87], v14 offset:59904
    v_mfma_f32_16x16x32_bf16 v[116:119], v[88:91], a[64:67], v[116:119]
    v_mfma_f32_16x16x32_bf16 v[96:99], v[64:67], a[80:83], v[96:99]
    s_add_u32 m0, s44, 133120
    ds_read_b64_tr_b16 v[88:89], v15 offset:51200
    ds_read_b64_tr_b16 v[90:91], v15 offset:51712
    v_mfma_f32_16x16x32_bf16 v[96:99], v[68:71], a[88:91], v[96:99]
    buffer_load_dwordx4 v22, s[16:19], s100 offen offset:0 lds
    v_mfma_f32_16x16x32_bf16 v[104:107], v[68:71], a[92:95], v[104:107]
L_pad2:
    s_cmp_eq_u32 s92, 1
    s_cbranch_scc1 L_pad6
    s_waitcnt lgkmcnt(6)
    ds_read_b64_tr_b16 v[92:93], v15 offset:59392
    ds_read_b64_tr_b16 v[94:95], v15 offset:59904
    v_mfma_f32_16x16x32_bf16 v[104:107], v[64:67], a[84:87], v[104:107]
    s_barrier
    v_mfma_f32_16x16x32_bf16 v[108:111], v[72:75], a[84:87], v[108:111]
    s_waitcnt lgkmcnt(6)
    ds_read_b64_tr_b16 v[64:65], v12 offset:0
    ds_read_b64_tr_b16 v[66:67], v12 offset:512
    v_mfma_f32_16x16x32_bf16 v[108:111], v[76:79], a[92:95], v[108:111]
    buffer_load_dwordx4 v23, s[16:19], s100 offen offset:1024 lds
    v_mfma_f32_16x16x32_bf16 v[100:103], v[76:79], a[88:91], v[100:103]
    s_waitcnt lgkmcnt(6)
    ds_read_b64_tr_b16 v[68:69], v12 offset:8192
    ds_read_b64_tr_b16 v[70:71], v12 offset:8704
    v_mfma_f32_16x16x32_bf16 v[100:103], v[72:75], a[80:83], v[100:103]
    v_mfma_f32_16x16x32_bf16 v[112:115], v[80:83], a[80:83], v[112:115]
    s_add_u32 m0, s44, 98304
    ds_read_b64_tr_b16 v[72:73], v13 offset:0
    ds_read_b64_tr_b16 v[74:75], v13 offset:512
    v_mfma_f32_16x16x32_bf16 v[112:115], v[84:87], a[88:91], v[112:115]
    buffer_load_dwordx4 v22, s[16:19], s101 offen offset:0 lds
    v_mfma_f32_16x16x32_bf16 v[120:123], v[84:87], a[92:95], v[120:123]
    s_waitcnt lgkmcnt(6)
    ds_read_b64_tr_b16 v[76:77], v13 offset:8192
    ds_read_b64_tr_b16 v[78:79], v13 offset:8704
    v_mfma_f32_16x16x32_bf16 v[120:123], v[80:83], a[84:87], v[120:123]
    v_mfma_f32_16x16x32_bf16 v[124:127], v[88:91], a[84:87], v[124:127]
    s_waitcnt lgkmcnt(6)
    ds_read_b64_tr_b16 v[80:81], v14 offset:0
    ds_read_b64_tr_b16 v[82:83], v14 offset:512
    v_mfma_f32_16x16x32_bf16 v[124:127], v[92:95], a[92:95], v[124:127]
    buffer_load_dwordx4 v23, s[16:19], s101 offen offset:1024 lds
    v_mfma_f32_16x16x32_bf16 v[116:119], v[92:95], a[88:91], v[116:119]
    s_waitcnt lgkmcnt(6)
    ds_read_b64_tr_b16 v[84:85], v14 offset:8192
    ds_read_b64_tr_b16 v[86:87], v14 offset:8704
    v_mfma_f32_16x16x32_bf16 v[116:119], v[88:91], a[80:83], v[116:119]
    v_mfma_f32_16x16x32_bf16 v[96:99], v[64:67], a[96:99], v[96:99]
    s_add_u32 m0, s44, 100352
    ds_read_b64_tr_b16 v[88:89], v15 offset:0
    ds_read_b64_tr_b16 v[90:91], v15 offset:512
    v_mfma_f32_16x16x32_bf16 v[96:99], v[68:71], a[104:107], v[96:99]
    buffer_load_dwordx4 v22, s[16:19], s41 offen offset:0 lds
    v_mfma_f32_16x16x32_bf16 v[104:107], v[68:71], a[108:111], v[104:107]
    s_waitcnt lgkmcnt(6)
    ds_read_b64_tr_b16 v[92:93], v15 offset:8192
    ds_read_b64_tr_b16 v[94:95], v15 offset:8704
    v_mfma_f32_16x16x32_bf16 v[104:107], v[64:67], a[100:103], v[104:107]
    s_waitcnt vmcnt(11)
    ds_read_b64_tr_b16 a[192:193], v24 offset:0
    ds_read_b64_tr_b16 a[194:195], v24 offset:512
    v_mfma_f32_16x16x32_bf16 v[108:111], v[72:75], a[100:103], v[108:111]
    s_waitcnt lgkmcnt(8)
    ds_read_b64_tr_b16 v[64:65], v12 offset:2048
    ds_read_b64_tr_b16 v[66:67], v12 offset:2560
    v_mfma_f32_16x16x32_bf16 v[108:111], v[76:79], a[108:111], v[108:111]
    buffer_load_dwordx4 v23, s[16:19], s41 offen offset:1024 lds
    v_mfma_f32_16x16x32_bf16 v[100:103], v[76:79], a[104:107], v[100:103]
    s_waitcnt lgkmcnt(8)
    ds_read_b64_tr_b16 v[68:69], v12 offset:10240
    ds_read_b64_tr_b16 v[70:71], v12 offset:10752
    v_mfma_f32_16x16x32_bf16 v[100:103], v[72:75], a[96:99], v[100:103]
    buffer_load_dword v56, v54, s[20:23], 0 offen offset:0 sc1
    v_mfma_f32_16x16x32_bf16 v[112:115], v[80:83], a[96:99], v[112:115]
    s_waitcnt lgkmcnt(8)
    ds_read_b64_tr_b16 v[72:73], v13 offset:2048
    ds_read_b64_tr_b16 v[74:75], v13 offset:2560
    v_mfma_f32_16x16x32_bf16 v[112:115], v[84:87], a[104:107], v[112:115]
    s_nop 0
    ds_read_b64_tr_b16 a[196:197], v25 offset:0
    ds_read_b64_tr_b16 a[198:199], v25 offset:512
    v_mfma_f32_16x16x32_bf16 v[120:123], v[84:87], a[108:111], v[120:123]
    s_waitcnt lgkmcnt(10)
    ds_read_b64_tr_b16 v[76:77], v13 offset:10240
    ds_read_b64_tr_b16 v[78:79], v13 offset:10752
    v_mfma_f32_16x16x32_bf16 v[120:123], v[80:83], a[100:103], v[120:123]
    s_nop 0
    ds_read_b64_tr_b16 a[200:201], v26 offset:0
    ds_read_b64_tr_b16 a[202:203], v26 offset:512
    v_mfma_f32_16x16x32_bf16 v[124:127], v[88:91], a[100:103], v[124:127]
    s_waitcnt lgkmcnt(10)
    ds_read_b64_tr_b16 v[80:81], v14 offset:2048
    ds_read_b64_tr_b16 v[82:83], v14 offset:2560
    v_mfma_f32_16x16x32_bf16 v[124:127], v[92:95], a[108:111], v[124:127]
    s_nop 0
    ds_read_b64_tr_b16 a[204:205], v27 offset:0
    ds_read_b64_tr_b16 a[206:207], v27 offset:512
    v_mfma_f32_16x16x32_bf16 v[116:119], v[92:95], a[104:107], v[116:119]
    s_waitcnt lgkmcnt(12)
    ds_read_b64_tr_b16 v[84:85], v14 offset:10240
    ds_read_b64_tr_b16 v[86:87], v14 offset:10752
    v_mfma_f32_16x16x32_bf16 v[116:119], v[88:91], a[96:99], v[116:119]
    v_mfma_f32_16x16x32_bf16 v[96:99], v[64:67], a[112:115], v[96:99]
    s_waitcnt lgkmcnt(12)
    ds_read_b64_tr_b16 v[88:89], v15 offset:2048
    ds_read_b64_tr_b16 v[90:91], v15 offset:2560
    v_mfma_f32_16x16x32_bf16 v[96:99], v[68:71], a[120:123], v[96:99]
    v_mfma_f32_16x16x32_bf16 v[104:107], v[68:71], a[124:127], v[104:107]
    s_waitcnt lgkmcnt(10)
    ds_read_b64_tr_b16 v[92:93], v15 offset:10240
    ds_read_b64_tr_b16 v[94:95], v15 offset:10752
    v_mfma_f32_16x16x32_bf16 v[104:107], v[64:67], a[116:119], v[104:107]
    s_barrier
    v_mfma_f32_16x16x32_bf16 v[108:111], v[72:75], a[116:119], v[108:111]
    s_add_u32 m0, s44, 114688
    ds_read_b64_tr_b16 v[64:65], v12 offset:16384
    ds_read_b64_tr_b16 v[66:67], v12 offset:16896
    v_mfma_f32_16x16x32_bf16 v[108:111], v[76:79], a[124:127], v[108:111]
    buffer_load_dwordx4 v22, s[16:19], s42 offen offset:0 lds
    v_mfma_f32_16x16x32_bf16 v[100:103], v[76:79], a[120:123], v[100:103]
    s_waitcnt lgkmcnt(6)
    ds_read_b64_tr_b16 v[68:69], v12 offset:24576
    ds_read_b64_tr_b16 v[70:71], v12 offset:25088
    v_mfma_f32_16x16x32_bf16 v[100:103], v[72:75], a[112:115], v[100:103]
    v_mfma_f32_16x16x32_bf16 v[112:115], v[80:83], a[112:115], v[112:115]
    s_waitcnt lgkmcnt(6)
    ds_read_b64_tr_b16 v[72:73], v13 offset:16384
    ds_read_b64_tr_b16 v[74:75], v13 offset:16896
    v_mfma_f32_16x16x32_bf16 v[112:115], v[84:87], a[120:123], v[112:115]
    buffer_load_dwordx4 v23, s[16:19], s42 offen offset:1024 lds
    v_mfma_f32_16x16x32_bf16 v[120:123], v[84:87], a[124:127], v[120:123]
    s_waitcnt lgkmcnt(6)
    ds_read_b64_tr_b16 v[76:77], v13 offset:24576
    ds_read_b64_tr_b16 v[78:79], v13 offset:25088
    v_mfma_f32_16x16x32_bf16 v[120:123], v[80:83], a[116:119], v[120:123]
    v_mfma_f32_16x16x32_bf16 v[124:127], v[88:91], a[116:119], v[124:127]
    s_add_u32 m0, s44, 116736
    ds_read_b64_tr_b16 v[80:81], v14 offset:16384
    ds_read_b64_tr_b16 v[82:83], v14 offset:16896
    v_mfma_f32_16x16x32_bf16 v[124:127], v[92:95], a[124:127], v[124:127]
    buffer_load_dwordx4 v22, s[16:19], s43 offen offset:0 lds
    v_mfma_f32_16x16x32_bf16 v[116:119], v[92:95], a[120:123], v[116:119]
    s_waitcnt lgkmcnt(6)
    ds_read_b64_tr_b16 v[84:85], v14 offset:24576
    ds_read_b64_tr_b16 v[86:87], v14 offset:25088
    v_mfma_f32_16x16x32_bf16 v[116:119], v[88:91], a[112:115], v[116:119]
    v_mfma_f32_16x16x32_bf16 v[96:99], v[64:67], a[128:131], v[96:99]
    s_waitcnt lgkmcnt(6)
    ds_read_b64_tr_b16 v[88:89], v15 offset:16384
    ds_read_b64_tr_b16 v[90:91], v15 offset:16896
    v_mfma_f32_16x16x32_bf16 v[96:99], v[68:71], a[136:139], v[96:99]
    buffer_load_dwordx4 v23, s[16:19], s43 offen offset:1024 lds
    v_mfma_f32_16x16x32_bf16 v[104:107], v[68:71], a[140:143], v[104:107]
    s_waitcnt lgkmcnt(6)
    ds_read_b64_tr_b16 v[92:93], v15 offset:24576
    ds_read_b64_tr_b16 v[94:95], v15 offset:25088
    v_mfma_f32_16x16x32_bf16 v[104:107], v[64:67], a[132:135], v[104:107]
    v_mfma_f32_16x16x32_bf16 v[108:111], v[72:75], a[132:135], v[108:111]
    s_waitcnt lgkmcnt(6)
    ds_read_b64_tr_b16 v[64:65], v12 offset:18432
    ds_read_b64_tr_b16 v[66:67], v12 offset:18944
    v_mfma_f32_16x16x32_bf16 v[108:111], v[76:79], a[140:143], v[108:111]
    v_mfma_f32_16x16x32_bf16 v[100:103], v[76:79], a[136:139], v[100:103]
    s_waitcnt lgkmcnt(6)
    ds_read_b64_tr_b16 v[68:69], v12 offset:26624
    ds_read_b64_tr_b16 v[70:71], v12 offset:27136
    v_mfma_f32_16x16x32_bf16 v[100:103], v[72:75], a[128:131], v[100:103]
    v_mfma_f32_16x16x32_bf16 v[112:115], v[80:83], a[128:131], v[112:115]
    s_waitcnt lgkmcnt(6)
    ds_read_b64_tr_b16 v[72:73], v13 offset:18432
    ds_read_b64_tr_b16 v[74:75], v13 offset:18944
    v_mfma_f32_16x16x32_bf16 v[112:115], v[84:87], a[136:139], v[112:115]
    v_mfma_f32_16x16x32_bf16 v[120:123], v[84:87], a[140:143], v[120:123]
    s_waitcnt lgkmcnt(6)
    ds_read_b64_tr_b16 v[76:77], v13 offset:26624
    ds_read_b64_tr_b16 v[78:79], v13 offset:27136
    v_mfma_f32_16x16x32_bf16 v[120:123], v[80:83], a[132:135], v[120:123]
    v_mfma_f32_16x16x32_bf16 v[124:127], v[88:91], a[132:135], v[124:127]
    s_waitcnt lgkmcnt(6)
    ds_read_b64_tr_b16 v[80:81], v14 offset:18432
    ds_read_b64_tr_b16 v[82:83], v14 offset:18944
    v_mfma_f32_16x16x32_bf16 v[124:127], v[92:95], a[140:143], v[124:127]
    v_mfma_f32_16x16x32_bf16 v[116:119], v[92:95], a[136:139], v[116:119]
    s_waitcnt lgkmcnt(6)
    ds_read_b64_tr_b16 v[84:85], v14 offset:26624
    ds_read_b64_tr_b16 v[86:87], v14 offset:27136
    v_mfma_f32_16x16x32_bf16 v[116:119], v[88:91], a[128:131], v[116:119]
    v_mfma_f32_16x16x32_bf16 v[96:99], v[64:67], a[144:147], v[96:99]
    s_waitcnt lgkmcnt(6)
    ds_read_b64_tr_b16 v[88:89], v15 offset:18432
    ds_read_b64_tr_b16 v[90:91], v15 offset:18944
    v_mfma_f32_16x16x32_bf16 v[96:99], v[68:71], a[152:155], v[96:99]
    v_mfma_f32_16x16x32_bf16 v[104:107], v[68:71], a[156:159], v[104:107]
    s_waitcnt lgkmcnt(6)
    ds_read_b64_tr_b16 v[92:93], v15 offset:26624
    ds_read_b64_tr_b16 v[94:95], v15 offset:27136
    v_mfma_f32_16x16x32_bf16 v[104:107], v[64:67], a[148:151], v[104:107]
    s_waitcnt vmcnt(4)
    v_cmp_ne_u32 vcc, 1, v56
    s_nop 0
    s_cbranch_vccnz L_spin_7
L_ok_8:
    s_barrier
    v_mfma_f32_16x16x32_bf16 v[108:111], v[72:75], a[148:151], v[108:111]
    s_waitcnt lgkmcnt(6)
    ds_read_b64_tr_b16 v[64:65], v16 offset:16384
    ds_read_b64_tr_b16 v[66:67], v16 offset:16896
    v_mfma_f32_16x16x32_bf16 v[108:111], v[76:79], a[156:159], v[108:111]
    buffer_load_dwordx4 v[208:211], v220, s[20:23], s66 offen sc1
    v_mfma_f32_16x16x32_bf16 v[100:103], v[76:79], a[152:155], v[100:103]
    s_waitcnt lgkmcnt(6)
    ds_read_b64_tr_b16 v[68:69], v16 offset:24576
    ds_read_b64_tr_b16 v[70:71], v16 offset:25088
    v_mfma_f32_16x16x32_bf16 v[100:103], v[72:75], a[144:147], v[100:103]
    buffer_load_dwordx2 v[216:217], v221, s[20:23], s66 offen offset:256 sc1
    v_mfma_f32_16x16x32_bf16 v[112:115], v[80:83], a[144:147], v[112:115]
    s_add_u32 m0, s61, 0
    ds_read_b64_tr_b16 v[72:73], v17 offset:16384
    ds_read_b64_tr_b16 v[74:75], v17 offset:16896
    v_mfma_f32_16x16x32_bf16 v[112:115], v[84:87], a[152:155], v[112:115]
    buffer_load_dwordx4 v236, s[20:23], s58 offen offset:0 sc1 lds
    v_mfma_f32_16x16x32_bf16 v[120:123], v[84:87], a[156:159], v[120:123]
    s_waitcnt lgkmcnt(6)
    ds_read_b64_tr_b16 v[76:77], v17 offset:24576
    ds_read_b64_tr_b16 v[78:79], v17 offset:25088
    v_mfma_f32_16x16x32_bf16 v[120:123], v[80:83], a[148:151], v[120:123]
    ds_write_b128 v62, v[232:235] offset:37888
    v_mfma_f32_16x16x32_bf16 v[124:127], v[88:91], a[148:151], v[124:127]
    s_waitcnt lgkmcnt(7)
    ds_read_b64_tr_b16 v[80:81], v18 offset:16384
    ds_read_b64_tr_b16 v[82:83], v18 offset:16896
    v_mfma_f32_16x16x32_bf16 v[124:127], v[92:95], a[156:159], v[124:127]
    buffer_load_dwordx4 v236, s[20:23], s58 offen offset:1024 sc1 lds
    v_mfma_f32_16x16x32_bf16 v[116:119], v[92:95], a[152:155], v[116:119]
    s_waitcnt lgkmcnt(7)
    ds_read_b64_tr_b16 v[84:85], v18 offset:24576
    ds_read_b64_tr_b16 v[86:87], v18 offset:25088
    v_mfma_f32_16x16x32_bf16 v[116:119], v[88:91], a[144:147], v[116:119]
    v_mfma_f32_16x16x32_bf16 v[128:131], v[64:67], a[0:3], 0
    s_waitcnt lgkmcnt(7)
    ds_read_b64_tr_b16 v[88:89], v19 offset:16384
    ds_read_b64_tr_b16 v[90:91], v19 offset:16896
    v_mfma_f32_16x16x32_bf16 v[128:131], v[68:71], a[8:11], v[128:131]
    buffer_load_dwordx4 v236, s[20:23], s58 offen offset:2048 sc1 lds
    v_mfma_f32_16x16x32_bf16 v[136:139], v[68:71], a[12:15], 0
    s_waitcnt lgkmcnt(7)
    ds_read_b64_tr_b16 v[92:93], v19 offset:24576
    ds_read_b64_tr_b16 v[94:95], v19 offset:25088
    v_mfma_f32_16x16x32_bf16 v[136:139], v[64:67], a[4:7], v[136:139]
    v_cvt_pk_bf16_f32 v192, v96, v97
    v_cvt_pk_bf16_f32 v193, v98, v99
    v_mfma_f32_16x16x32_bf16 v[140:143], v[72:75], a[4:7], 0
    s_waitcnt lgkmcnt(6)
    ds_read_b64_tr_b16 v[64:65], v16 offset:18432
    ds_read_b64_tr_b16 v[66:67], v16 offset:18944
    v_mfma_f32_16x16x32_bf16 v[140:143], v[76:79], a[12:15], v[140:143]
    buffer_load_dwordx4 v236, s[20:23], s58 offen offset:3072 sc1 lds
    v_mfma_f32_16x16x32_bf16 v[132:135], v[76:79], a[8:11], 0
    s_waitcnt lgkmcnt(6)
    ds_read_b64_tr_b16 v[68:69], v16 offset:26624
    ds_read_b64_tr_b16 v[70:71], v16 offset:27136
    v_mfma_f32_16x16x32_bf16 v[132:135], v[72:75], a[0:3], v[132:135]
    v_cvt_pk_bf16_f32 v194, v100, v101
    v_cvt_pk_bf16_f32 v195, v102, v103
    v_mfma_f32_16x16x32_bf16 v[144:147], v[80:83], a[0:3], 0
    s_add_u32 m0, s61, 4096
    ds_read_b64_tr_b16 v[72:73], v17 offset:18432
    ds_read_b64_tr_b16 v[74:75], v17 offset:18944
    v_mfma_f32_16x16x32_bf16 v[144:147], v[84:87], a[8:11], v[144:147]
    buffer_load_dwordx4 v237, s[20:23], s58 offen offset:0 sc1 lds
    v_mfma_f32_16x16x32_bf16 v[152:155], v[84:87], a[12:15], 0
    s_waitcnt lgkmcnt(6)
    ds_read_b64_tr_b16 v[76:77], v17 offset:26624
    ds_read_b64_tr_b16 v[78:79], v17 offset:27136
    v_mfma_f32_16x16x32_bf16 v[152:155], v[80:83], a[4:7], v[152:155]
    v_pk_max_i16 v192, v192, 0
    v_pk_max_i16 v193, v193, 0
    v_mfma_f32_16x16x32_bf16 v[156:159], v[88:91], a[4:7], 0
    s_add_u32 m0, s44, 65536
    ds_read_b64_tr_b16 v[80:81], v18 offset:18432
    ds_read_b64_tr_b16 v[82:83], v18 offset:18944
    v_mfma_f32_16x16x32_bf16 v[156:159], v[92:95], a[12:15], v[156:159]
    buffer_load_dwordx4 v22, s[16:19], s54 offen offset:0 lds
    v_mfma_f32_16x16x32_bf16 v[148:151], v[92:95], a[8:11], 0
    s_waitcnt lgkmcnt(6)
    ds_read_b64_tr_b16 v[84:85], v18 offset:26624
    ds_read_b64_tr_b16 v[86:87], v18 offset:27136
    v_mfma_f32_16x16x32_bf16 v[148:151], v[88:91], a[0:3], v[148:151]
    v_pk_max_i16 v194, v194, 0
    v_pk_max_i16 v195, v195, 0
    v_mfma_f32_16x16x32_bf16 v[128:131], v[64:67], a[16:19], v[128:131]
    s_waitcnt lgkmcnt(6)
    ds_read_b64_tr_b16 v[88:89], v19 offset:18432
    ds_read_b64_tr_b16 v[90:91], v19 offset:18944
    v_mfma_f32_16x16x32_bf16 v[128:131], v[68:71], a[24:27], v[128:131]
    buffer_load_dwordx4 v23, s[16:19], s54 offen offset:1024 lds
    v_mfma_f32_16x16x32_bf16 v[136:139], v[68:71], a[28:31], v[136:139]
    s_waitcnt lgkmcnt(6)
    ds_read_b64_tr_b16 v[92:93], v19 offset:26624
    ds_read_b64_tr_b16 v[94:95], v19 offset:27136
    v_mfma_f32_16x16x32_bf16 v[136:139], v[64:67], a[20:23], v[136:139]
    s_barrier
    v_mfma_f32_16x16x32_bf16 v[140:143], v[72:75], a[20:23], v[140:143]
    s_add_u32 m0, s44, 67584
    ds_read_b64_tr_b16 v[64:65], v16 offset:0
    ds_read_b64_tr_b16 v[66:67], v16 offset:512
    v_mfma_f32_16x16x32_bf16 v[140:143], v[76:79], a[28:31], v[140:143]
    buffer_load_dwordx4 v22, s[16:19], s55 offen offset:0 lds
    v_mfma_f32_16x16x32_bf16 v[132:135], v[76:79], a[24:27], v[132:135]
    s_waitcnt lgkmcnt(6)
    ds_read_b64_tr_b16 v[68:69], v16 offset:8192
    ds_read_b64_tr_b16 v[70:71], v16 offset:8704
    v_mfma_f32_16x16x32_bf16 v[132:135], v[72:75], a[16:19], v[132:135]
    v_cvt_pk_bf16_f32 v196, v104, v105
    v_cvt_pk_bf16_f32 v197, v106, v107
    v_mfma_f32_16x16x32_bf16 v[144:147], v[80:83], a[16:19], v[144:147]
    s_waitcnt lgkmcnt(6)
    ds_read_b64_tr_b16 v[72:73], v17 offset:0
    ds_read_b64_tr_b16 v[74:75], v17 offset:512
    v_mfma_f32_16x16x32_bf16 v[144:147], v[84:87], a[24:27], v[144:147]
    buffer_load_dwordx4 v23, s[16:19], s55 offen offset:1024 lds
    v_mfma_f32_16x16x32_bf16 v[152:155], v[84:87], a[28:31], v[152:155]
    s_waitcnt lgkmcnt(6)
    ds_read_b64_tr_b16 v[76:77], v17 offset:8192
    ds_read_b64_tr_b16 v[78:79], v17 offset:8704
    v_mfma_f32_16x16x32_bf16 v[152:155], v[80:83], a[20:23], v[152:155]
    v_cvt_pk_bf16_f32 v198, v108, v109
    v_cvt_pk_bf16_f32 v199, v110, v111
    v_mfma_f32_16x16x32_bf16 v[156:159], v[88:91], a[20:23], v[156:159]
    s_waitcnt lgkmcnt(6)
    ds_read_b64_tr_b16 v[80:81], v18 offset:0
    ds_read_b64_tr_b16 v[82:83], v18 offset:512
    v_mfma_f32_16x16x32_bf16 v[156:159], v[92:95], a[28:31], v[156:159]
    buffer_load_dwordx4 v[212:215], v220, s[20:23], s66 offen offset:384 sc1
    v_mfma_f32_16x16x32_bf16 v[148:151], v[92:95], a[24:27], v[148:151]
    s_waitcnt lgkmcnt(6)
    ds_read_b64_tr_b16 v[84:85], v18 offset:8192
    ds_read_b64_tr_b16 v[86:87], v18 offset:8704
    v_mfma_f32_16x16x32_bf16 v[148:151], v[88:91], a[16:19], v[148:151]
    buffer_load_dword v58, v61, s[20:23], s67 offen sc1
    v_mfma_f32_16x16x32_bf16 v[128:131], v[64:67], a[32:35], v[128:131]
    s_add_u32 m0, s62, 0
    ds_read_b64_tr_b16 v[88:89], v19 offset:0
    ds_read_b64_tr_b16 v[90:91], v19 offset:512
    v_mfma_f32_16x16x32_bf16 v[128:131], v[68:71], a[40:43], v[128:131]
    buffer_load_dwordx4 v236, s[20:23], s59 offen offset:0 sc1 lds
    v_mfma_f32_16x16x32_bf16 v[136:139], v[68:71], a[44:47], v[136:139]
    s_waitcnt lgkmcnt(6)
    ds_read_b64_tr_b16 v[92:93], v19 offset:8192
    ds_read_b64_tr_b16 v[94:95], v19 offset:8704
    v_mfma_f32_16x16x32_bf16 v[136:139], v[64:67], a[36:39], v[136:139]
    v_pk_max_i16 v196, v196, 0
    v_pk_max_i16 v197, v197, 0
    v_mfma_f32_16x16x32_bf16 v[140:143], v[72:75], a[36:39], v[140:143]
    s_waitcnt lgkmcnt(6)
    ds_read_b64_tr_b16 v[64:65], v16 offset:2048
    ds_read_b64_tr_b16 v[66:67], v16 offset:2560
    v_mfma_f32_16x16x32_bf16 v[140:143], v[76:79], a[44:47], v[140:143]
    buffer_load_dwordx4 v236, s[20:23], s59 offen offset:1024 sc1 lds
    v_mfma_f32_16x16x32_bf16 v[132:135], v[76:79], a[40:43], v[132:135]
    s_waitcnt lgkmcnt(6)
    ds_read_b64_tr_b16 v[68:69], v16 offset:10240
    ds_read_b64_tr_b16 v[70:71], v16 offset:10752
    v_mfma_f32_16x16x32_bf16 v[132:135], v[72:75], a[32:35], v[132:135]
    v_pk_max_i16 v198, v198, 0
    v_pk_max_i16 v199, v199, 0
    v_mfma_f32_16x16x32_bf16 v[144:147], v[80:83], a[32:35], v[144:147]
    s_waitcnt lgkmcnt(6)
    ds_read_b64_tr_b16 v[72:73], v17 offset:2048
    ds_read_b64_tr_b16 v[74:75], v17 offset:2560
    v_mfma_f32_16x16x32_bf16 v[144:147], v[84:87], a[40:43], v[144:147]
    buffer_load_dwordx4 v236, s[20:23], s59 offen offset:2048 sc1 lds
    v_mfma_f32_16x16x32_bf16 v[152:155], v[84:87], a[44:47], v[152:155]
    s_waitcnt lgkmcnt(6)
    ds_read_b64_tr_b16 v[76:77], v17 offset:10240
    ds_read_b64_tr_b16 v[78:79], v17 offset:10752
    v_mfma_f32_16x16x32_bf16 v[152:155], v[80:83], a[36:39], v[152:155]
    v_cvt_pk_bf16_f32 v200, v112, v113
    v_cvt_pk_bf16_f32 v201, v114, v115
    v_mfma_f32_16x16x32_bf16 v[156:159], v[88:91], a[36:39], v[156:159]
    s_waitcnt lgkmcnt(6)
    ds_read_b64_tr_b16 v[80:81], v18 offset:2048
    ds_read_b64_tr_b16 v[82:83], v18 offset:2560
    v_mfma_f32_16x16x32_bf16 v[156:159], v[92:95], a[44:47], v[156:159]
    buffer_load_dwordx4 v236, s[20:23], s59 offen offset:3072 sc1 lds
    v_mfma_f32_16x16x32_bf16 v[148:151], v[92:95], a[40:43], v[148:151]
    s_waitcnt lgkmcnt(6)
    ds_read_b64_tr_b16 v[84:85], v18 offset:10240
    ds_read_b64_tr_b16 v[86:87], v18 offset:10752
    v_mfma_f32_16x16x32_bf16 v[148:151], v[88:91], a[32:35], v[148:151]
    v_cvt_pk_bf16_f32 v202, v116, v117
    v_cvt_pk_bf16_f32 v203, v118, v119
    v_mfma_f32_16x16x32_bf16 v[128:131], v[64:67], a[48:51], v[128:131]
    s_add_u32 m0, s62, 4096
    ds_read_b64_tr_b16 v[88:89], v19 offset:2048
    ds_read_b64_tr_b16 v[90:91], v19 offset:2560
    v_mfma_f32_16x16x32_bf16 v[128:131], v[68:71], a[56:59], v[128:131]
    buffer_load_dwordx4 v237, s[20:23], s59 offen offset:0 sc1 lds
    v_mfma_f32_16x16x32_bf16 v[136:139], v[68:71], a[60:63], v[136:139]
    s_waitcnt lgkmcnt(6)
    ds_read_b64_tr_b16 v[92:93], v19 offset:10240
    ds_read_b64_tr_b16 v[94:95], v19 offset:10752
    v_mfma_f32_16x16x32_bf16 v[136:139], v[64:67], a[52:55], v[136:139]
    s_barrier
    v_mfma_f32_16x16x32_bf16 v[140:143], v[72:75], a[52:55], v[140:143]
    s_add_u32 m0, s63, 0
    ds_read_b64_tr_b16 v[64:65], v12 offset:32768
    ds_read_b64_tr_b16 v[66:67], v12 offset:33280
    v_mfma_f32_16x16x32_bf16 v[140:143], v[76:79], a[60:63], v[140:143]
    buffer_load_dwordx4 v236, s[20:23], s60 offen offset:0 sc1 lds
    v_mfma_f32_16x16x32_bf16 v[132:135], v[76:79], a[56:59], v[132:135]
    s_waitcnt lgkmcnt(6)
    ds_read_b64_tr_b16 v[68:69], v12 offset:40960
    ds_read_b64_tr_b16 v[70:71], v12 offset:41472
    v_mfma_f32_16x16x32_bf16 v[132:135], v[72:75], a[48:51], v[132:135]
    v_pk_max_i16 v200, v200, 0
    v_pk_max_i16 v201, v201, 0
    v_mfma_f32_16x16x32_bf16 v[144:147], v[80:83], a[48:51], v[144:147]
    s_waitcnt lgkmcnt(6)
    ds_read_b64_tr_b16 v[72:73], v13 offset:32768
    ds_read_b64_tr_b16 v[74:75], v13 offset:33280
    v_mfma_f32_16x16x32_bf16 v[144:147], v[84:87], a[56:59], v[144:147]
    buffer_load_dwordx4 v236, s[20:23], s60 offen offset:1024 sc1 lds
    v_mfma_f32_16x16x32_bf16 v[152:155], v[84:87], a[60:63], v[152:155]
    s_waitcnt lgkmcnt(6)
    ds_read_b64_tr_b16 v[76:77], v13 offset:40960
    ds_read_b64_tr_b16 v[78:79], v13 offset:41472
    v_mfma_f32_16x16x32_bf16 v[152:155], v[80:83], a[52:55], v[152:155]
    v_pk_max_i16 v202, v202, 0
    v_pk_max_i16 v203, v203, 0
    v_mfma_f32_16x16x32_bf16 v[156:159], v[88:91], a[52:55], v[156:159]
    s_waitcnt lgkmcnt(6)
    ds_read_b64_tr_b16 v[80:81], v14 offset:32768
    ds_read_b64_tr_b16 v[82:83], v14 offset:33280
    v_mfma_f32_16x16x32_bf16 v[156:159], v[92:95], a[60:63], v[156:159]
    buffer_load_dwordx4 v236, s[20:23], s60 offen offset:2048 sc1 lds
    v_mfma_f32_16x16x32_bf16 v[148:151], v[92:95], a[56:59], v[148:151]
    s_waitcnt lgkmcnt(6)
    ds_read_b64_tr_b16 v[84:85], v14 offset:40960
    ds_read_b64_tr_b16 v[86:87], v14 offset:41472
    v_mfma_f32_16x16x32_bf16 v[148:151], v[88:91], a[48:51], v[148:151]
    v_cvt_pk_bf16_f32 v204, v120, v121
    v_cvt_pk_bf16_f32 v205, v122, v123
    v_mfma_f32_16x16x32_bf16 v[128:131], v[64:67], a[64:67], v[128:131]
    s_waitcnt lgkmcnt(6)
    ds_read_b64_tr_b16 v[88:89], v15 offset:32768
    ds_read_b64_tr_b16 v[90:91], v15 offset:33280
    v_mfma_f32_16x16x32_bf16 v[128:131], v[68:71], a[72:75], v[128:131]
    buffer_load_dwordx4 v236, s[20:23], s60 offen offset:3072 sc1 lds
    v_mfma_f32_16x16x32_bf16 v[136:139], v[68:71], a[76:79], v[136:139]
    s_waitcnt lgkmcnt(6)
    ds_read_b64_tr_b16 v[92:93], v15 offset:40960
    ds_read_b64_tr_b16 v[94:95], v15 offset:41472
    v_mfma_f32_16x16x32_bf16 v[136:139], v[64:67], a[68:71], v[136:139]
    v_cvt_pk_bf16_f32 v206, v124, v125
    v_cvt_pk_bf16_f32 v207, v126, v127
    v_mfma_f32_16x16x32_bf16 v[140:143], v[72:75], a[68:71], v[140:143]
    s_add_u32 m0, s63, 4096
    ds_read_b64_tr_b16 v[64:65], v12 offset:34816
    ds_read_b64_tr_b16 v[66:67], v12 offset:35328
    v_mfma_f32_16x16x32_bf16 v[140:143], v[76:79], a[76:79], v[140:143]
    buffer_load_dwordx4 v237, s[20:23], s60 offen offset:0 sc1 lds
    v_mfma_f32_16x16x32_bf16 v[132:135], v[76:79], a[72:75], v[132:135]
    s_waitcnt lgkmcnt(6)
    ds_read_b64_tr_b16 v[68:69], v12 offset:43008
    ds_read_b64_tr_b16 v[70:71], v12 offset:43520
    v_mfma_f32_16x16x32_bf16 v[132:135], v[72:75], a[64:67], v[132:135]
    s_add_u32 m0, s44, 81920
    buffer_store_dwordx4 v[192:195], v31, s[20:23], s94 offen offset:0 sc1
    v_mfma_f32_16x16x32_bf16 v[144:147], v[80:83], a[64:67], v[144:147]
    s_waitcnt lgkmcnt(6)
    ds_read_b64_tr_b16 v[72:73], v13 offset:34816
    ds_read_b64_tr_b16 v[74:75], v13 offset:35328
    v_mfma_f32_16x16x32_bf16 v[144:147], v[84:87], a[72:75], v[144:147]
    buffer_load_dwordx4 v35, s[24:27], s69 offen offset:0 lds
    v_mfma_f32_16x16x32_bf16 v[152:155], v[84:87], a[76:79], v[152:155]
    s_waitcnt lgkmcnt(6)
    ds_read_b64_tr_b16 v[76:77], v13 offset:43008
    ds_read_b64_tr_b16 v[78:79], v13 offset:43520
    v_mfma_f32_16x16x32_bf16 v[152:155], v[80:83], a[68:71], v[152:155]
    buffer_store_dwordx4 v[196:199], v31, s[20:23], s94 offen offset:512 sc1
    v_mfma_f32_16x16x32_bf16 v[156:159], v[88:91], a[68:71], v[156:159]
    s_waitcnt lgkmcnt(6)
    ds_read_b64_tr_b16 v[80:81], v14 offset:34816
    ds_read_b64_tr_b16 v[82:83], v14 offset:35328
    v_mfma_f32_16x16x32_bf16 v[156:159], v[92:95], a[76:79], v[156:159]
    buffer_load_dwordx4 v36, s[24:27], s69 offen offset:1024 lds
    v_mfma_f32_16x16x32_bf16 v[148:151], v[92:95], a[72:75], v[148:151]
    s_waitcnt lgkmcnt(6)
    ds_read_b64_tr_b16 v[84:85], v14 offset:43008
    ds_read_b64_tr_b16 v[86:87], v14 offset:43520
    v_mfma_f32_16x16x32_bf16 v[148:151], v[88:91], a[64:67], v[148:151]
    buffer_store_dwordx4 v[200:203], v31, s[20:23], s95 offen offset:0 sc1
    v_mfma_f32_16x16x32_bf16 v[128:131], v[64:67], a[80:83], v[128:131]
    s_waitcnt lgkmcnt(6)
    ds_read_b64_tr_b16 v[88:89], v15 offset:34816
    ds_read_b64_tr_b16 v[90:91], v15 offset:35328
    v_mfma_f32_16x16x32_bf16 v[128:131], v[68:71], a[88:91], v[128:131]
    buffer_load_dwordx4 v37, s[24:27], s69 offen offset:2048 lds
    v_mfma_f32_16x16x32_bf16 v[136:139], v[68:71], a[92:95], v[136:139]
    s_waitcnt lgkmcnt(6)
    ds_read_b64_tr_b16 v[92:93], v15 offset:43008
    ds_read_b64_tr_b16 v[94:95], v15 offset:43520
    v_mfma_f32_16x16x32_bf16 v[136:139], v[64:67], a[84:87], v[136:139]
    s_waitcnt vmcnt(29)
    s_barrier
    v_pk_max_i16 v204, v204, 0
    v_mfma_f32_16x16x32_bf16 v[140:143], v[72:75], a[84:87], v[140:143]
    s_waitcnt lgkmcnt(6)
    ds_read_b64_tr_b16 v[64:65], v12 offset:49152
    ds_read_b64_tr_b16 v[66:67], v12 offset:49664
    v_mfma_f32_16x16x32_bf16 v[140:143], v[76:79], a[92:95], v[140:143]
    buffer_load_dwordx4 v38, s[24:27], s69 offen offset:3072 lds
    v_mfma_f32_16x16x32_bf16 v[132:135], v[76:79], a[88:91], v[132:135]
    s_waitcnt lgkmcnt(6)
    ds_read_b64_tr_b16 v[68:69], v12 offset:57344
    ds_read_b64_tr_b16 v[70:71], v12 offset:57856
    v_mfma_f32_16x16x32_bf16 v[132:135], v[72:75], a[80:83], v[132:135]
    s_add_u32 s69, s69, 40960
    v_pk_max_i16 v205, v205, 0
    v_mfma_f32_16x16x32_bf16 v[144:147], v[80:83], a[80:83], v[144:147]
    s_add_u32 m0, s44, 147456
    ds_read_b64_tr_b16 v[72:73], v13 offset:49152
    ds_read_b64_tr_b16 v[74:75], v13 offset:49664
    v_mfma_f32_16x16x32_bf16 v[144:147], v[84:87], a[88:91], v[144:147]
    buffer_load_dwordx4 v35, s[24:27], s69 offen offset:0 lds
    v_mfma_f32_16x16x32_bf16 v[152:155], v[84:87], a[92:95], v[152:155]
    s_waitcnt lgkmcnt(6)
    ds_read_b64_tr_b16 v[76:77], v13 offset:57344
    ds_read_b64_tr_b16 v[78:79], v13 offset:57856
    v_mfma_f32_16x16x32_bf16 v[152:155], v[80:83], a[84:87], v[152:155]
    v_pk_max_i16 v206, v206, 0
    v_pk_max_i16 v207, v207, 0
    v_mfma_f32_16x16x32_bf16 v[156:159], v[88:91], a[84:87], v[156:159]
    s_waitcnt lgkmcnt(6)
    ds_read_b64_tr_b16 v[80:81], v14 offset:49152
    ds_read_b64_tr_b16 v[82:83], v14 offset:49664
    v_mfma_f32_16x16x32_bf16 v[156:159], v[92:95], a[92:95], v[156:159]
    buffer_load_dwordx4 v36, s[24:27], s69 offen offset:1024 lds
    v_mfma_f32_16x16x32_bf16 v[148:151], v[92:95], a[88:91], v[148:151]
    s_waitcnt lgkmcnt(6)
    ds_read_b64_tr_b16 v[84:85], v14 offset:57344
    ds_read_b64_tr_b16 v[86:87], v14 offset:57856
    v_mfma_f32_16x16x32_bf16 v[148:151], v[88:91], a[80:83], v[148:151]
    buffer_store_dwordx4 v[204:207], v31, s[20:23], s95 offen offset:512 sc1
    v_mfma_f32_16x16x32_bf16 v[128:131], v[64:67], a[96:99], v[128:131]
    s_waitcnt lgkmcnt(6)
    ds_read_b64_tr_b16 v[88:89], v15 offset:49152
    ds_read_b64_tr_b16 v[90:91], v15 offset:49664
    v_mfma_f32_16x16x32_bf16 v[128:131], v[68:71], a[104:107], v[128:131]
    buffer_load_dwordx4 v37, s[24:27], s69 offen offset:2048 lds
    v_mfma_f32_16x16x32_bf16 v[136:139], v[68:71], a[108:111], v[136:139]
    s_waitcnt lgkmcnt(6)
    ds_read_b64_tr_b16 v[92:93], v15 offset:57344
    ds_read_b64_tr_b16 v[94:95], v15 offset:57856
    v_mfma_f32_16x16x32_bf16 v[136:139], v[64:67], a[100:103], v[136:139]
    s_waitcnt vmcnt(33)
    v_lshlrev_b32 v252, 16, v208
    v_and_b32 v253, 0xffff0000, v208
    v_mfma_f32_16x16x32_bf16 v[140:143], v[72:75], a[100:103], v[140:143]
    s_waitcnt lgkmcnt(6)
    ds_read_b64_tr_b16 v[64:65], v12 offset:51200
    ds_read_b64_tr_b16 v[66:67], v12 offset:51712
    v_mfma_f32_16x16x32_bf16 v[140:143], v[76:79], a[108:111], v[140:143]
    buffer_load_dwordx4 v38, s[24:27], s69 offen offset:3072 lds
    v_mfma_f32_16x16x32_bf16 v[132:135], v[76:79], a[104:107], v[132:135]
    s_waitcnt lgkmcnt(6)
    ds_read_b64_tr_b16 v[68:69], v12 offset:59392
    ds_read_b64_tr_b16 v[70:71], v12 offset:59904
    v_mfma_f32_16x16x32_bf16 v[132:135], v[72:75], a[96:99], v[132:135]
L_pad3:
    s_cmp_eq_u32 s92, 1
    s_cbranch_scc1 L_pad7
    s_add_u32 s69, s69, 40960
    v_mul_f32 v252, 0x3ea52b5c, v252
    v_mul_f32 v253, 0x3ea52b5c, v253
    v_mfma_f32_16x16x32_bf16 v[144:147], v[80:83], a[96:99], v[144:147]
    s_waitcnt lgkmcnt(6)
    ds_read_b64_tr_b16 v[72:73], v13 offset:51200
    ds_read_b64_tr_b16 v[74:75], v13 offset:51712
    v_mfma_f32_16x16x32_bf16 v[144:147], v[84:87], a[104:107], v[144:147]
    v_cvt_pk_bf16_f32 v208, v252, v253
    v_lshlrev_b32 v252, 16, v209
    v_mfma_f32_16x16x32_bf16 v[152:155], v[84:87], a[108:111], v[152:155]
    s_waitcnt lgkmcnt(6)
    ds_read_b64_tr_b16 v[76:77], v13 offset:59392
    ds_read_b64_tr_b16 v[78:79], v13 offset:59904
    v_mfma_f32_16x16x32_bf16 v[152:155], v[80:83], a[100:103], v[152:155]
    v_and_b32 v253, 0xffff0000, v209
    v_mul_f32 v252, 0x3ea52b5c, v252
    v_mfma_f32_16x16x32_bf16 v[156:159], v[88:91], a[100:103], v[156:159]
    s_waitcnt lgkmcnt(6)
    ds_read_b64_tr_b16 v[80:81], v14 offset:51200
    ds_read_b64_tr_b16 v[82:83], v14 offset:51712
    v_mfma_f32_16x16x32_bf16 v[156:159], v[92:95], a[108:111], v[156:159]
    v_mul_f32 v253, 0x3ea52b5c, v253
    v_cvt_pk_bf16_f32 v209, v252, v253
    v_mfma_f32_16x16x32_bf16 v[148:151], v[92:95], a[104:107], v[148:151]
    s_waitcnt lgkmcnt(6)
    ds_read_b64_tr_b16 v[84:85], v14 offset:59392
    ds_read_b64_tr_b16 v[86:87], v14 offset:59904
    v_mfma_f32_16x16x32_bf16 v[148:151], v[88:91], a[96:99], v[148:151]
    v_lshlrev_b32 v252, 16, v210
    v_and_b32 v253, 0xffff0000, v210
    v_mfma_f32_16x16x32_bf16 v[128:131], v[64:67], a[112:115], v[128:131]
    s_waitcnt lgkmcnt(6)
    ds_read_b64_tr_b16 v[88:89], v15 offset:51200
    ds_read_b64_tr_b16 v[90:91], v15 offset:51712
    v_mfma_f32_16x16x32_bf16 v[128:131], v[68:71], a[120:123], v[128:131]
    v_mul_f32 v252, 0x3ea52b5c, v252
    v_mul_f32 v253, 0x3ea52b5c, v253
    v_mfma_f32_16x16x32_bf16 v[136:139], v[68:71], a[124:127], v[136:139]
    s_waitcnt lgkmcnt(6)
    ds_read_b64_tr_b16 v[92:93], v15 offset:59392
    ds_read_b64_tr_b16 v[94:95], v15 offset:59904
    v_mfma_f32_16x16x32_bf16 v[136:139], v[64:67], a[116:119], v[136:139]
    s_waitcnt vmcnt(24)
    s_barrier
    v_cvt_pk_bf16_f32 v210, v252, v253
    v_mfma_f32_16x16x32_bf16 v[140:143], v[72:75], a[116:119], v[140:143]
    s_waitcnt lgkmcnt(6)
    ds_read_b64_tr_b16 v[64:65], v12 offset:0
    ds_read_b64_tr_b16 v[66:67], v12 offset:512
    v_mfma_f32_16x16x32_bf16 v[140:143], v[76:79], a[124:127], v[140:143]
    v_lshlrev_b32 v252, 16, v211
    v_and_b32 v253, 0xffff0000, v211
    v_mfma_f32_16x16x32_bf16 v[132:135], v[76:79], a[120:123], v[132:135]
    s_waitcnt lgkmcnt(6)
    ds_read_b64_tr_b16 v[68:69], v12 offset:8192
    ds_read_b64_tr_b16 v[70:71], v12 offset:8704
    v_mfma_f32_16x16x32_bf16 v[132:135], v[72:75], a[112:115], v[132:135]
    v_mul_f32 v252, 0x3ea52b5c, v252
    v_mul_f32 v253, 0x3ea52b5c, v253
    v_mfma_f32_16x16x32_bf16 v[144:147], v[80:83], a[112:115], v[144:147]
    s_waitcnt lgkmcnt(6)
    ds_read_b64_tr_b16 v[72:73], v13 offset:0
    ds_read_b64_tr_b16 v[74:75], v13 offset:512
    v_mfma_f32_16x16x32_bf16 v[144:147], v[84:87], a[120:123], v[144:147]
    v_cvt_pk_bf16_f32 v211, v252, v253
    s_waitcnt vmcnt(23)
    v_lshlrev_b32 v252, 16, v212
    v_mfma_f32_16x16x32_bf16 v[152:155], v[84:87], a[124:127], v[152:155]
    s_waitcnt lgkmcnt(6)
    ds_read_b64_tr_b16 v[76:77], v13 offset:8192
    ds_read_b64_tr_b16 v[78:79], v13 offset:8704
    v_mfma_f32_16x16x32_bf16 v[152:155], v[80:83], a[116:119], v[152:155]
    v_and_b32 v253, 0xffff0000, v212
    v_mul_f32 v252, 0x3ea52b5c, v252
    v_mfma_f32_16x16x32_bf16 v[156:159], v[88:91], a[116:119], v[156:159]
    s_waitcnt lgkmcnt(6)
    ds_read_b64_tr_b16 v[80:81], v12 offset:2048
    ds_read_b64_tr_b16 v[82:83], v12 offset:2560
    v_mfma_f32_16x16x32_bf16 v[156:159], v[92:95], a[124:127], v[156:159]
    v_mul_f32 v253, 0x3ea52b5c, v253
    v_cvt_pk_bf16_f32 v212, v252, v253
    v_mfma_f32_16x16x32_bf16 v[148:151], v[92:95], a[120:123], v[148:151]
    s_waitcnt lgkmcnt(6)
    ds_read_b64_tr_b16 v[84:85], v12 offset:10240
    ds_read_b64_tr_b16 v[86:87], v12 offset:10752
    v_mfma_f32_16x16x32_bf16 v[148:151], v[88:91], a[112:115], v[148:151]
    v_lshlrev_b32 v252, 16, v213
    v_and_b32 v253, 0xffff0000, v213
    v_mfma_f32_16x16x32_bf16 v[128:131], v[64:67], a[128:131], v[128:131]
    s_waitcnt lgkmcnt(6)
    ds_read_b64_tr_b16 v[88:89], v13 offset:2048
    ds_read_b64_tr_b16 v[90:91], v13 offset:2560
    v_mfma_f32_16x16x32_bf16 v[128:131], v[68:71], a[136:139], v[128:131]
    v_mul_f32 v252, 0x3ea52b5c, v252
    v_mul_f32 v253, 0x3ea52b5c, v253
    v_mfma_f32_16x16x32_bf16 v[136:139], v[68:71], a[140:143], v[136:139]
    s_waitcnt lgkmcnt(6)
    ds_read_b64_tr_b16 v[92:93], v13 offset:10240
    ds_read_b64_tr_b16 v[94:95], v13 offset:10752
    v_mfma_f32_16x16x32_bf16 v[136:139], v[64:67], a[132:135], v[136:139]
    s_waitcnt vmcnt(12)
    s_barrier
    v_mfma_f32_16x16x32_bf16 v[140:143], v[72:75], a[132:135], v[140:143]
    s_waitcnt lgkmcnt(6)
    ds_read_b64_tr_b16 v[64:65], v14 offset:0
    ds_read_b64_tr_b16 v[66:67], v14 offset:512
    v_mfma_f32_16x16x32_bf16 v[140:143], v[76:79], a[140:143], v[140:143]
    s_nop 0
    ds_read_b128 v[112:115], v220 offset:0
    ds_read_b64 v[124:125], v221 offset:256
    v_mfma_f32_16x16x32_bf16 v[132:135], v[76:79], a[136:139], v[132:135]
    s_waitcnt lgkmcnt(8)
    ds_read_b64_tr_b16 v[68:69], v14 offset:8192
    ds_read_b64_tr_b16 v[70:71], v14 offset:8704
    v_mfma_f32_16x16x32_bf16 v[132:135], v[72:75], a[128:131], v[132:135]
    ds_read_b128 v[116:119], v224 offset:32768
    v_cvt_pk_bf16_f32 v213, v252, v253
    v_mfma_f32_16x16x32_bf16 v[128:131], v[80:83], a[144:147], v[128:131]
    s_waitcnt lgkmcnt(9)
    ds_read_b64_tr_b16 v[72:73], v15 offset:0
    ds_read_b64_tr_b16 v[74:75], v15 offset:512
    v_mfma_f32_16x16x32_bf16 v[128:131], v[84:87], a[152:155], v[128:131]
    v_lshlrev_b32 v252, 16, v214
    v_and_b32 v253, 0xffff0000, v214
    v_mfma_f32_16x16x32_bf16 v[136:139], v[84:87], a[156:159], v[136:139]
    s_waitcnt lgkmcnt(9)
    ds_read_b64_tr_b16 v[76:77], v15 offset:8192
    ds_read_b64_tr_b16 v[78:79], v15 offset:8704
    v_mfma_f32_16x16x32_bf16 v[136:139], v[80:83], a[148:151], v[136:139]
    v_mul_f32 v252, 0x3ea52b5c, v252
    v_mul_f32 v253, 0x3ea52b5c, v253
    v_mfma_f32_16x16x32_bf16 v[140:143], v[88:91], a[148:151], v[140:143]
    s_waitcnt lgkmcnt(9)
    ds_read_b64_tr_b16 v[80:81], v14 offset:2048
    ds_read_b64_tr_b16 v[82:83], v14 offset:2560
    v_mfma_f32_16x16x32_bf16 v[140:143], v[92:95], a[156:159], v[140:143]
    v_cvt_pk_bf16_f32 v214, v252, v253
    v_lshlrev_b32 v252, 16, v215
    v_mfma_f32_16x16x32_bf16 v[132:135], v[92:95], a[152:155], v[132:135]
    s_waitcnt lgkmcnt(7)
    ds_read_b64_tr_b16 v[84:85], v14 offset:10240
    ds_read_b64_tr_b16 v[86:87], v14 offset:10752
    v_mfma_f32_16x16x32_bf16 v[132:135], v[88:91], a[144:147], v[132:135]
    v_and_b32 v253, 0xffff0000, v215
    v_mul_f32 v252, 0x3ea52b5c, v252
    v_mfma_f32_16x16x32_bf16 v[144:147], v[64:67], a[128:131], v[144:147]
    s_waitcnt lgkmcnt(6)
    ds_read_b64_tr_b16 v[88:89], v15 offset:2048
    ds_read_b64_tr_b16 v[90:91], v15 offset:2560
    v_mfma_f32_16x16x32_bf16 v[144:147], v[68:71], a[136:139], v[144:147]
    v_mul_f32 v253, 0x3ea52b5c, v253
    v_cvt_pk_bf16_f32 v215, v252, v253
    v_mfma_f32_16x16x32_bf16 v[152:155], v[68:71], a[140:143], v[152:155]
    s_waitcnt lgkmcnt(6)
    ds_read_b64_tr_b16 v[92:93], v15 offset:10240
    ds_read_b64_tr_b16 v[94:95], v15 offset:10752
    v_mfma_f32_16x16x32_bf16 v[152:155], v[64:67], a[132:135], v[152:155]
    v_cvt_pk_bf16_f32 v192, v128, v129
    v_cvt_pk_bf16_f32 v193, v130, v131
    v_mfma_f32_16x16x32_bf16 v[156:159], v[72:75], a[132:135], v[156:159]
    s_waitcnt lgkmcnt(6)
    v_mfma_f32_16x16x32_bf16 v[156:159], v[76:79], a[140:143], v[156:159]
    v_cvt_pk_bf16_f32 v194, v132, v133
    v_cvt_pk_bf16_f32 v195, v134, v135
    v_mfma_f32_16x16x32_bf16 v[148:151], v[76:79], a[136:139], v[148:151]
    s_waitcnt lgkmcnt(4)
    v_mfma_f32_16x16x32_bf16 v[148:151], v[72:75], a[128:131], v[148:151]
    v_pk_max_i16 v192, v192, 0
    v_pk_max_i16 v193, v193, 0
    v_mfma_f32_16x16x32_bf16 v[144:147], v[80:83], a[144:147], v[144:147]
    s_waitcnt lgkmcnt(2)
    v_mfma_f32_16x16x32_bf16 v[144:147], v[84:87], a[152:155], v[144:147]
    v_pk_max_i16 v194, v194, 0
    v_pk_max_i16 v195, v195, 0
    v_mfma_f32_16x16x32_bf16 v[152:155], v[84:87], a[156:159], v[152:155]
    s_waitcnt lgkmcnt(0)
    v_mfma_f32_16x16x32_bf16 v[152:155], v[80:83], a[148:151], v[152:155]
    buffer_store_dwordx4 v[192:195], v31, s[20:23], s96 offen offset:0 sc1
    v_mfma_f32_16x16x32_bf16 v[156:159], v[88:91], a[148:151], v[156:159]
    v_mfma_f32_16x16x32_bf16 v[156:159], v[92:95], a[156:159], v[156:159]
    v_lshlrev_b32 v252, 16, v216
    v_and_b32 v253, 0xffff0000, v216
    v_mfma_f32_16x16x32_bf16 v[148:151], v[92:95], a[152:155], v[148:151]
    v_mfma_f32_16x16x32_bf16 v[148:151], v[88:91], a[144:147], v[148:151]
    v_mul_f32 v252, 0x3ea52b5c, v252
    v_mul_f32 v253, 0x3ea52b5c, v253
    v_cvt_pk_bf16_f32 v216, v252, v253
    v_lshlrev_b32 v252, 16, v217
    v_and_b32 v253, 0xffff0000, v217
    v_mul_f32 v252, 0x3ea52b5c, v252
    v_mul_f32 v253, 0x3ea52b5c, v253
    v_cvt_pk_bf16_f32 v217, v252, v253
    v_cndmask_b32 v218, v216, 0, s[98:99]
    v_cndmask_b32 v216, 0, v216, s[98:99]
    v_cndmask_b32 v219, v217, 0, s[98:99]
    v_cndmask_b32 v217, 0, v217, s[98:99]
    v_mfma_f32_32x32x16_bf16 v[64:79], v[112:115], v[208:211], v[160:175]
    ds_read_b128 v[112:115], v220 offset:384
    v_cvt_pk_bf16_f32 v196, v136, v137
    v_cvt_pk_bf16_f32 v197, v138, v139
    v_cvt_pk_bf16_f32 v198, v140, v141
    v_cvt_pk_bf16_f32 v199, v142, v143
    v_pk_max_i16 v196, v196, 0
    v_pk_max_i16 v197, v197, 0
    v_pk_max_i16 v198, v198, 0
    v_pk_max_i16 v199, v199, 0
    buffer_store_dwordx4 v[196:199], v31, s[20:23], s96 offen offset:512 sc1
    v_mfma_f32_32x32x8_bf16 v[64:79], v[124:125], v[216:217], v[64:79]
    v_cvt_pk_bf16_f32 v200, v144, v145
    v_cvt_pk_bf16_f32 v201, v146, v147
    v_cvt_pk_bf16_f32 v202, v148, v149
    v_cvt_pk_bf16_f32 v203, v150, v151
    v_pk_max_i16 v200, v200, 0
    v_pk_max_i16 v201, v201, 0
    v_pk_max_i16 v202, v202, 0
    v_pk_max_i16 v203, v203, 0
    v_cvt_pk_bf16_f32 v204, v152, v153
    v_cvt_pk_bf16_f32 v205, v154, v155
    v_cvt_pk_bf16_f32 v206, v156, v157
    v_cvt_pk_bf16_f32 v207, v158, v159
    v_pk_max_i16 v204, v204, 0
    v_pk_max_i16 v205, v205, 0
    v_pk_max_i16 v206, v206, 0
    v_pk_max_i16 v207, v207, 0
    s_waitcnt lgkmcnt(0)
    v_mfma_f32_32x32x16_bf16 v[80:95], v[112:115], v[212:215], v[160:175]
    ds_read_b128 v[112:115], v220 offset:2560
    buffer_store_dwordx4 v[200:203], v31, s[20:23], s97 offen offset:0 sc1
    v_exp_f32 v96, v64
    v_exp_f32 v97, v65
    v_exp_f32 v98, v66
    v_exp_f32 v99, v67
    ds_read_b128 v[120:123], v225 offset:32768
    v_cvt_pk_bf16_f32 v104, v96, v97
    v_cvt_pk_bf16_f32 v105, v98, v99
    v_exp_f32 v100, v68
    v_exp_f32 v101, v69
    v_exp_f32 v102, v70
    v_exp_f32 v103, v71
    v_mfma_f32_32x32x8_bf16 v[80:95], v[124:125], v[218:219], v[80:95]
    ds_read_b64 v[124:125], v221 offset:2816
    buffer_store_dwordx4 v[204:207], v31, s[20:23], s97 offen offset:512 sc1
    v_cvt_pk_bf16_f32 v106, v100, v101
    v_cvt_pk_bf16_f32 v107, v102, v103
    v_exp_f32 v96, v72
    v_exp_f32 v97, v73
    v_exp_f32 v98, v74
    v_exp_f32 v99, v75
    v_mfma_f32_32x32x16_bf16 v[128:143], v[116:119], v[104:107], 0
    s_waitcnt lgkmcnt(2)
    ds_read_b128 v[116:119], v228 offset:32768
    s_add_u32 m0, s44, 131072
    v_cvt_pk_bf16_f32 v108, v96, v97
    v_cvt_pk_bf16_f32 v109, v98, v99
    v_exp_f32 v100, v76
    v_exp_f32 v101, v77
    v_exp_f32 v102, v78
    v_exp_f32 v103, v79
    v_mfma_f32_32x32x16_bf16 v[64:79], v[112:115], v[208:211], 0
    s_waitcnt lgkmcnt(2)
    ds_read_b128 v[112:115], v220 offset:2944
    buffer_load_dwordx4 v35, s[24:27], s69 offen offset:0 lds
    v_cvt_pk_bf16_f32 v110, v100, v101
    v_cvt_pk_bf16_f32 v111, v102, v103
    v_exp_f32 v96, v80
    v_exp_f32 v97, v81
    v_exp_f32 v98, v82
    v_exp_f32 v99, v83
    v_mfma_f32_32x32x16_bf16 v[128:143], v[120:123], v[108:111], v[128:143]
    s_waitcnt lgkmcnt(2)
    ds_read_b128 v[120:123], v229 offset:32768
    buffer_load_dwordx4 v36, s[24:27], s69 offen offset:1024 lds
    v_cvt_pk_bf16_f32 v104, v96, v97
    v_cvt_pk_bf16_f32 v105, v98, v99
    v_exp_f32 v100, v84
    v_exp_f32 v101, v85
    v_exp_f32 v102, v86
    v_exp_f32 v103, v87
    v_mfma_f32_32x32x8_bf16 v[64:79], v[124:125], v[216:217], v[64:79]
    s_waitcnt lgkmcnt(2)
    v_cvt_pk_bf16_f32 v106, v100, v101
    v_cvt_pk_bf16_f32 v107, v102, v103
    v_exp_f32 v96, v88
    v_exp_f32 v97, v89
    v_exp_f32 v98, v90
    v_exp_f32 v99, v91
    v_mfma_f32_32x32x16_bf16 v[144:159], v[116:119], v[104:107], 0
    s_waitcnt lgkmcnt(1)
    ds_read_b128 v[116:119], v226 offset:32768
    buffer_load_dwordx4 v37, s[24:27], s69 offen offset:2048 lds
    v_cvt_pk_bf16_f32 v108, v96, v97
    v_cvt_pk_bf16_f32 v109, v98, v99
    v_exp_f32 v100, v92
    v_exp_f32 v101, v93
    v_exp_f32 v102, v94
    v_exp_f32 v103, v95
    v_mfma_f32_32x32x16_bf16 v[80:95], v[112:115], v[212:215], 0
    s_waitcnt lgkmcnt(1)
    ds_read_b128 v[112:115], v220 offset:5120
    v_cvt_pk_bf16_f32 v110, v100, v101
    v_cvt_pk_bf16_f32 v111, v102, v103
    v_exp_f32 v96, v64
    v_exp_f32 v97, v65
    v_exp_f32 v98, v66
    v_exp_f32 v99, v67
    v_mfma_f32_32x32x16_bf16 v[144:159], v[120:123], v[108:111], v[144:159]
    ds_read_b128 v[120:123], v227 offset:32768
    buffer_load_dwordx4 v38, s[24:27], s69 offen offset:3072 lds
    s_add_u32 s69, s69, 40960
    v_cvt_pk_bf16_f32 v104, v96, v97
    v_cvt_pk_bf16_f32 v105, v98, v99
    v_exp_f32 v100, v68
    v_exp_f32 v101, v69
    v_exp_f32 v102, v70
    v_exp_f32 v103, v71
    v_mfma_f32_32x32x8_bf16 v[80:95], v[124:125], v[218:219], v[80:95]
    s_waitcnt lgkmcnt(2)
    ds_read_b64 v[124:125], v221 offset:5376
    s_add_u32 m0, s44, 98304
    v_cvt_pk_bf16_f32 v106, v100, v101
    v_cvt_pk_bf16_f32 v107, v102, v103
    v_exp_f32 v96, v72
    v_exp_f32 v97, v73
    v_exp_f32 v98, v74
    v_exp_f32 v99, v75
    v_mfma_f32_32x32x16_bf16 v[128:143], v[116:119], v[104:107], v[128:143]
    s_waitcnt lgkmcnt(2)
    ds_read_b128 v[116:119], v230 offset:32768
    buffer_load_dwordx4 v35, s[24:27], s69 offen offset:0 lds
    v_cvt_pk_bf16_f32 v108, v96, v97
    v_cvt_pk_bf16_f32 v109, v98, v99
    v_exp_f32 v100, v76
    v_exp_f32 v101, v77
    v_exp_f32 v102, v78
    v_exp_f32 v103, v79
    v_mfma_f32_32x32x16_bf16 v[64:79], v[112:115], v[208:211], 0
    s_waitcnt lgkmcnt(2)
    ds_read_b128 v[112:115], v220 offset:5504
    buffer_load_dwordx4 v36, s[24:27], s69 offen offset:1024 lds
    v_cvt_pk_bf16_f32 v110, v100, v101
    v_cvt_pk_bf16_f32 v111, v102, v103
    v_exp_f32 v96, v80
    v_exp_f32 v97, v81
    v_exp_f32 v98, v82
    v_exp_f32 v99, v83
    v_mfma_f32_32x32x16_bf16 v[128:143], v[120:123], v[108:111], v[128:143]
    s_waitcnt lgkmcnt(2)
    ds_read_b128 v[120:123], v231 offset:32768
    v_cvt_pk_bf16_f32 v104, v96, v97
    v_cvt_pk_bf16_f32 v105, v98, v99
    v_exp_f32 v100, v84
    v_exp_f32 v101, v85
    v_exp_f32 v102, v86
    v_exp_f32 v103, v87
    v_mfma_f32_32x32x8_bf16 v[64:79], v[124:125], v[216:217], v[64:79]
    s_waitcnt lgkmcnt(2)
    buffer_load_dwordx4 v37, s[24:27], s69 offen offset:2048 lds
    v_cvt_pk_bf16_f32 v106, v100, v101
    v_cvt_pk_bf16_f32 v107, v102, v103
    v_exp_f32 v96, v88
    v_exp_f32 v97, v89
    v_exp_f32 v98, v90
    v_exp_f32 v99, v91
    v_mfma_f32_32x32x16_bf16 v[144:159], v[116:119], v[104:107], v[144:159]
    s_waitcnt lgkmcnt(1)
    ds_read_b128 v[116:119], v224 offset:37904
    v_cvt_pk_bf16_f32 v108, v96, v97
    v_cvt_pk_bf16_f32 v109, v98, v99
    v_exp_f32 v100, v92
    v_exp_f32 v101, v93
    v_exp_f32 v102, v94
    v_exp_f32 v103, v95
    v_mfma_f32_32x32x16_bf16 v[80:95], v[112:115], v[212:215], 0
    s_waitcnt lgkmcnt(1)
    ds_read_b128 v[112:115], v220 offset:7680
    buffer_load_dwordx4 v38, s[24:27], s69 offen offset:3072 lds
    s_add_u32 s69, s69, 40960
    s_waitcnt vmcnt(8)
    s_barrier
    buffer_store_dword v53, v51, s[20:23], 0 offen offset:128 sc1
    v_cvt_pk_bf16_f32 v110, v100, v101
    v_cvt_pk_bf16_f32 v111, v102, v103
    v_exp_f32 v96, v64
    v_exp_f32 v97, v65
    v_exp_f32 v98, v66
    v_exp_f32 v99, v67
    v_mfma_f32_32x32x16_bf16 v[144:159], v[120:123], v[108:111], v[144:159]
    ds_read_b128 v[120:123], v225 offset:37904
    s_add_u32 m0, s44, 114688
    v_cvt_pk_bf16_f32 v104, v96, v97
    v_cvt_pk_bf16_f32 v105, v98, v99
    v_exp_f32 v100, v68
    v_exp_f32 v101, v69
    v_exp_f32 v102, v70
    v_exp_f32 v103, v71
    v_mfma_f32_32x32x8_bf16 v[80:95], v[124:125], v[218:219], v[80:95]
    s_waitcnt lgkmcnt(2)
    ds_read_b64 v[124:125], v221 offset:7936
    buffer_load_dwordx4 v35, s[24:27], s69 offen offset:0 lds
    buffer_load_dwordx4 v36, s[24:27], s69 offen offset:1024 lds
    v_cvt_pk_bf16_f32 v106, v100, v101
    v_cvt_pk_bf16_f32 v107, v102, v103
    v_exp_f32 v96, v72
    v_exp_f32 v97, v73
    v_exp_f32 v98, v74
    v_exp_f32 v99, v75
    v_mfma_f32_32x32x16_bf16 v[128:143], v[116:119], v[104:107], v[128:143]
    s_waitcnt lgkmcnt(2)
    ds_read_b128 v[116:119], v228 offset:37904
    buffer_load_dwordx4 v37, s[24:27], s69 offen offset:2048 lds
    v_cvt_pk_bf16_f32 v108, v96, v97
    v_cvt_pk_bf16_f32 v109, v98, v99
    v_exp_f32 v100, v76
    v_exp_f32 v101, v77
    v_exp_f32 v102, v78
    v_exp_f32 v103, v79
    v_mfma_f32_32x32x16_bf16 v[64:79], v[112:115], v[208:211], 0
    s_waitcnt lgkmcnt(2)
    ds_read_b128 v[112:115], v220 offset:8064
    ds_read_b64_tr_b16 a[208:209], v41 offset:16384
    ds_read_b64_tr_b16 a[210:211], v41 offset:16896
    buffer_load_dwordx4 v38, s[24:27], s69 offen offset:3072 lds
    s_add_u32 s69, s69, 40960
    s_add_u32 m0, s44, 65536
    v_cvt_pk_bf16_f32 v110, v100, v101
    v_cvt_pk_bf16_f32 v111, v102, v103
    v_exp_f32 v96, v80
    v_exp_f32 v97, v81
    v_exp_f32 v98, v82
    v_exp_f32 v99, v83
    v_mfma_f32_32x32x16_bf16 v[128:143], v[120:123], v[108:111], v[128:143]
    s_waitcnt lgkmcnt(4)
    ds_read_b128 v[120:123], v229 offset:37904
    ds_read_b64_tr_b16 a[212:213], v42 offset:16384
    ds_read_b64_tr_b16 a[214:215], v42 offset:16896
    buffer_load_dwordx4 v35, s[24:27], s69 offen offset:0 lds
    v_cvt_pk_bf16_f32 v104, v96, v97
    v_cvt_pk_bf16_f32 v105, v98, v99
    v_exp_f32 v100, v84
    v_exp_f32 v101, v85
    v_exp_f32 v102, v86
    v_exp_f32 v103, v87
    v_mfma_f32_32x32x8_bf16 v[64:79], v[124:125], v[216:217], v[64:79]
    s_waitcnt lgkmcnt(6)
    ds_read_b64_tr_b16 a[216:217], v43 offset:16384
    ds_read_b64_tr_b16 a[218:219], v43 offset:16896
    buffer_load_dwordx4 v36, s[24:27], s69 offen offset:1024 lds
    v_cvt_pk_bf16_f32 v106, v100, v101
    v_cvt_pk_bf16_f32 v107, v102, v103
    v_exp_f32 v96, v88
    v_exp_f32 v97, v89
    v_exp_f32 v98, v90
    v_exp_f32 v99, v91
    v_mfma_f32_32x32x16_bf16 v[144:159], v[116:119], v[104:107], v[144:159]
    s_waitcnt lgkmcnt(7)
    ds_read_b128 v[116:119], v226 offset:37904
    ds_read_b64_tr_b16 a[220:221], v44 offset:16384
    ds_read_b64_tr_b16 a[222:223], v44 offset:16896
    buffer_load_dwordx4 v37, s[24:27], s69 offen offset:2048 lds
    v_cvt_pk_bf16_f32 v108, v96, v97
    v_cvt_pk_bf16_f32 v109, v98, v99
    v_exp_f32 v100, v92
    v_exp_f32 v101, v93
    v_exp_f32 v102, v94
    v_exp_f32 v103, v95
    v_mfma_f32_32x32x16_bf16 v[80:95], v[112:115], v[212:215], 0
    s_waitcnt lgkmcnt(7)
    ds_read_b128 v[112:115], v220 offset:10240
    ds_read_b64_tr_b16 a[224:225], v45 offset:16384
    ds_read_b64_tr_b16 a[226:227], v45 offset:16896
    buffer_load_dwordx4 v38, s[24:27], s69 offen offset:3072 lds
    s_add_u32 s69, s69, 40960
    s_add_u32 m0, s44, 81920
    v_cvt_pk_bf16_f32 v110, v100, v101
    v_cvt_pk_bf16_f32 v111, v102, v103
    v_exp_f32 v96, v64
    v_exp_f32 v97, v65
    v_exp_f32 v98, v66
    v_exp_f32 v99, v67
    v_mfma_f32_32x32x16_bf16 v[144:159], v[120:123], v[108:111], v[144:159]
    ds_read_b128 v[120:123], v227 offset:37904
    ds_read_b64_tr_b16 a[228:229], v46 offset:16384
    ds_read_b64_tr_b16 a[230:231], v46 offset:16896
    s_waitcnt lgkmcnt(6)
    buffer_load_dwordx4 v35, s[24:27], s69 offen offset:0 lds
    v_cvt_pk_bf16_f32 v104, v96, v97
    v_cvt_pk_bf16_f32 v105, v98, v99
    v_exp_f32 v100, v68
    v_exp_f32 v101, v69
    v_exp_f32 v102, v70
    v_exp_f32 v103, v71
    v_mfma_f32_32x32x8_bf16 v[80:95], v[124:125], v[218:219], v[80:95]
    ds_read_b64 v[124:125], v221 offset:10496
    ds_read_b64_tr_b16 a[232:233], v241 offset:16384
    ds_read_b64_tr_b16 a[234:235], v241 offset:16896
    buffer_load_dwordx4 v36, s[24:27], s69 offen offset:1024 lds
    v_cvt_pk_bf16_f32 v106, v100, v101
    v_cvt_pk_bf16_f32 v107, v102, v103
    v_exp_f32 v96, v72
    v_exp_f32 v97, v73
    v_exp_f32 v98, v74
    v_exp_f32 v99, v75
    v_mfma_f32_32x32x16_bf16 v[128:143], v[116:119], v[104:107], v[128:143]
    s_waitcnt lgkmcnt(8)
    ds_read_b128 v[116:119], v230 offset:37904
    ds_read_b64_tr_b16 a[236:237], v242 offset:16384
    ds_read_b64_tr_b16 a[238:239], v242 offset:16896
    buffer_load_dwordx4 v37, s[24:27], s69 offen offset:2048 lds
    v_cvt_pk_bf16_f32 v108, v96, v97
    v_cvt_pk_bf16_f32 v109, v98, v99
    v_exp_f32 v100, v76
    v_exp_f32 v101, v77
    v_exp_f32 v102, v78
    v_exp_f32 v103, v79
    v_mfma_f32_32x32x16_bf16 v[64:79], v[112:115], v[208:211], 0
    s_waitcnt lgkmcnt(8)
    ds_read_b128 v[112:115], v220 offset:10624
    s_waitcnt vmcnt(16)
    ds_read_b64_tr_b16 a[240:241], v45 offset:0
    ds_read_b64_tr_b16 a[242:243], v45 offset:512
    buffer_load_dwordx4 v38, s[24:27], s69 offen offset:3072 lds
    s_add_u32 s69, s69, 40960
    s_add_u32 m0, s44, 147456
    v_cvt_pk_bf16_f32 v110, v100, v101
    v_cvt_pk_bf16_f32 v111, v102, v103
    v_exp_f32 v96, v80
    v_exp_f32 v97, v81
    v_exp_f32 v98, v82
    v_exp_f32 v99, v83
    v_mfma_f32_32x32x16_bf16 v[128:143], v[120:123], v[108:111], v[128:143]
    s_waitcnt lgkmcnt(8)
    ds_read_b128 v[120:123], v231 offset:37904
    ds_read_b64_tr_b16 a[244:245], v46 offset:0
    ds_read_b64_tr_b16 a[246:247], v46 offset:512
    s_waitcnt lgkmcnt(6)
    buffer_load_dwordx4 v35, s[24:27], s69 offen offset:0 lds
    buffer_load_dwordx4 v36, s[24:27], s69 offen offset:1024 lds
    v_cvt_pk_bf16_f32 v104, v96, v97
    v_cvt_pk_bf16_f32 v105, v98, v99
    v_exp_f32 v100, v84
    v_exp_f32 v101, v85
    v_exp_f32 v102, v86
    v_exp_f32 v103, v87
    v_mfma_f32_32x32x8_bf16 v[64:79], v[124:125], v[216:217], v[64:79]
    ds_read_b64_tr_b16 a[248:249], v241 offset:0
    ds_read_b64_tr_b16 a[250:251], v241 offset:512
    buffer_load_dwordx4 v37, s[24:27], s69 offen offset:2048 lds
    v_cvt_pk_bf16_f32 v106, v100, v101
    v_cvt_pk_bf16_f32 v107, v102, v103
    v_exp_f32 v96, v88
    v_exp_f32 v97, v89
    v_exp_f32 v98, v90
    v_exp_f32 v99, v91
    v_mfma_f32_32x32x16_bf16 v[144:159], v[116:119], v[104:107], v[144:159]
    s_waitcnt lgkmcnt(7)
    ds_read_b128 v[116:119], v224 offset:43040
    ds_read_b64_tr_b16 a[252:253], v242 offset:0
    ds_read_b64_tr_b16 a[254:255], v242 offset:512
    buffer_load_dwordx4 v38, s[24:27], s69 offen offset:3072 lds
    s_add_u32 s69, s69, 40960
    s_add_u32 m0, s44, 131072
    v_cvt_pk_bf16_f32 v108, v96, v97
    v_cvt_pk_bf16_f32 v109, v98, v99
    v_exp_f32 v100, v92
    v_exp_f32 v101, v93
    v_exp_f32 v102, v94
    v_exp_f32 v103, v95
    v_mfma_f32_32x32x16_bf16 v[80:95], v[112:115], v[212:215], 0
    s_waitcnt lgkmcnt(7)
    ds_read_b128 v[112:115], v220 offset:12800
    s_waitcnt vmcnt(17)
    ds_read_b64_tr_b16 a[80:81], v41 offset:32768
    ds_read_b64_tr_b16 a[82:83], v41 offset:33280
    s_waitcnt lgkmcnt(3)
    buffer_load_dwordx4 v35, s[24:27], s69 offen offset:0 lds
    v_cvt_pk_bf16_f32 v110, v100, v101
    v_cvt_pk_bf16_f32 v111, v102, v103
    v_exp_f32 v96, v64
    v_exp_f32 v97, v65
    v_exp_f32 v98, v66
    v_exp_f32 v99, v67
    v_mfma_f32_32x32x16_bf16 v[144:159], v[120:123], v[108:111], v[144:159]
    ds_read_b128 v[120:123], v225 offset:43040
    ds_read_b64_tr_b16 a[84:85], v42 offset:32768
    ds_read_b64_tr_b16 a[86:87], v42 offset:33280
    buffer_load_dwordx4 v36, s[24:27], s69 offen offset:1024 lds
    v_cvt_pk_bf16_f32 v104, v96, v97
    v_cvt_pk_bf16_f32 v105, v98, v99
    v_exp_f32 v100, v68
    v_exp_f32 v101, v69
    v_exp_f32 v102, v70
    v_exp_f32 v103, v71
    v_mfma_f32_32x32x8_bf16 v[80:95], v[124:125], v[218:219], v[80:95]
    ds_read_b64 v[124:125], v221 offset:13056
    ds_read_b64_tr_b16 a[88:89], v43 offset:32768
    ds_read_b64_tr_b16 a[90:91], v43 offset:33280
    buffer_load_dwordx4 v37, s[24:27], s69 offen offset:2048 lds
    v_cvt_pk_bf16_f32 v106, v100, v101
    v_cvt_pk_bf16_f32 v107, v102, v103
    v_exp_f32 v96, v72
    v_exp_f32 v97, v73
    v_exp_f32 v98, v74
    v_exp_f32 v99, v75
    v_mfma_f32_32x32x16_bf16 v[128:143], v[116:119], v[104:107], v[128:143]
    s_waitcnt lgkmcnt(8)
    ds_read_b128 v[116:119], v228 offset:43040
    ds_read_b64_tr_b16 a[92:93], v44 offset:32768
    ds_read_b64_tr_b16 a[94:95], v44 offset:33280
    buffer_load_dwordx4 v38, s[24:27], s69 offen offset:3072 lds
    s_add_u32 s69, s69, 40960
    s_add_u32 m0, s44, 98304
    v_cvt_pk_bf16_f32 v108, v96, v97
    v_cvt_pk_bf16_f32 v109, v98, v99
    v_exp_f32 v100, v76
    v_exp_f32 v101, v77
    v_exp_f32 v102, v78
    v_exp_f32 v103, v79
    v_mfma_f32_32x32x16_bf16 v[64:79], v[112:115], v[208:211], 0
    s_waitcnt lgkmcnt(8)
    ds_read_b128 v[112:115], v220 offset:13184
L_pad4:
    s_cmp_eq_u32 s92, 1
    s_cbranch_scc1 L_pad8
    s_waitcnt vmcnt(16)
    ds_read_b64_tr_b16 a[96:97], v41 offset:49152
    ds_read_b64_tr_b16 a[98:99], v41 offset:49664
    s_waitcnt lgkmcnt(3)
    buffer_load_dwordx4 v35, s[24:27], s69 offen offset:0 lds
    v_cvt_pk_bf16_f32 v110, v100, v101
    v_cvt_pk_bf16_f32 v111, v102, v103
    v_exp_f32 v96, v80
    v_exp_f32 v97, v81
    v_exp_f32 v98, v82
    v_exp_f32 v99, v83
    v_mfma_f32_32x32x16_bf16 v[128:143], v[120:123], v[108:111], v[128:143]
    ds_read_b128 v[120:123], v229 offset:43040
    ds_read_b64_tr_b16 a[100:101], v42 offset:49152
    ds_read_b64_tr_b16 a[102:103], v42 offset:49664
    buffer_load_dwordx4 v36, s[24:27], s69 offen offset:1024 lds
    v_cvt_pk_bf16_f32 v104, v96, v97
    v_cvt_pk_bf16_f32 v105, v98, v99
    v_exp_f32 v100, v84
    v_exp_f32 v101, v85
    v_exp_f32 v102, v86
    v_exp_f32 v103, v87
    v_mfma_f32_32x32x8_bf16 v[64:79], v[124:125], v[216:217], v[64:79]
    ds_read_b64_tr_b16 a[104:105], v43 offset:49152
    ds_read_b64_tr_b16 a[106:107], v43 offset:49664
    buffer_load_dwordx4 v37, s[24:27], s69 offen offset:2048 lds
    v_cvt_pk_bf16_f32 v106, v100, v101
    v_cvt_pk_bf16_f32 v107, v102, v103
    v_exp_f32 v96, v88
    v_exp_f32 v97, v89
    v_exp_f32 v98, v90
    v_exp_f32 v99, v91
    v_mfma_f32_32x32x16_bf16 v[144:159], v[116:119], v[104:107], v[144:159]
    s_waitcnt lgkmcnt(7)
    ds_read_b128 v[116:119], v226 offset:43040
    ds_read_b64_tr_b16 a[108:109], v44 offset:49152
    ds_read_b64_tr_b16 a[110:111], v44 offset:49664
    buffer_load_dwordx4 v38, s[24:27], s69 offen offset:3072 lds
    s_add_u32 s69, s69, 40960
    s_or_b32 s69, s69, s74
    s_add_u32 m0, s44, 114688
    v_cvt_pk_bf16_f32 v108, v96, v97
    v_cvt_pk_bf16_f32 v109, v98, v99
    v_exp_f32 v100, v92
    v_exp_f32 v101, v93
    v_exp_f32 v102, v94
    v_exp_f32 v103, v95
    v_mfma_f32_32x32x16_bf16 v[80:95], v[112:115], v[212:215], 0
    s_waitcnt lgkmcnt(7)
    ds_read_b128 v[112:115], v220 offset:15360
    s_waitcnt vmcnt(16)
    ds_read_b64_tr_b16 a[112:113], v41 offset:0
    ds_read_b64_tr_b16 a[114:115], v41 offset:512
    s_waitcnt lgkmcnt(3)
    buffer_load_dwordx4 v35, s[24:27], s69 offen offset:0 lds
    v_cvt_pk_bf16_f32 v110, v100, v101
    v_cvt_pk_bf16_f32 v111, v102, v103
    v_exp_f32 v96, v64
    v_exp_f32 v97, v65
    v_exp_f32 v98, v66
    v_exp_f32 v99, v67
    v_mfma_f32_32x32x16_bf16 v[144:159], v[120:123], v[108:111], v[144:159]
    ds_read_b128 v[120:123], v227 offset:43040
    ds_read_b64_tr_b16 a[116:117], v42 offset:0
    ds_read_b64_tr_b16 a[118:119], v42 offset:512
    buffer_load_dwordx4 v36, s[24:27], s69 offen offset:1024 lds
    v_cvt_pk_bf16_f32 v104, v96, v97
    v_cvt_pk_bf16_f32 v105, v98, v99
    v_exp_f32 v100, v68
    v_exp_f32 v101, v69
    v_exp_f32 v102, v70
    v_exp_f32 v103, v71
    v_mfma_f32_32x32x8_bf16 v[80:95], v[124:125], v[218:219], v[80:95]
    ds_read_b64 v[124:125], v221 offset:15616
    ds_read_b64_tr_b16 a[120:121], v43 offset:0
    ds_read_b64_tr_b16 a[122:123], v43 offset:512
    buffer_load_dwordx4 v37, s[24:27], s69 offen offset:2048 lds
    buffer_load_dword v56, v55, s[20:23], 0 offen offset:128 sc1
    v_cvt_pk_bf16_f32 v106, v100, v101
    v_cvt_pk_bf16_f32 v107, v102, v103
    v_exp_f32 v96, v72
    v_exp_f32 v97, v73
    v_exp_f32 v98, v74
    v_exp_f32 v99, v75
    v_mfma_f32_32x32x16_bf16 v[128:143], v[116:119], v[104:107], v[128:143]
    s_waitcnt lgkmcnt(8)
    ds_read_b128 v[116:119], v230 offset:43040
    ds_read_b64_tr_b16 a[124:125], v44 offset:0
    ds_read_b64_tr_b16 a[126:127], v44 offset:512
    buffer_load_dwordx4 v38, s[24:27], s69 offen offset:3072 lds
    s_add_u32 m0, s44, 65536
    v_cvt_pk_bf16_f32 v108, v96, v97
    v_cvt_pk_bf16_f32 v109, v98, v99
    v_exp_f32 v100, v76
    v_exp_f32 v101, v77
    v_exp_f32 v102, v78
    v_exp_f32 v103, v79
    v_mfma_f32_32x32x16_bf16 v[64:79], v[112:115], v[208:211], 0
    s_waitcnt lgkmcnt(8)
    ds_read_b128 v[112:115], v220 offset:15744
    s_waitcnt vmcnt(17)
    ds_read_b64_tr_b16 a[128:129], v41 offset:16384
    ds_read_b64_tr_b16 a[130:131], v41 offset:16896
    s_waitcnt lgkmcnt(3)
    buffer_load_dwordx4 v35, s[28:31], s70 offen offset:0 lds
    v_cvt_pk_bf16_f32 v110, v100, v101
    v_cvt_pk_bf16_f32 v111, v102, v103
    v_exp_f32 v96, v80
    v_exp_f32 v97, v81
    v_exp_f32 v98, v82
    v_exp_f32 v99, v83
    v_mfma_f32_32x32x16_bf16 v[128:143], v[120:123], v[108:111], v[128:143]
    ds_read_b128 v[120:123], v231 offset:43040
    ds_read_b64_tr_b16 a[132:133], v42 offset:16384
    ds_read_b64_tr_b16 a[134:135], v42 offset:16896
    buffer_load_dwordx4 v39, s[28:31], s70 offen offset:1024 lds
    v_cvt_pk_bf16_f32 v104, v96, v97
    v_cvt_pk_bf16_f32 v105, v98, v99
    v_exp_f32 v100, v84
    v_exp_f32 v101, v85
    v_exp_f32 v102, v86
    v_exp_f32 v103, v87
    v_mfma_f32_32x32x8_bf16 v[64:79], v[124:125], v[216:217], v[64:79]
    ds_read_b64_tr_b16 a[136:137], v43 offset:16384
    ds_read_b64_tr_b16 a[138:139], v43 offset:16896
    buffer_load_dwordx4 v37, s[28:31], s70 offen offset:2048 lds
    v_cvt_pk_bf16_f32 v106, v100, v101
    v_cvt_pk_bf16_f32 v107, v102, v103
    v_exp_f32 v96, v88
    v_exp_f32 v97, v89
    v_exp_f32 v98, v90
    v_exp_f32 v99, v91
    v_mfma_f32_32x32x16_bf16 v[144:159], v[116:119], v[104:107], v[144:159]
    s_waitcnt lgkmcnt(7)
    ds_read_b128 v[116:119], v224 offset:48176
    ds_read_b64_tr_b16 a[140:141], v44 offset:16384
    ds_read_b64_tr_b16 a[142:143], v44 offset:16896
    buffer_load_dwordx4 v40, s[28:31], s70 offen offset:3072 lds
    s_add_u32 s70, s70, 40960
    s_add_u32 m0, s44, 81920
    v_cvt_pk_bf16_f32 v108, v96, v97
    v_cvt_pk_bf16_f32 v109, v98, v99
    v_exp_f32 v100, v92
    v_exp_f32 v101, v93
    v_exp_f32 v102, v94
    v_exp_f32 v103, v95
    v_mfma_f32_32x32x16_bf16 v[80:95], v[112:115], v[212:215], 0
    s_waitcnt lgkmcnt(7)
    ds_read_b128 v[112:115], v220 offset:17920
    s_waitcnt vmcnt(17)
    ds_read_b64_tr_b16 a[144:145], v45 offset:16384
    ds_read_b64_tr_b16 a[146:147], v45 offset:16896
    s_waitcnt lgkmcnt(3)
    buffer_load_dwordx4 v35, s[28:31], s70 offen offset:0 lds
    v_cvt_pk_bf16_f32 v110, v100, v101
    v_cvt_pk_bf16_f32 v111, v102, v103
    v_exp_f32 v96, v64
    v_exp_f32 v97, v65
    v_exp_f32 v98, v66
    v_exp_f32 v99, v67
    v_mfma_f32_32x32x16_bf16 v[144:159], v[120:123], v[108:111], v[144:159]
    ds_read_b128 v[120:123], v225 offset:48176
    ds_read_b64_tr_b16 a[148:149], v46 offset:16384
    ds_read_b64_tr_b16 a[150:151], v46 offset:16896
    buffer_load_dwordx4 v39, s[28:31], s70 offen offset:1024 lds
    v_cvt_pk_bf16_f32 v104, v96, v97
    v_cvt_pk_bf16_f32 v105, v98, v99
    v_exp_f32 v100, v68
    v_exp_f32 v101, v69
    v_exp_f32 v102, v70
    v_exp_f32 v103, v71
    v_mfma_f32_32x32x8_bf16 v[80:95], v[124:125], v[218:219], v[80:95]
    ds_read_b64 v[124:125], v221 offset:18176
    ds_read_b64_tr_b16 a[152:153], v241 offset:16384
    ds_read_b64_tr_b16 a[154:155], v241 offset:16896
    buffer_load_dwordx4 v37, s[28:31], s70 offen offset:2048 lds
    v_cvt_pk_bf16_f32 v106, v100, v101
    v_cvt_pk_bf16_f32 v107, v102, v103
    v_exp_f32 v96, v72
    v_exp_f32 v97, v73
    v_exp_f32 v98, v74
    v_exp_f32 v99, v75
    v_mfma_f32_32x32x16_bf16 v[128:143], v[116:119], v[104:107], v[128:143]
    s_waitcnt lgkmcnt(8)
    ds_read_b128 v[116:119], v228 offset:48176
    ds_read_b64_tr_b16 a[156:157], v242 offset:16384
    ds_read_b64_tr_b16 a[158:159], v242 offset:16896
    buffer_load_dwordx4 v40, s[28:31], s70 offen offset:3072 lds
    s_add_u32 s70, s70, 40960
    s_add_u32 m0, s44, 147456
    v_cvt_pk_bf16_f32 v108, v96, v97
    v_cvt_pk_bf16_f32 v109, v98, v99
    v_exp_f32 v100, v76
    v_exp_f32 v101, v77
    v_exp_f32 v102, v78
    v_exp_f32 v103, v79
    v_mfma_f32_32x32x16_bf16 v[64:79], v[112:115], v[208:211], 0
    s_waitcnt lgkmcnt(8)
    ds_read_b128 v[112:115], v220 offset:18304
    s_waitcnt lgkmcnt(1)
    buffer_load_dwordx4 v35, s[28:31], s70 offen offset:0 lds
    buffer_load_dwordx4 v39, s[28:31], s70 offen offset:1024 lds
    v_cvt_pk_bf16_f32 v110, v100, v101
    v_cvt_pk_bf16_f32 v111, v102, v103
    v_exp_f32 v96, v80
    v_exp_f32 v97, v81
    v_exp_f32 v98, v82
    v_exp_f32 v99, v83
    v_mfma_f32_32x32x16_bf16 v[128:143], v[120:123], v[108:111], v[128:143]
    ds_read_b128 v[120:123], v229 offset:48176
    buffer_load_dwordx4 v37, s[28:31], s70 offen offset:2048 lds
    buffer_load_dwordx4 v40, s[28:31], s70 offen offset:3072 lds
    s_add_u32 s70, s70, 40960
    v_cvt_pk_bf16_f32 v104, v96, v97
    v_cvt_pk_bf16_f32 v105, v98, v99
    v_exp_f32 v100, v84
    v_exp_f32 v101, v85
    v_exp_f32 v102, v86
    v_exp_f32 v103, v87
    v_mfma_f32_32x32x8_bf16 v[64:79], v[124:125], v[216:217], v[64:79]
    s_waitcnt vmcnt(13)
    v_cmp_ne_u32 vcc, 1, v56
    s_nop 0
    s_cbranch_vccnz L_spin_15
L_ok_16:
    s_barrier
    buffer_load_dwordx4 a[0:3], v48, s[20:23], s71 offen offset:0 sc1
    v_cvt_pk_bf16_f32 v106, v100, v101
    v_cvt_pk_bf16_f32 v107, v102, v103
    v_exp_f32 v96, v88
    v_exp_f32 v97, v89
    v_exp_f32 v98, v90
    v_exp_f32 v99, v91
    v_mfma_f32_32x32x16_bf16 v[144:159], v[116:119], v[104:107], v[144:159]
    s_waitcnt lgkmcnt(1)
    ds_read_b128 v[116:119], v226 offset:48176
    buffer_load_dwordx4 a[4:7], v48, s[20:23], s72 offen offset:0 sc1
    v_cvt_pk_bf16_f32 v108, v96, v97
    v_cvt_pk_bf16_f32 v109, v98, v99
    v_exp_f32 v100, v92
    v_exp_f32 v101, v93
    v_exp_f32 v102, v94
    v_exp_f32 v103, v95
    v_mfma_f32_32x32x16_bf16 v[80:95], v[112:115], v[212:215], 0
    s_waitcnt lgkmcnt(1)
    ds_read_b128 v[112:115], v220 offset:20480
    buffer_load_dwordx4 a[8:11], v49, s[20:23], s71 offen offset:1024 sc1
    v_cvt_pk_bf16_f32 v110, v100, v101
    v_cvt_pk_bf16_f32 v111, v102, v103
    v_exp_f32 v96, v64
    v_exp_f32 v97, v65
    v_exp_f32 v98, v66
    v_exp_f32 v99, v67
    v_mfma_f32_32x32x16_bf16 v[144:159], v[120:123], v[108:111], v[144:159]
    ds_read_b128 v[120:123], v227 offset:48176
    buffer_load_dwordx4 a[12:15], v49, s[20:23], s72 offen offset:1024 sc1
    v_cvt_pk_bf16_f32 v104, v96, v97
    v_cvt_pk_bf16_f32 v105, v98, v99
    v_exp_f32 v100, v68
    v_exp_f32 v101, v69
    v_exp_f32 v102, v70
    v_exp_f32 v103, v71
    v_mfma_f32_32x32x8_bf16 v[80:95], v[124:125], v[218:219], v[80:95]
    s_waitcnt lgkmcnt(2)
    ds_read_b64 v[124:125], v221 offset:20736
    buffer_load_dwordx4 a[16:19], v50, s[20:23], s71 offen offset:2048 sc1
    v_cvt_pk_bf16_f32 v106, v100, v101
    v_cvt_pk_bf16_f32 v107, v102, v103
    v_exp_f32 v96, v72
    v_exp_f32 v97, v73
    v_exp_f32 v98, v74
    v_exp_f32 v99, v75
    v_mfma_f32_32x32x16_bf16 v[128:143], v[116:119], v[104:107], v[128:143]
    s_waitcnt lgkmcnt(2)
    ds_read_b128 v[116:119], v230 offset:48176
    buffer_load_dwordx4 a[20:23], v50, s[20:23], s72 offen offset:2048 sc1
    v_cvt_pk_bf16_f32 v108, v96, v97
    v_cvt_pk_bf16_f32 v109, v98, v99
    v_exp_f32 v100, v76
    v_exp_f32 v101, v77
    v_exp_f32 v102, v78
    v_exp_f32 v103, v79
    v_mfma_f32_32x32x16_bf16 v[64:79], v[112:115], v[208:211], v[176:191]
    s_waitcnt lgkmcnt(2)
    ds_read_b128 v[112:115], v220 offset:20864
    buffer_load_dwordx4 a[24:27], v52, s[20:23], s71 offen offset:3072 sc1
    v_cvt_pk_bf16_f32 v110, v100, v101
    v_cvt_pk_bf16_f32 v111, v102, v103
    v_exp_f32 v96, v80
    v_exp_f32 v97, v81
    v_exp_f32 v98, v82
    v_exp_f32 v99, v83
    v_mfma_f32_32x32x16_bf16 v[128:143], v[120:123], v[108:111], v[128:143]
    s_waitcnt lgkmcnt(2)
    ds_read_b128 v[120:123], v231 offset:48176
    buffer_load_dwordx4 a[28:31], v52, s[20:23], s72 offen offset:3072 sc1
    v_cvt_pk_bf16_f32 v104, v96, v97
    v_cvt_pk_bf16_f32 v105, v98, v99
    v_exp_f32 v100, v84
    v_exp_f32 v101, v85
    v_exp_f32 v102, v86
    v_exp_f32 v103, v87
    v_mfma_f32_32x32x8_bf16 v[64:79], v[124:125], v[216:217], v[64:79]
    s_waitcnt lgkmcnt(2)
    v_cvt_pk_bf16_f32 v106, v100, v101
    v_cvt_pk_bf16_f32 v107, v102, v103
    v_exp_f32 v96, v88
    v_exp_f32 v97, v89
    v_exp_f32 v98, v90
    v_exp_f32 v99, v91
    v_mfma_f32_32x32x16_bf16 v[144:159], v[116:119], v[104:107], v[144:159]
    s_waitcnt lgkmcnt(1)
    ds_read_b128 v[116:119], v224 offset:53312
    buffer_load_dwordx4 a[32:35], v222, s[20:23], s71 offen offset:0 sc1
    v_cvt_pk_bf16_f32 v108, v96, v97
    v_cvt_pk_bf16_f32 v109, v98, v99
    v_exp_f32 v100, v92
    v_exp_f32 v101, v93
    v_exp_f32 v102, v94
    v_exp_f32 v103, v95
    v_mfma_f32_32x32x16_bf16 v[80:95], v[112:115], v[212:215], v[176:191]
    s_waitcnt lgkmcnt(1)
    buffer_load_dwordx4 a[36:39], v222, s[20:23], s72 offen offset:0 sc1
    v_cvt_pk_bf16_f32 v110, v100, v101
    v_cvt_pk_bf16_f32 v111, v102, v103
    v_exp_f32 v96, v64
    v_exp_f32 v97, v65
    v_exp_f32 v98, v66
    v_exp_f32 v99, v67
    v_mfma_f32_32x32x16_bf16 v[144:159], v[120:123], v[108:111], v[144:159]
    ds_read_b128 v[120:123], v225 offset:53312
    buffer_load_dwordx4 a[40:43], v223, s[20:23], s71 offen offset:1024 sc1
    s_add_u32 s71, s71, 32768
    v_cvt_pk_bf16_f32 v104, v96, v97
    v_cvt_pk_bf16_f32 v105, v98, v99
    v_exp_f32 v100, v68
    v_exp_f32 v101, v69
    v_exp_f32 v102, v70
    v_exp_f32 v103, v71
    v_mfma_f32_32x32x8_bf16 v[80:95], v[124:125], v[218:219], v[80:95]
    s_waitcnt lgkmcnt(1)
    buffer_load_dwordx4 a[44:47], v223, s[20:23], s72 offen offset:1024 sc1
    s_add_u32 s72, s72, 32768
    v_cvt_pk_bf16_f32 v106, v100, v101
    v_cvt_pk_bf16_f32 v107, v102, v103
    v_exp_f32 v96, v72
    v_exp_f32 v97, v73
    v_exp_f32 v98, v74
    v_exp_f32 v99, v75
    v_mfma_f32_32x32x16_bf16 v[128:143], v[116:119], v[104:107], v[128:143]
    s_waitcnt lgkmcnt(0)
    ds_read_b128 v[116:119], v228 offset:53312
    buffer_load_dwordx4 a[48:51], v48, s[20:23], s71 offen offset:0 sc1
    v_cvt_pk_bf16_f32 v108, v96, v97
    v_cvt_pk_bf16_f32 v109, v98, v99
    v_exp_f32 v100, v76
    v_exp_f32 v101, v77
    v_exp_f32 v102, v78
    v_exp_f32 v103, v79
    buffer_load_dwordx4 a[52:55], v48, s[20:23], s72 offen offset:0 sc1
    v_cvt_pk_bf16_f32 v110, v100, v101
    v_cvt_pk_bf16_f32 v111, v102, v103
    v_exp_f32 v96, v80
    v_exp_f32 v97, v81
    v_exp_f32 v98, v82
    v_exp_f32 v99, v83
    v_mfma_f32_32x32x16_bf16 v[128:143], v[120:123], v[108:111], v[128:143]
    s_waitcnt lgkmcnt(0)
    ds_read_b128 v[120:123], v229 offset:53312
    buffer_load_dwordx4 a[56:59], v49, s[20:23], s71 offen offset:1024 sc1
    v_cvt_pk_bf16_f32 v104, v96, v97
    v_cvt_pk_bf16_f32 v105, v98, v99
    v_exp_f32 v100, v84
    v_exp_f32 v101, v85
    v_exp_f32 v102, v86
    v_exp_f32 v103, v87
    buffer_load_dwordx4 a[60:63], v49, s[20:23], s72 offen offset:1024 sc1
    v_cvt_pk_bf16_f32 v106, v100, v101
    v_cvt_pk_bf16_f32 v107, v102, v103
    v_exp_f32 v96, v88
    v_exp_f32 v97, v89
    v_exp_f32 v98, v90
    v_exp_f32 v99, v91
    v_mfma_f32_32x32x16_bf16 v[144:159], v[116:119], v[104:107], v[144:159]
    s_waitcnt lgkmcnt(0)
    v_cvt_pk_bf16_f32 v108, v96, v97
    v_cvt_pk_bf16_f32 v109, v98, v99
    v_exp_f32 v100, v92
    v_exp_f32 v101, v93
    v_exp_f32 v102, v94
    v_exp_f32 v103, v95
    v_cvt_pk_bf16_f32 v110, v100, v101
    v_cvt_pk_bf16_f32 v111, v102, v103
    s_nop 1
    v_mfma_f32_32x32x16_bf16 v[144:159], v[120:123], v[108:111], v[144:159]
L_p2_3:
    buffer_load_dwordx4 a[64:67], v50, s[20:23], s71 offen offset:2048 sc1
    v_pk_mul_f32 v[4:5], v[128:129], 0
    v_pk_fma_f32 v[4:5], v[130:131], 0, v[4:5]
    v_pk_fma_f32 v[4:5], v[132:133], 0, v[4:5]
    v_pk_fma_f32 v[4:5], v[134:135], 0, v[4:5]
    v_pk_fma_f32 v[4:5], v[136:137], 0, v[4:5]
    v_pk_fma_f32 v[4:5], v[138:139], 0, v[4:5]
    v_pk_fma_f32 v[4:5], v[140:141], 0, v[4:5]
    buffer_load_dwordx4 a[68:71], v50, s[20:23], s72 offen offset:2048 sc1
    s_nop 2
    v_pk_mul_f32 v[6:7], v[144:145], 0
    v_pk_fma_f32 v[6:7], v[146:147], 0, v[6:7]
    v_pk_fma_f32 v[6:7], v[148:149], 0, v[6:7]
    v_pk_fma_f32 v[6:7], v[150:151], 0, v[6:7]
    v_pk_fma_f32 v[6:7], v[152:153], 0, v[6:7]
    v_pk_fma_f32 v[6:7], v[154:155], 0, v[6:7]
    v_pk_fma_f32 v[6:7], v[156:157], 0, v[6:7]
    v_max_f32 v2, v140, v156
    v_min_f32 v3, v140, v156
    v_pk_add_f32 v[4:5], v[4:5], v[6:7]
    v_add_f32 v2, v2, v4
    v_add_f32 v3, v3, v5
    v_cmp_nge_f32 vcc, 0x5d800000, v2
    s_nop 0
    s_mov_b64 s[76:77], vcc
    v_cmp_nle_f32 vcc, 0x21800000, v3
    s_nop 0
    s_or_b64 vcc, vcc, s[76:77]
    s_cbranch_vccnz L_slow_17
L_norm_18:
    buffer_load_dwordx4 a[72:75], v52, s[20:23], s71 offen offset:3072 sc1
    v_rcp_f32 v2, v140
    s_nop 0
    v_mul_f32 v2, v58, v2
    v_pk_mul_f32 v[128:129], v[128:129], v[2:3] op_sel_hi:[1,0]
    v_pk_mul_f32 v[130:131], v[130:131], v[2:3] op_sel_hi:[1,0]
    v_pk_mul_f32 v[132:133], v[132:133], v[2:3] op_sel_hi:[1,0]
    v_pk_mul_f32 v[134:135], v[134:135], v[2:3] op_sel_hi:[1,0]
    v_pk_mul_f32 v[136:137], v[136:137], v[2:3] op_sel_hi:[1,0]
    v_pk_mul_f32 v[138:139], v[138:139], v[2:3] op_sel_hi:[1,0]
    v_cvt_pk_bf16_f32 v192, v128, v129
    v_cvt_pk_bf16_f32 v193, v130, v131
    v_cvt_pk_bf16_f32 v194, v132, v133
    v_cvt_pk_bf16_f32 v195, v134, v135
    v_cvt_pk_bf16_f32 v200, v136, v137
    v_cvt_pk_bf16_f32 v201, v138, v139
    buffer_store_dwordx4 v[192:195], v57, s[20:23], s68 offen sc1
    buffer_load_dwordx4 a[76:79], v52, s[20:23], s72 offen offset:3072 sc1
    v_rcp_f32 v2, v156
    s_nop 0
    v_mul_f32 v2, v58, v2
    v_pk_mul_f32 v[144:145], v[144:145], v[2:3] op_sel_hi:[1,0]
    v_pk_mul_f32 v[146:147], v[146:147], v[2:3] op_sel_hi:[1,0]
    v_pk_mul_f32 v[148:149], v[148:149], v[2:3] op_sel_hi:[1,0]
    v_pk_mul_f32 v[150:151], v[150:151], v[2:3] op_sel_hi:[1,0]
    v_pk_mul_f32 v[152:153], v[152:153], v[2:3] op_sel_hi:[1,0]
    v_pk_mul_f32 v[154:155], v[154:155], v[2:3] op_sel_hi:[1,0]
    v_cvt_pk_bf16_f32 v196, v144, v145
    v_cvt_pk_bf16_f32 v197, v146, v147
    v_cvt_pk_bf16_f32 v198, v148, v149
    v_cvt_pk_bf16_f32 v199, v150, v151
    v_cvt_pk_bf16_f32 v202, v152, v153
    v_cvt_pk_bf16_f32 v203, v154, v155
    buffer_store_dwordx4 v[196:199], v59, s[20:23], s68 offen sc1
    s_mov_b32 exec_hi, 0
    buffer_store_dwordx4 v[200:203], v60, s[20:23], s68 offen sc1
    s_mov_b64 exec, -1
    s_cmp_lg_u32 s73, 0
    s_cbranch_scc1 L_hexit_4
    s_waitcnt vmcnt(22)
    v_mfma_f32_16x16x32_bf16 v[64:67], a[160:163], a[0:3], 0
    s_waitcnt vmcnt(21)
    v_mfma_f32_16x16x32_bf16 v[64:67], a[176:179], a[4:7], v[64:67]
    v_mfma_f32_16x16x32_bf16 v[68:71], a[180:183], a[4:7], 0
    v_lshrrev_b32 v2, 3, v1
    v_and_b32 v4, 7, v1
    s_mul_i32 s77, s56, 11
    v_mfma_f32_16x16x32_bf16 v[68:71], a[164:167], a[0:3], v[68:71]
    s_add_u32 s77, s77, s5
    s_mul_i32 s77, s77, 10240
    s_lshl_b32 s78, s57, 7
    v_mfma_f32_16x16x32_bf16 v[72:75], a[168:171], a[0:3], 0
    s_add_u32 s77, s77, s78
    v_mul_u32_u24 v5, 1280, v2
    v_lshl_add_u32 v5, v4, 4, v5
    v_mfma_f32_16x16x32_bf16 v[72:75], a[184:187], a[4:7], v[72:75]
    v_add_u32 v20, s77, v5
    v_add_u32 v21, 40960, v20
    s_add_u32 s77, s5, 1
    v_mfma_f32_16x16x32_bf16 v[76:79], a[188:191], a[4:7], 0
    s_lshr_b32 s77, s77, 2
    s_lshl_b32 s77, s77, 31
    s_add_u32 s77, s77, 81920
    v_mfma_f32_16x16x32_bf16 v[76:79], a[172:175], a[0:3], v[76:79]
    s_waitcnt vmcnt(19)
    v_add_u32 v22, s77, v20
    v_lshlrev_b32 v5, 1, v4
    v_mfma_f32_16x16x32_bf16 v[92:95], a[172:175], a[8:11], 0
    v_xor_b32 v5, v5, v2
    v_lshlrev_b32 v5, 4, v5
    v_mfma_f32_16x16x32_bf16 v[92:95], a[188:191], a[12:15], v[92:95]
    buffer_load_dwordx4 a[0:3], v222, s[20:23], s71 offen offset:0 sc1
    v_mfma_f32_16x16x32_bf16 v[88:91], a[184:187], a[12:15], 0
    v_lshl_add_u32 v5, v2, 8, v5
    s_lshl_b32 s77, s5, 11
    v_add_u32 v16, s77, v5
    v_mfma_f32_16x16x32_bf16 v[88:91], a[168:171], a[8:11], v[88:91]
    v_xor_b32 v17, 16, v16
    v_lshrrev_b32 v2, 4, v1
    v_mfma_f32_16x16x32_bf16 v[84:87], a[164:167], a[8:11], 0
    v_xor_b32 v5, v2, v4
    v_lshlrev_b32 v5, 4, v5
    v_mfma_f32_16x16x32_bf16 v[84:87], a[180:183], a[12:15], v[84:87]
    buffer_load_dwordx4 a[4:7], v222, s[20:23], s72 offen offset:0 sc1
    v_mfma_f32_16x16x32_bf16 v[80:83], a[176:179], a[12:15], 0
    v_and_b32 v3, 15, v1
    v_lshl_add_u32 v5, v3, 8, v5
    s_lshl_b32 s77, s5, 13
    v_mfma_f32_16x16x32_bf16 v[80:83], a[160:163], a[8:11], v[80:83]
    s_waitcnt vmcnt(19)
    v_add_u32 v8, s77, v5
    v_xor_b32 v9, 64, v8
    v_mfma_f32_16x16x32_bf16 v[96:99], a[160:163], a[16:19], 0
    v_add_u32 v10, 0x10000, v8
    v_add_u32 v18, 0x10000, v16
    v_mfma_f32_16x16x32_bf16 v[96:99], a[176:179], a[20:23], v[96:99]
    buffer_load_dwordx4 a[8:11], v223, s[20:23], s71 offen offset:1024 sc1
    s_add_u32 s71, s71, 32768
    v_mfma_f32_16x16x32_bf16 v[100:103], a[180:183], a[20:23], 0
    v_add_u32 v11, 0x10000, v9
    v_add_u32 v19, 0x10000, v17
    s_mul_i32 s77, s5, 81920
    v_mfma_f32_16x16x32_bf16 v[100:103], a[164:167], a[16:19], v[100:103]
    s_add_u32 s45, s77, 884736
    s_add_u32 s47, s77, 901120
    s_add_u32 s48, s77, 917504
    v_mfma_f32_16x16x32_bf16 v[104:107], a[168:171], a[16:19], 0
    s_add_u32 s65, s77, 933888
    s_add_u32 s84, s77, 950272
    v_lshlrev_b32 v12, 2, v3
    v_mfma_f32_16x16x32_bf16 v[104:107], a[184:187], a[20:23], v[104:107]
    buffer_load_dwordx4 a[12:15], v223, s[20:23], s72 offen offset:1024 sc1
    s_add_u32 s72, s72, 32768
    v_mfma_f32_16x16x32_bf16 v[108:111], a[188:191], a[20:23], 0
    s_mul_i32 s77, s56, 352
    s_add_u32 s77, s77, 1703936
    v_mfma_f32_16x16x32_bf16 v[108:111], a[172:175], a[16:19], v[108:111]
    s_waitcnt vmcnt(19)
    buffer_load_dword v24, v12, s[20:23], s77 offen offset:0 sc1
    v_mfma_f32_16x16x32_bf16 v[124:127], a[172:175], a[24:27], 0
    v_mfma_f32_16x16x32_bf16 v[124:127], a[188:191], a[28:31], v[124:127]
    buffer_load_dwordx4 a[16:19], v48, s[20:23], s71 offen offset:0 sc1
    v_mfma_f32_16x16x32_bf16 v[120:123], a[184:187], a[28:31], 0
    v_mfma_f32_16x16x32_bf16 v[120:123], a[168:171], a[24:27], v[120:123]
    v_mfma_f32_16x16x32_bf16 v[116:119], a[164:167], a[24:27], 0
    v_mfma_f32_16x16x32_bf16 v[116:119], a[180:183], a[28:31], v[116:119]
    buffer_load_dwordx4 a[20:23], v48, s[20:23], s72 offen offset:0 sc1
    v_mfma_f32_16x16x32_bf16 v[112:115], a[176:179], a[28:31], 0
    v_mfma_f32_16x16x32_bf16 v[112:115], a[160:163], a[24:27], v[112:115]
    s_waitcnt vmcnt(20)
    buffer_load_dword v25, v12, s[20:23], s77 offen offset:64 sc1
    v_mfma_f32_16x16x32_bf16 v[128:131], a[160:163], a[32:35], 0
    v_mfma_f32_16x16x32_bf16 v[128:131], a[176:179], a[36:39], v[128:131]
    buffer_load_dwordx4 a[24:27], v49, s[20:23], s71 offen offset:1024 sc1
    v_mfma_f32_16x16x32_bf16 v[132:135], a[180:183], a[36:39], 0
    v_mfma_f32_16x16x32_bf16 v[132:135], a[164:167], a[32:35], v[132:135]
    buffer_load_dwordx4 a[28:31], v49, s[20:23], s72 offen offset:1024 sc1
    v_mfma_f32_16x16x32_bf16 v[136:139], a[168:171], a[32:35], 0
    v_mfma_f32_16x16x32_bf16 v[136:139], a[184:187], a[36:39], v[136:139]
    v_mfma_f32_16x16x32_bf16 v[140:143], a[188:191], a[36:39], 0
    v_mfma_f32_16x16x32_bf16 v[140:143], a[172:175], a[32:35], v[140:143]
    s_waitcnt vmcnt(21)
    buffer_load_dword v26, v12, s[20:23], s77 offen offset:128 sc1
    v_mfma_f32_16x16x32_bf16 v[156:159], a[172:175], a[40:43], 0
    buffer_load_dwordx4 a[32:35], v50, s[20:23], s71 offen offset:2048 sc1
    v_mfma_f32_16x16x32_bf16 v[156:159], a[188:191], a[44:47], v[156:159]
    v_mfma_f32_16x16x32_bf16 v[152:155], a[184:187], a[44:47], 0
    v_mfma_f32_16x16x32_bf16 v[152:155], a[168:171], a[40:43], v[152:155]
    buffer_load_dwordx4 a[36:39], v50, s[20:23], s72 offen offset:2048 sc1
    v_mfma_f32_16x16x32_bf16 v[148:151], a[164:167], a[40:43], 0
    v_mfma_f32_16x16x32_bf16 v[148:151], a[180:183], a[44:47], v[148:151]
    v_mfma_f32_16x16x32_bf16 v[144:147], a[176:179], a[44:47], 0
    v_mfma_f32_16x16x32_bf16 v[144:147], a[160:163], a[40:43], v[144:147]
    s_waitcnt vmcnt(22)
    buffer_load_dword v27, v12, s[20:23], s77 offen offset:192 sc1
    v_mfma_f32_16x16x32_bf16 v[64:67], a[192:195], a[48:51], v[64:67]
    buffer_load_dwordx4 a[40:43], v52, s[20:23], s71 offen offset:3072 sc1
    v_mfma_f32_16x16x32_bf16 v[64:67], a[208:211], a[52:55], v[64:67]
    v_mfma_f32_16x16x32_bf16 v[68:71], a[212:215], a[52:55], v[68:71]
    ds_read_b64_tr_b16 a[160:161], v45 offset:0
    ds_read_b64_tr_b16 a[162:163], v45 offset:512
    v_mfma_f32_16x16x32_bf16 v[68:71], a[196:199], a[48:51], v[68:71]
    buffer_load_dwordx4 a[44:47], v52, s[20:23], s72 offen offset:3072 sc1
    v_mfma_f32_16x16x32_bf16 v[72:75], a[200:203], a[48:51], v[72:75]
    s_waitcnt vmcnt(16)
    s_barrier
    v_mfma_f32_16x16x32_bf16 v[72:75], a[216:219], a[52:55], v[72:75]
    buffer_store_dword v53, v51, s[20:23], 0 offen offset:256 sc1
    v_mfma_f32_16x16x32_bf16 v[76:79], a[220:223], a[52:55], v[76:79]
    s_nop 0
    ds_read_b64_tr_b16 a[164:165], v46 offset:0
    ds_read_b64_tr_b16 a[166:167], v46 offset:512
    v_mfma_f32_16x16x32_bf16 v[76:79], a[204:207], a[48:51], v[76:79]
    ds_read_b64_tr_b16 a[168:169], v241 offset:0
    ds_read_b64_tr_b16 a[170:171], v241 offset:512
    v_mfma_f32_16x16x32_bf16 v[92:95], a[204:207], a[56:59], v[92:95]
    buffer_load_dwordx4 a[48:51], v222, s[20:23], s71 offen offset:0 sc1
    v_mfma_f32_16x16x32_bf16 v[92:95], a[220:223], a[60:63], v[92:95]
    s_nop 0
    ds_read_b64_tr_b16 a[172:173], v242 offset:0
    ds_read_b64_tr_b16 a[174:175], v242 offset:512
    v_mfma_f32_16x16x32_bf16 v[88:91], a[216:219], a[60:63], v[88:91]
    ds_read_b64_tr_b16 a[176:177], v41 offset:32768
    ds_read_b64_tr_b16 a[178:179], v41 offset:33280
    v_mfma_f32_16x16x32_bf16 v[88:91], a[200:203], a[56:59], v[88:91]
    buffer_load_dwordx4 a[52:55], v222, s[20:23], s72 offen offset:0 sc1
    v_mfma_f32_16x16x32_bf16 v[84:87], a[196:199], a[56:59], v[84:87]
    s_nop 0
    ds_read_b64_tr_b16 a[180:181], v42 offset:32768
    ds_read_b64_tr_b16 a[182:183], v42 offset:33280
    v_mfma_f32_16x16x32_bf16 v[84:87], a[212:215], a[60:63], v[84:87]
    buffer_load_dword v28, v12, s[20:23], s77 offen offset:256 sc1
    v_mfma_f32_16x16x32_bf16 v[80:83], a[208:211], a[60:63], v[80:83]
    s_nop 0
    ds_read_b64_tr_b16 a[184:185], v43 offset:32768
    ds_read_b64_tr_b16 a[186:187], v43 offset:33280
    v_mfma_f32_16x16x32_bf16 v[80:83], a[192:195], a[56:59], v[80:83]
    buffer_load_dword v29, v12, s[20:23], s77 offen offset:320 sc1
    v_mfma_f32_16x16x32_bf16 v[96:99], a[192:195], a[64:67], v[96:99]
    s_nop 0
    ds_read_b64_tr_b16 a[188:189], v44 offset:32768
    s_waitcnt lgkmcnt(8)
    ds_read_b64_tr_b16 a[190:191], v44 offset:33280
    s_waitcnt lgkmcnt(8)
    s_add_u32 m0, s44, 131072
    v_mfma_f32_16x16x32_bf16 v[96:99], a[208:211], a[68:71], v[96:99]
    buffer_load_dwordx4 v35, s[28:31], s70 offen offset:0 lds
    v_mfma_f32_16x16x32_bf16 v[100:103], a[212:215], a[68:71], v[100:103]
    v_mfma_f32_16x16x32_bf16 v[100:103], a[196:199], a[64:67], v[100:103]
    buffer_load_dwordx4 v39, s[28:31], s70 offen offset:1024 lds
L_pad5:
    s_cmp_eq_u32 s92, 1
    s_cbranch_scc1 L_pad9
    v_mfma_f32_16x16x32_bf16 v[104:107], a[200:203], a[64:67], v[104:107]
    v_mfma_f32_16x16x32_bf16 v[104:107], a[216:219], a[68:71], v[104:107]
    v_mfma_f32_16x16x32_bf16 v[108:111], a[220:223], a[68:71], v[108:111]
    v_mfma_f32_16x16x32_bf16 v[108:111], a[204:207], a[64:67], v[108:111]
    v_mfma_f32_16x16x32_bf16 v[124:127], a[204:207], a[72:75], v[124:127]
    buffer_load_dwordx4 v37, s[28:31], s70 offen offset:2048 lds
    v_mfma_f32_16x16x32_bf16 v[124:127], a[220:223], a[76:79], v[124:127]
    v_mfma_f32_16x16x32_bf16 v[120:123], a[216:219], a[76:79], v[120:123]
    v_mfma_f32_16x16x32_bf16 v[120:123], a[200:203], a[72:75], v[120:123]
    buffer_load_dwordx4 v40, s[28:31], s70 offen offset:3072 lds
    v_mfma_f32_16x16x32_bf16 v[116:119], a[196:199], a[72:75], v[116:119]
    s_add_u32 s70, s70, 40960
    v_mfma_f32_16x16x32_bf16 v[116:119], a[212:215], a[76:79], v[116:119]
    v_mfma_f32_16x16x32_bf16 v[112:115], a[208:211], a[76:79], v[112:115]
    v_mfma_f32_16x16x32_bf16 v[112:115], a[192:195], a[72:75], v[112:115]
    s_waitcnt vmcnt(23)
    v_mfma_f32_16x16x32_bf16 v[128:131], a[192:195], a[0:3], v[128:131]
    buffer_load_dwordx4 a[56:59], v223, s[20:23], s71 offen offset:1024 sc1
    s_add_u32 s71, s71, 32768
    v_mfma_f32_16x16x32_bf16 v[128:131], a[208:211], a[4:7], v[128:131]
    v_mfma_f32_16x16x32_bf16 v[132:135], a[212:215], a[4:7], v[132:135]
    v_mfma_f32_16x16x32_bf16 v[132:135], a[196:199], a[0:3], v[132:135]
    buffer_load_dwordx4 a[60:63], v223, s[20:23], s72 offen offset:1024 sc1
    s_add_u32 s72, s72, 32768
    v_mfma_f32_16x16x32_bf16 v[136:139], a[200:203], a[0:3], v[136:139]
    v_mfma_f32_16x16x32_bf16 v[136:139], a[216:219], a[4:7], v[136:139]
    v_mfma_f32_16x16x32_bf16 v[140:143], a[220:223], a[4:7], v[140:143]
    v_mfma_f32_16x16x32_bf16 v[140:143], a[204:207], a[0:3], v[140:143]
    s_waitcnt vmcnt(23)
    v_mfma_f32_16x16x32_bf16 v[156:159], a[204:207], a[8:11], v[156:159]
    buffer_load_dwordx4 a[64:67], v48, s[20:23], s71 offen offset:0 sc1
    v_mfma_f32_16x16x32_bf16 v[156:159], a[220:223], a[12:15], v[156:159]
    v_mfma_f32_16x16x32_bf16 v[152:155], a[216:219], a[12:15], v[152:155]
    v_mfma_f32_16x16x32_bf16 v[152:155], a[200:203], a[8:11], v[152:155]
    buffer_load_dwordx4 a[68:71], v48, s[20:23], s72 offen offset:0 sc1
    v_mfma_f32_16x16x32_bf16 v[148:151], a[196:199], a[8:11], v[148:151]
    v_mfma_f32_16x16x32_bf16 v[148:151], a[212:215], a[12:15], v[148:151]
    v_mfma_f32_16x16x32_bf16 v[144:147], a[208:211], a[12:15], v[144:147]
    v_mfma_f32_16x16x32_bf16 v[144:147], a[192:195], a[8:11], v[144:147]
    s_waitcnt vmcnt(22)
    v_mfma_f32_16x16x32_bf16 v[64:67], a[224:227], a[16:19], v[64:67]
    buffer_load_dwordx4 a[72:75], v49, s[20:23], s71 offen offset:1024 sc1
    v_mfma_f32_16x16x32_bf16 v[64:67], a[240:243], a[20:23], v[64:67]
    v_mfma_f32_16x16x32_bf16 v[68:71], a[244:247], a[20:23], v[68:71]
    ds_read_b64_tr_b16 a[192:193], v41 offset:49152
    ds_read_b64_tr_b16 a[194:195], v41 offset:49664
    v_mfma_f32_16x16x32_bf16 v[68:71], a[228:231], a[16:19], v[68:71]
    buffer_load_dwordx4 a[76:79], v49, s[20:23], s72 offen offset:1024 sc1
    v_mfma_f32_16x16x32_bf16 v[72:75], a[232:235], a[16:19], v[72:75]
    s_nop 0
    ds_read_b64_tr_b16 a[196:197], v42 offset:49152
    ds_read_b64_tr_b16 a[198:199], v42 offset:49664
    v_mfma_f32_16x16x32_bf16 v[72:75], a[248:251], a[20:23], v[72:75]
    buffer_load_dwordx4 a[0:3], v50, s[20:23], s71 offen offset:2048 sc1
    v_mfma_f32_16x16x32_bf16 v[76:79], a[252:255], a[20:23], v[76:79]
    s_nop 0
    ds_read_b64_tr_b16 a[200:201], v43 offset:49152
    ds_read_b64_tr_b16 a[202:203], v43 offset:49664
    v_mfma_f32_16x16x32_bf16 v[76:79], a[236:239], a[16:19], v[76:79]
    s_waitcnt vmcnt(22)
    v_mfma_f32_16x16x32_bf16 v[92:95], a[236:239], a[24:27], v[92:95]
    s_nop 0
    ds_read_b64_tr_b16 a[204:205], v44 offset:49152
    s_waitcnt lgkmcnt(8)
    ds_read_b64_tr_b16 a[206:207], v44 offset:49664
    v_mfma_f32_16x16x32_bf16 v[92:95], a[252:255], a[28:31], v[92:95]
    buffer_load_dwordx4 a[4:7], v50, s[20:23], s72 offen offset:2048 sc1
    v_mfma_f32_16x16x32_bf16 v[88:91], a[248:251], a[28:31], v[88:91]
    ds_read_b64_tr_b16 a[208:209], v41 offset:0
    ds_read_b64_tr_b16 a[210:211], v41 offset:512
    v_mfma_f32_16x16x32_bf16 v[88:91], a[232:235], a[24:27], v[88:91]
    v_mfma_f32_16x16x32_bf16 v[84:87], a[228:231], a[24:27], v[84:87]
    s_nop 0
    ds_read_b64_tr_b16 a[212:213], v42 offset:0
    ds_read_b64_tr_b16 a[214:215], v42 offset:512
    v_mfma_f32_16x16x32_bf16 v[84:87], a[244:247], a[28:31], v[84:87]
    buffer_load_dwordx4 a[8:11], v52, s[20:23], s71 offen offset:3072 sc1
    v_mfma_f32_16x16x32_bf16 v[80:83], a[240:243], a[28:31], v[80:83]
    s_nop 0
    ds_read_b64_tr_b16 a[216:217], v43 offset:0
    ds_read_b64_tr_b16 a[218:219], v43 offset:512
    v_mfma_f32_16x16x32_bf16 v[80:83], a[224:227], a[24:27], v[80:83]
    s_waitcnt vmcnt(21)
    v_mfma_f32_16x16x32_bf16 v[96:99], a[224:227], a[32:35], v[96:99]
    s_nop 0
    s_waitcnt lgkmcnt(8)
    ds_read_b64_tr_b16 a[220:221], v44 offset:0
    ds_read_b64_tr_b16 a[222:223], v44 offset:512
    v_mfma_f32_16x16x32_bf16 v[96:99], a[240:243], a[36:39], v[96:99]
    buffer_load_dwordx4 a[12:15], v52, s[20:23], s72 offen offset:3072 sc1
    v_mfma_f32_16x16x32_bf16 v[100:103], a[244:247], a[36:39], v[100:103]
    v_mfma_f32_16x16x32_bf16 v[100:103], a[228:231], a[32:35], v[100:103]
    v_mfma_f32_16x16x32_bf16 v[104:107], a[232:235], a[32:35], v[104:107]
    v_mfma_f32_16x16x32_bf16 v[104:107], a[248:251], a[36:39], v[104:107]
    buffer_load_dwordx4 a[16:19], v222, s[20:23], s71 offen offset:0 sc1
    v_mfma_f32_16x16x32_bf16 v[108:111], a[252:255], a[36:39], v[108:111]
    v_mfma_f32_16x16x32_bf16 v[108:111], a[236:239], a[32:35], v[108:111]
    s_waitcnt vmcnt(20)
    v_mfma_f32_16x16x32_bf16 v[124:127], a[236:239], a[40:43], v[124:127]
    v_mfma_f32_16x16x32_bf16 v[124:127], a[252:255], a[44:47], v[124:127]
    buffer_load_dwordx4 a[20:23], v222, s[20:23], s72 offen offset:0 sc1
    v_mfma_f32_16x16x32_bf16 v[120:123], a[248:251], a[44:47], v[120:123]
    v_mfma_f32_16x16x32_bf16 v[120:123], a[232:235], a[40:43], v[120:123]
    v_mfma_f32_16x16x32_bf16 v[116:119], a[228:231], a[40:43], v[116:119]
    v_mfma_f32_16x16x32_bf16 v[116:119], a[244:247], a[44:47], v[116:119]
    buffer_load_dwordx4 a[24:27], v223, s[20:23], s71 offen offset:1024 sc1
    s_add_u32 s71, s71, 32768
    v_mfma_f32_16x16x32_bf16 v[112:115], a[240:243], a[44:47], v[112:115]
    v_mfma_f32_16x16x32_bf16 v[112:115], a[224:227], a[40:43], v[112:115]
    s_waitcnt vmcnt(19)
    v_mfma_f32_16x16x32_bf16 v[128:131], a[224:227], a[48:51], v[128:131]
    v_mfma_f32_16x16x32_bf16 v[128:131], a[240:243], a[52:55], v[128:131]
    buffer_load_dwordx4 a[28:31], v223, s[20:23], s72 offen offset:1024 sc1
    s_add_u32 s72, s72, 32768
    v_mfma_f32_16x16x32_bf16 v[132:135], a[244:247], a[52:55], v[132:135]
    v_mfma_f32_16x16x32_bf16 v[132:135], a[228:231], a[48:51], v[132:135]
    v_mfma_f32_16x16x32_bf16 v[136:139], a[232:235], a[48:51], v[136:139]
    v_mfma_f32_16x16x32_bf16 v[136:139], a[248:251], a[52:55], v[136:139]
    buffer_load_dwordx4 a[32:35], v48, s[20:23], s71 offen offset:0 sc1
    v_mfma_f32_16x16x32_bf16 v[140:143], a[252:255], a[52:55], v[140:143]
    v_mfma_f32_16x16x32_bf16 v[140:143], a[236:239], a[48:51], v[140:143]
    s_waitcnt vmcnt(13)
    v_mfma_f32_16x16x32_bf16 v[156:159], a[236:239], a[56:59], v[156:159]
    v_mfma_f32_16x16x32_bf16 v[156:159], a[252:255], a[60:63], v[156:159]
    buffer_load_dwordx4 a[36:39], v48, s[20:23], s72 offen offset:0 sc1
    v_mfma_f32_16x16x32_bf16 v[152:155], a[248:251], a[60:63], v[152:155]
    v_mfma_f32_16x16x32_bf16 v[152:155], a[232:235], a[56:59], v[152:155]
    v_mfma_f32_16x16x32_bf16 v[148:151], a[228:231], a[56:59], v[148:151]
    v_mfma_f32_16x16x32_bf16 v[148:151], a[244:247], a[60:63], v[148:151]
    buffer_load_dwordx4 a[40:43], v49, s[20:23], s71 offen offset:1024 sc1
    v_mfma_f32_16x16x32_bf16 v[144:147], a[240:243], a[60:63], v[144:147]
    v_mfma_f32_16x16x32_bf16 v[144:147], a[224:227], a[56:59], v[144:147]
    s_waitcnt vmcnt(13)
    v_sub_f32 v24, 1.0, v24
    v_sub_f32 v25, 1.0, v25
    v_mfma_f32_16x16x32_bf16 v[64:67], a[80:83], a[64:67], v[64:67]
    v_sub_f32 v26, 1.0, v26
    v_sub_f32 v27, 1.0, v27
    v_mfma_f32_16x16x32_bf16 v[64:67], a[96:99], a[68:71], v[64:67]
    buffer_load_dwordx4 a[44:47], v49, s[20:23], s72 offen offset:1024 sc1
    v_mfma_f32_16x16x32_bf16 v[68:71], a[100:103], a[68:71], v[68:71]
    ds_read_b64_tr_b16 a[224:225], v41 offset:16384
    ds_read_b64_tr_b16 a[226:227], v41 offset:16896
    v_mfma_f32_16x16x32_bf16 v[68:71], a[84:87], a[64:67], v[68:71]
    v_sub_f32 v28, 1.0, v28
    v_sub_f32 v29, 1.0, v29
    v_mfma_f32_16x16x32_bf16 v[72:75], a[88:91], a[64:67], v[72:75]
    s_nop 0
    ds_read_b64_tr_b16 a[228:229], v42 offset:16384
    ds_read_b64_tr_b16 a[230:231], v42 offset:16896
    v_mfma_f32_16x16x32_bf16 v[72:75], a[104:107], a[68:71], v[72:75]
    buffer_load_dwordx4 a[48:51], v50, s[20:23], s71 offen offset:2048 sc1
    v_mfma_f32_16x16x32_bf16 v[76:79], a[108:111], a[68:71], v[76:79]
    s_nop 0
    ds_read_b64_tr_b16 a[232:233], v43 offset:16384
    s_waitcnt lgkmcnt(8)
    ds_read_b64_tr_b16 a[234:235], v43 offset:16896
    v_mfma_f32_16x16x32_bf16 v[76:79], a[92:95], a[64:67], v[76:79]
    s_waitcnt vmcnt(13)
    v_mfma_f32_16x16x32_bf16 v[92:95], a[92:95], a[72:75], v[92:95]
    s_nop 0
    ds_read_b64_tr_b16 a[236:237], v44 offset:16384
    ds_read_b64_tr_b16 a[238:239], v44 offset:16896
    v_mfma_f32_16x16x32_bf16 v[92:95], a[108:111], a[76:79], v[92:95]
    buffer_load_dwordx4 a[52:55], v50, s[20:23], s72 offen offset:2048 sc1
    v_mfma_f32_16x16x32_bf16 v[88:91], a[104:107], a[76:79], v[88:91]
    ds_read_b64_tr_b16 a[240:241], v45 offset:16384
    ds_read_b64_tr_b16 a[242:243], v45 offset:16896
    v_mfma_f32_16x16x32_bf16 v[88:91], a[88:91], a[72:75], v[88:91]
    v_mfma_f32_16x16x32_bf16 v[84:87], a[84:87], a[72:75], v[84:87]
    s_nop 0
    ds_read_b64_tr_b16 a[244:245], v46 offset:16384
    ds_read_b64_tr_b16 a[246:247], v46 offset:16896
    v_mfma_f32_16x16x32_bf16 v[84:87], a[100:103], a[76:79], v[84:87]
    buffer_load_dwordx4 a[56:59], v52, s[20:23], s71 offen offset:3072 sc1
    v_mfma_f32_16x16x32_bf16 v[80:83], a[96:99], a[76:79], v[80:83]
    s_nop 0
    s_waitcnt lgkmcnt(8)
    ds_read_b64_tr_b16 a[248:249], v241 offset:16384
    ds_read_b64_tr_b16 a[250:251], v241 offset:16896
    v_mfma_f32_16x16x32_bf16 v[80:83], a[80:83], a[72:75], v[80:83]
    s_waitcnt vmcnt(13)
    v_mfma_f32_16x16x32_bf16 v[96:99], a[80:83], a[0:3], v[96:99]
    s_nop 0
    ds_read_b64_tr_b16 a[252:253], v242 offset:16384
    ds_read_b64_tr_b16 a[254:255], v242 offset:16896
    v_mfma_f32_16x16x32_bf16 v[96:99], a[96:99], a[4:7], v[96:99]
    buffer_load_dwordx4 a[60:63], v52, s[20:23], s72 offen offset:3072 sc1
    v_mfma_f32_16x16x32_bf16 v[100:103], a[100:103], a[4:7], v[100:103]
    v_mfma_f32_16x16x32_bf16 v[100:103], a[84:87], a[0:3], v[100:103]
    v_mfma_f32_16x16x32_bf16 v[104:107], a[88:91], a[0:3], v[104:107]
    v_mfma_f32_16x16x32_bf16 v[104:107], a[104:107], a[4:7], v[104:107]
    buffer_load_dwordx4 a[64:67], v222, s[20:23], s71 offen offset:0 sc1
    v_mfma_f32_16x16x32_bf16 v[108:111], a[108:111], a[4:7], v[108:111]
    v_mfma_f32_16x16x32_bf16 v[108:111], a[92:95], a[0:3], v[108:111]
    s_waitcnt vmcnt(13)
    v_mfma_f32_16x16x32_bf16 v[124:127], a[92:95], a[8:11], v[124:127]
    buffer_load_dwordx4 a[68:71], v222, s[20:23], s72 offen offset:0 sc1
    v_mfma_f32_16x16x32_bf16 v[124:127], a[108:111], a[12:15], v[124:127]
    v_mfma_f32_16x16x32_bf16 v[120:123], a[104:107], a[12:15], v[120:123]
    s_add_u32 m0, s44, 98304
    v_mfma_f32_16x16x32_bf16 v[120:123], a[88:91], a[8:11], v[120:123]
    buffer_load_dwordx4 v35, s[28:31], s70 offen offset:0 lds
    v_mfma_f32_16x16x32_bf16 v[116:119], a[84:87], a[8:11], v[116:119]
    v_mfma_f32_16x16x32_bf16 v[116:119], a[100:103], a[12:15], v[116:119]
    v_mfma_f32_16x16x32_bf16 v[112:115], a[96:99], a[12:15], v[112:115]
    v_mfma_f32_16x16x32_bf16 v[112:115], a[80:83], a[8:11], v[112:115]
    s_waitcnt vmcnt(13)
    v_mfma_f32_16x16x32_bf16 v[128:131], a[80:83], a[16:19], v[128:131]
    buffer_load_dwordx4 a[72:75], v223, s[20:23], s71 offen offset:1024 sc1
    s_add_u32 s71, s71, 32768
    v_mfma_f32_16x16x32_bf16 v[128:131], a[96:99], a[20:23], v[128:131]
    v_mfma_f32_16x16x32_bf16 v[132:135], a[100:103], a[20:23], v[132:135]
    v_mfma_f32_16x16x32_bf16 v[132:135], a[84:87], a[16:19], v[132:135]
    buffer_load_dwordx4 a[76:79], v223, s[20:23], s72 offen offset:1024 sc1
    s_add_u32 s72, s72, 32768
    v_mfma_f32_16x16x32_bf16 v[136:139], a[88:91], a[16:19], v[136:139]
    v_mfma_f32_16x16x32_bf16 v[136:139], a[104:107], a[20:23], v[136:139]
    v_mfma_f32_16x16x32_bf16 v[140:143], a[108:111], a[20:23], v[140:143]
    v_mfma_f32_16x16x32_bf16 v[140:143], a[92:95], a[16:19], v[140:143]
    s_waitcnt vmcnt(13)
    v_mfma_f32_16x16x32_bf16 v[156:159], a[92:95], a[24:27], v[156:159]
    buffer_load_dwordx4 a[0:3], v48, s[20:23], s71 offen offset:0 sc1
    v_mfma_f32_16x16x32_bf16 v[156:159], a[108:111], a[28:31], v[156:159]
    v_mfma_f32_16x16x32_bf16 v[152:155], a[104:107], a[28:31], v[152:155]
    v_mfma_f32_16x16x32_bf16 v[152:155], a[88:91], a[24:27], v[152:155]
    buffer_load_dwordx4 a[4:7], v48, s[20:23], s72 offen offset:0 sc1
    v_mfma_f32_16x16x32_bf16 v[148:151], a[84:87], a[24:27], v[148:151]
    v_mfma_f32_16x16x32_bf16 v[148:151], a[100:103], a[28:31], v[148:151]
    v_mfma_f32_16x16x32_bf16 v[144:147], a[96:99], a[28:31], v[144:147]
    v_mfma_f32_16x16x32_bf16 v[144:147], a[80:83], a[24:27], v[144:147]
    s_waitcnt vmcnt(13)
    v_mfma_f32_16x16x32_bf16 v[64:67], a[112:115], a[32:35], v[64:67]
    buffer_load_dwordx4 a[8:11], v49, s[20:23], s71 offen offset:1024 sc1
    v_mfma_f32_16x16x32_bf16 v[64:67], a[128:131], a[36:39], v[64:67]
    v_mfma_f32_16x16x32_bf16 v[68:71], a[132:135], a[36:39], v[68:71]
    ds_read_b64_tr_b16 a[80:81], v45 offset:0
    ds_read_b64_tr_b16 a[82:83], v45 offset:512
    v_mfma_f32_16x16x32_bf16 v[68:71], a[116:119], a[32:35], v[68:71]
    buffer_load_dwordx4 a[12:15], v49, s[20:23], s72 offen offset:1024 sc1
    v_mfma_f32_16x16x32_bf16 v[72:75], a[120:123], a[32:35], v[72:75]
    s_nop 0
    ds_read_b64_tr_b16 a[84:85], v46 offset:0
    s_waitcnt lgkmcnt(8)
    ds_read_b64_tr_b16 a[86:87], v46 offset:512
    v_mfma_f32_16x16x32_bf16 v[72:75], a[136:139], a[36:39], v[72:75]
    v_mfma_f32_16x16x32_bf16 v[76:79], a[140:143], a[36:39], v[76:79]
    s_nop 0
    ds_read_b64_tr_b16 a[88:89], v241 offset:0
    ds_read_b64_tr_b16 a[90:91], v241 offset:512
    v_mfma_f32_16x16x32_bf16 v[76:79], a[124:127], a[32:35], v[76:79]
    s_waitcnt vmcnt(13)
    v_mfma_f32_16x16x32_bf16 v[92:95], a[124:127], a[40:43], v[92:95]
    s_nop 0
    ds_read_b64_tr_b16 a[92:93], v242 offset:0
    ds_read_b64_tr_b16 a[94:95], v242 offset:512
    v_mfma_f32_16x16x32_bf16 v[92:95], a[140:143], a[44:47], v[92:95]
    buffer_load_dwordx4 a[16:19], v50, s[20:23], s71 offen offset:2048 sc1
    v_mfma_f32_16x16x32_bf16 v[88:91], a[136:139], a[44:47], v[88:91]
    v_mfma_f32_16x16x32_bf16 v[88:91], a[120:123], a[40:43], v[88:91]
    buffer_load_dwordx4 a[20:23], v50, s[20:23], s72 offen offset:2048 sc1
    v_mfma_f32_16x16x32_bf16 v[84:87], a[116:119], a[40:43], v[84:87]
    v_mfma_f32_16x16x32_bf16 v[84:87], a[132:135], a[44:47], v[84:87]
    v_mfma_f32_16x16x32_bf16 v[80:83], a[128:131], a[44:47], v[80:83]
    v_mfma_f32_16x16x32_bf16 v[80:83], a[112:115], a[40:43], v[80:83]
    s_waitcnt vmcnt(13)
    v_mfma_f32_16x16x32_bf16 v[96:99], a[112:115], a[48:51], v[96:99]
    buffer_load_dwordx4 a[24:27], v52, s[20:23], s71 offen offset:3072 sc1
    v_mfma_f32_16x16x32_bf16 v[96:99], a[128:131], a[52:55], v[96:99]
    v_mfma_f32_16x16x32_bf16 v[100:103], a[132:135], a[52:55], v[100:103]
    v_mfma_f32_16x16x32_bf16 v[100:103], a[116:119], a[48:51], v[100:103]
    buffer_load_dwordx4 a[28:31], v52, s[20:23], s72 offen offset:3072 sc1
    v_mfma_f32_16x16x32_bf16 v[104:107], a[120:123], a[48:51], v[104:107]
    v_mfma_f32_16x16x32_bf16 v[104:107], a[136:139], a[52:55], v[104:107]
    v_mfma_f32_16x16x32_bf16 v[108:111], a[140:143], a[52:55], v[108:111]
    v_mfma_f32_16x16x32_bf16 v[108:111], a[124:127], a[48:51], v[108:111]
    s_waitcnt vmcnt(13)
    v_mfma_f32_16x16x32_bf16 v[124:127], a[124:127], a[56:59], v[124:127]
    buffer_load_dwordx4 a[32:35], v222, s[20:23], s71 offen offset:0 sc1
    v_mfma_f32_16x16x32_bf16 v[124:127], a[140:143], a[60:63], v[124:127]
    v_mfma_f32_16x16x32_bf16 v[120:123], a[136:139], a[60:63], v[120:123]
    v_mfma_f32_16x16x32_bf16 v[120:123], a[120:123], a[56:59], v[120:123]
    buffer_load_dwordx4 a[36:39], v222, s[20:23], s72 offen offset:0 sc1
    v_mfma_f32_16x16x32_bf16 v[116:119], a[116:119], a[56:59], v[116:119]
    v_mfma_f32_16x16x32_bf16 v[116:119], a[132:135], a[60:63], v[116:119]
    v_mfma_f32_16x16x32_bf16 v[112:115], a[128:131], a[60:63], v[112:115]
    v_mfma_f32_16x16x32_bf16 v[112:115], a[112:115], a[56:59], v[112:115]
    s_waitcnt vmcnt(13)
    v_mfma_f32_16x16x32_bf16 v[128:131], a[112:115], a[64:67], v[128:131]
    buffer_load_dwordx4 a[40:43], v223, s[20:23], s71 offen offset:1024 sc1
    s_add_u32 s71, s71, 32768
    v_mfma_f32_16x16x32_bf16 v[128:131], a[128:131], a[68:71], v[128:131]
    v_mfma_f32_16x16x32_bf16 v[132:135], a[132:135], a[68:71], v[132:135]
    v_mfma_f32_16x16x32_bf16 v[132:135], a[116:119], a[64:67], v[132:135]
    buffer_load_dwordx4 a[44:47], v223, s[20:23], s72 offen offset:1024 sc1
    s_add_u32 s72, s72, 32768
    s_or_b32 s72, s72, s74
    v_mfma_f32_16x16x32_bf16 v[136:139], a[120:123], a[64:67], v[136:139]
    v_mfma_f32_16x16x32_bf16 v[136:139], a[136:139], a[68:71], v[136:139]
    v_mfma_f32_16x16x32_bf16 v[140:143], a[140:143], a[68:71], v[140:143]
    v_mfma_f32_16x16x32_bf16 v[140:143], a[124:127], a[64:67], v[140:143]
    s_waitcnt vmcnt(12)
    v_mfma_f32_16x16x32_bf16 v[156:159], a[124:127], a[72:75], v[156:159]
    buffer_load_dwordx4 a[48:51], v48, s[20:23], s71 offen offset:0 sc1
    v_mfma_f32_16x16x32_bf16 v[156:159], a[140:143], a[76:79], v[156:159]
    buffer_load_dwordx4 a[52:55], v48, s[20:23], s72 offen offset:0 sc1
    v_mfma_f32_16x16x32_bf16 v[152:155], a[136:139], a[76:79], v[152:155]
    v_mfma_f32_16x16x32_bf16 v[152:155], a[120:123], a[72:75], v[152:155]
    v_mfma_f32_16x16x32_bf16 v[148:151], a[116:119], a[72:75], v[148:151]
    v_mfma_f32_16x16x32_bf16 v[148:151], a[132:135], a[76:79], v[148:151]
    buffer_load_dwordx4 a[56:59], v49, s[20:23], s71 offen offset:1024 sc1
    v_mfma_f32_16x16x32_bf16 v[144:147], a[128:131], a[76:79], v[144:147]
    v_mfma_f32_16x16x32_bf16 v[144:147], a[112:115], a[72:75], v[144:147]
    s_waitcnt vmcnt(13)
    buffer_load_dword v56, v55, s[20:23], 0 offen offset:256 sc1
    v_mfma_f32_16x16x32_bf16 v[64:67], a[144:147], a[0:3], v[64:67]
    v_mfma_f32_16x16x32_bf16 v[64:67], a[160:163], a[4:7], v[64:67]
    buffer_load_dwordx4 v39, s[28:31], s70 offen offset:1024 lds
    v_mfma_f32_16x16x32_bf16 v[68:71], a[164:167], a[4:7], v[68:71]
    v_mfma_f32_16x16x32_bf16 v[68:71], a[148:151], a[0:3], v[68:71]
    v_mfma_f32_16x16x32_bf16 v[72:75], a[152:155], a[0:3], v[72:75]
    v_mfma_f32_16x16x32_bf16 v[72:75], a[168:171], a[4:7], v[72:75]
    buffer_load_dwordx4 v37, s[28:31], s70 offen offset:2048 lds
    v_mfma_f32_16x16x32_bf16 v[76:79], a[172:175], a[4:7], v[76:79]
    v_mfma_f32_16x16x32_bf16 v[76:79], a[156:159], a[0:3], v[76:79]
    s_waitcnt vmcnt(14)
    v_mfma_f32_16x16x32_bf16 v[92:95], a[156:159], a[8:11], v[92:95]
    v_mfma_f32_16x16x32_bf16 v[92:95], a[172:175], a[12:15], v[92:95]
    buffer_load_dwordx4 v40, s[28:31], s70 offen offset:3072 lds
    v_mfma_f32_16x16x32_bf16 v[88:91], a[168:171], a[12:15], v[88:91]
    v_mfma_f32_16x16x32_bf16 v[88:91], a[152:155], a[8:11], v[88:91]
    v_mfma_f32_16x16x32_bf16 v[84:87], a[148:151], a[8:11], v[84:87]
    v_mfma_f32_16x16x32_bf16 v[84:87], a[164:167], a[12:15], v[84:87]
    buffer_load_dwordx4 a[60:63], v49, s[20:23], s72 offen offset:1024 sc1
    v_mfma_f32_16x16x32_bf16 v[80:83], a[160:163], a[12:15], v[80:83]
    v_mfma_f32_16x16x32_bf16 v[80:83], a[144:147], a[8:11], v[80:83]
    s_waitcnt vmcnt(14)
    v_mfma_f32_16x16x32_bf16 v[96:99], a[144:147], a[16:19], v[96:99]
    v_mfma_f32_16x16x32_bf16 v[96:99], a[160:163], a[20:23], v[96:99]
    buffer_load_dwordx4 a[64:67], v50, s[20:23], s71 offen offset:2048 sc1
    v_mfma_f32_16x16x32_bf16 v[100:103], a[164:167], a[20:23], v[100:103]
    v_mfma_f32_16x16x32_bf16 v[100:103], a[148:151], a[16:19], v[100:103]
    v_mfma_f32_16x16x32_bf16 v[104:107], a[152:155], a[16:19], v[104:107]
    v_mfma_f32_16x16x32_bf16 v[104:107], a[168:171], a[20:23], v[104:107]
    buffer_load_dwordx4 a[68:71], v50, s[20:23], s72 offen offset:2048 sc1
    v_mfma_f32_16x16x32_bf16 v[108:111], a[172:175], a[20:23], v[108:111]
    v_mfma_f32_16x16x32_bf16 v[108:111], a[156:159], a[16:19], v[108:111]
    s_waitcnt vmcnt(14)
    v_mfma_f32_16x16x32_bf16 v[124:127], a[156:159], a[24:27], v[124:127]
    v_mfma_f32_16x16x32_bf16 v[124:127], a[172:175], a[28:31], v[124:127]
    buffer_load_dwordx4 a[72:75], v52, s[20:23], s71 offen offset:3072 sc1
    v_mfma_f32_16x16x32_bf16 v[120:123], a[168:171], a[28:31], v[120:123]
    v_mfma_f32_16x16x32_bf16 v[120:123], a[152:155], a[24:27], v[120:123]
    v_mfma_f32_16x16x32_bf16 v[116:119], a[148:151], a[24:27], v[116:119]
    v_mfma_f32_16x16x32_bf16 v[116:119], a[164:167], a[28:31], v[116:119]
    buffer_load_dwordx4 a[76:79], v52, s[20:23], s72 offen offset:3072 sc1
    v_mfma_f32_16x16x32_bf16 v[112:115], a[160:163], a[28:31], v[112:115]
    v_mfma_f32_16x16x32_bf16 v[112:115], a[144:147], a[24:27], v[112:115]
    s_waitcnt vmcnt(14)
    v_mfma_f32_16x16x32_bf16 v[128:131], a[144:147], a[32:35], v[128:131]
    v_mfma_f32_16x16x32_bf16 v[128:131], a[160:163], a[36:39], v[128:131]
    buffer_load_dwordx4 a[0:3], v222, s[20:23], s71 offen offset:0 sc1
    v_mfma_f32_16x16x32_bf16 v[132:135], a[164:167], a[36:39], v[132:135]
    v_mfma_f32_16x16x32_bf16 v[132:135], a[148:151], a[32:35], v[132:135]
    v_mfma_f32_16x16x32_bf16 v[136:139], a[152:155], a[32:35], v[136:139]
    v_mfma_f32_16x16x32_bf16 v[136:139], a[168:171], a[36:39], v[136:139]
    buffer_load_dwordx4 a[4:7], v222, s[20:23], s72 offen offset:0 sc1
    v_mfma_f32_16x16x32_bf16 v[140:143], a[172:175], a[36:39], v[140:143]
    v_mfma_f32_16x16x32_bf16 v[140:143], a[156:159], a[32:35], v[140:143]
    s_waitcnt vmcnt(14)
    v_mfma_f32_16x16x32_bf16 v[156:159], a[156:159], a[40:43], v[156:159]
    v_mfma_f32_16x16x32_bf16 v[156:159], a[172:175], a[44:47], v[156:159]
    buffer_load_dwordx4 a[8:11], v223, s[20:23], s71 offen offset:1024 sc1
    v_mfma_f32_16x16x32_bf16 v[152:155], a[168:171], a[44:47], v[152:155]
    v_mfma_f32_16x16x32_bf16 v[152:155], a[152:155], a[40:43], v[152:155]
    v_mfma_f32_16x16x32_bf16 v[148:151], a[148:151], a[40:43], v[148:151]
    v_mfma_f32_16x16x32_bf16 v[148:151], a[164:167], a[44:47], v[148:151]
    buffer_load_dwordx4 a[12:15], v223, s[20:23], s72 offen offset:1024 sc1
    v_mfma_f32_16x16x32_bf16 v[144:147], a[160:163], a[44:47], v[144:147]
    v_mfma_f32_16x16x32_bf16 v[144:147], a[144:147], a[40:43], v[144:147]
    s_waitcnt vmcnt(14)
    v_mfma_f32_16x16x32_bf16 v[64:67], a[176:179], a[48:51], v[64:67]
    s_waitcnt vmcnt(12)
    v_cmp_ne_u32 vcc, 1, v56
    s_nop 0
    s_cbranch_vccnz L_spin_31
L_ok_32:
    s_barrier
    v_mfma_f32_16x16x32_bf16 v[64:67], a[192:195], a[52:55], v[64:67]
    buffer_load_dwordx4 a[16:19], v48, s[20:23], s45 offen offset:0 sc1
    v_mfma_f32_16x16x32_bf16 v[68:71], a[196:199], a[52:55], v[68:71]
    v_mfma_f32_16x16x32_bf16 v[68:71], a[180:183], a[48:51], v[68:71]
    v_mfma_f32_16x16x32_bf16 v[72:75], a[184:187], a[48:51], v[72:75]
    v_mfma_f32_16x16x32_bf16 v[72:75], a[200:203], a[52:55], v[72:75]
    buffer_load_dwordx4 a[20:23], v48, s[20:23], s47 offen offset:0 sc1
    v_mfma_f32_16x16x32_bf16 v[76:79], a[204:207], a[52:55], v[76:79]
    v_mfma_f32_16x16x32_bf16 v[76:79], a[188:191], a[48:51], v[76:79]
    s_waitcnt vmcnt(10)
    v_mfma_f32_16x16x32_bf16 v[92:95], a[188:191], a[56:59], v[92:95]
    v_mfma_f32_16x16x32_bf16 v[92:95], a[204:207], a[60:63], v[92:95]
    buffer_load_dwordx4 a[24:27], v48, s[20:23], s48 offen offset:0 sc1
    v_mfma_f32_16x16x32_bf16 v[88:91], a[200:203], a[60:63], v[88:91]
    v_mul_f32 v64, v24, v64
    v_mul_f32 v65, v24, v65
    v_mfma_f32_16x16x32_bf16 v[88:91], a[184:187], a[56:59], v[88:91]
    buffer_load_dwordx4 a[28:31], v48, s[20:23], s65 offen offset:0 sc1
    v_mfma_f32_16x16x32_bf16 v[84:87], a[180:183], a[56:59], v[84:87]
    v_mul_f32 v66, v24, v66
    v_mul_f32 v67, v24, v67
    v_mfma_f32_16x16x32_bf16 v[84:87], a[196:199], a[60:63], v[84:87]
    v_mul_f32 v68, v24, v68
    v_mul_f32 v69, v24, v69
    v_mfma_f32_16x16x32_bf16 v[80:83], a[192:195], a[60:63], v[80:83]
    v_mul_f32 v70, v24, v70
    v_mul_f32 v71, v24, v71
    v_mfma_f32_16x16x32_bf16 v[80:83], a[176:179], a[56:59], v[80:83]
    s_waitcnt vmcnt(10)
    v_mul_f32 v72, v24, v72
    v_mul_f32 v73, v24, v73
    v_mfma_f32_16x16x32_bf16 v[96:99], a[176:179], a[64:67], v[96:99]
    buffer_load_dwordx4 a[32:35], v48, s[20:23], s84 offen offset:0 sc1
    v_mfma_f32_16x16x32_bf16 v[96:99], a[192:195], a[68:71], v[96:99]
    v_mul_f32 v74, v24, v74
    v_mul_f32 v75, v24, v75
    v_mfma_f32_16x16x32_bf16 v[100:103], a[196:199], a[68:71], v[100:103]
    v_mul_f32 v76, v24, v76
    v_mul_f32 v77, v24, v77
    v_mfma_f32_16x16x32_bf16 v[100:103], a[180:183], a[64:67], v[100:103]
    buffer_load_dwordx4 a[36:39], v49, s[20:23], s45 offen offset:1024 sc1
    v_mfma_f32_16x16x32_bf16 v[104:107], a[184:187], a[64:67], v[104:107]
    v_mul_f32 v78, v24, v78
    v_mul_f32 v79, v24, v79
    v_mfma_f32_16x16x32_bf16 v[104:107], a[200:203], a[68:71], v[104:107]
    v_mul_f32 v80, v25, v80
    v_mul_f32 v81, v25, v81
    v_mfma_f32_16x16x32_bf16 v[108:111], a[204:207], a[68:71], v[108:111]
    ds_read_b64_tr_b16 a[96:97], v41 offset:32768
    ds_read_b64_tr_b16 a[98:99], v41 offset:33280
    v_mfma_f32_16x16x32_bf16 v[108:111], a[188:191], a[64:67], v[108:111]
    s_waitcnt vmcnt(10)
    v_mul_f32 v82, v25, v82
    v_mul_f32 v83, v25, v83
    v_mfma_f32_16x16x32_bf16 v[124:127], a[188:191], a[72:75], v[124:127]
    s_nop 0
    s_waitcnt lgkmcnt(8)
    ds_read_b64_tr_b16 a[100:101], v42 offset:32768
    ds_read_b64_tr_b16 a[102:103], v42 offset:33280
    v_mfma_f32_16x16x32_bf16 v[124:127], a[204:207], a[76:79], v[124:127]
    buffer_load_dwordx4 a[40:43], v49, s[20:23], s47 offen offset:1024 sc1
    v_mfma_f32_16x16x32_bf16 v[120:123], a[200:203], a[76:79], v[120:123]
    s_nop 0
    ds_read_b64_tr_b16 a[104:105], v43 offset:32768
    ds_read_b64_tr_b16 a[106:107], v43 offset:33280
    v_mfma_f32_16x16x32_bf16 v[120:123], a[184:187], a[72:75], v[120:123]
    buffer_load_dwordx4 a[44:47], v49, s[20:23], s48 offen offset:1024 sc1
    v_mfma_f32_16x16x32_bf16 v[116:119], a[180:183], a[72:75], v[116:119]
    s_nop 0
    ds_read_b64_tr_b16 a[108:109], v44 offset:32768
    ds_read_b64_tr_b16 a[110:111], v44 offset:33280
    v_mfma_f32_16x16x32_bf16 v[116:119], a[196:199], a[76:79], v[116:119]
    v_mul_f32 v84, v25, v84
    v_mul_f32 v85, v25, v85
    v_mfma_f32_16x16x32_bf16 v[112:115], a[192:195], a[76:79], v[112:115]
    v_mul_f32 v86, v25, v86
    v_mul_f32 v87, v25, v87
    v_mfma_f32_16x16x32_bf16 v[112:115], a[176:179], a[72:75], v[112:115]
    s_waitcnt vmcnt(10)
    v_mul_f32 v88, v25, v88
    v_mul_f32 v89, v25, v89
    v_mfma_f32_16x16x32_bf16 v[128:131], a[176:179], a[0:3], v[128:131]
    buffer_load_dwordx4 a[48:51], v49, s[20:23], s65 offen offset:1024 sc1
    v_mfma_f32_16x16x32_bf16 v[128:131], a[192:195], a[4:7], v[128:131]
    v_mul_f32 v90, v25, v90
    v_mul_f32 v91, v25, v91
    v_mfma_f32_16x16x32_bf16 v[132:135], a[196:199], a[4:7], v[132:135]
    v_mul_f32 v92, v25, v92
    v_mul_f32 v93, v25, v93
    v_mfma_f32_16x16x32_bf16 v[132:135], a[180:183], a[0:3], v[132:135]
    buffer_load_dwordx4 a[52:55], v49, s[20:23], s84 offen offset:1024 sc1
    v_mfma_f32_16x16x32_bf16 v[136:139], a[184:187], a[0:3], v[136:139]
    v_mul_f32 v94, v25, v94
    v_mul_f32 v95, v25, v95
    v_mfma_f32_16x16x32_bf16 v[136:139], a[200:203], a[4:7], v[136:139]
    v_mul_f32 v96, v26, v96
    v_mul_f32 v97, v26, v97
    v_mfma_f32_16x16x32_bf16 v[140:143], a[204:207], a[4:7], v[140:143]
    v_mul_f32 v98, v26, v98
    v_mul_f32 v99, v26, v99
    v_mfma_f32_16x16x32_bf16 v[140:143], a[188:191], a[0:3], v[140:143]
    s_waitcnt vmcnt(10)
    v_mul_f32 v100, v26, v100
    v_mul_f32 v101, v26, v101
    v_mfma_f32_16x16x32_bf16 v[156:159], a[188:191], a[8:11], v[156:159]
    buffer_load_dwordx4 a[56:59], v50, s[20:23], s45 offen offset:2048 sc1
    v_mfma_f32_16x16x32_bf16 v[156:159], a[204:207], a[12:15], v[156:159]
    v_mul_f32 v102, v26, v102
    v_mul_f32 v103, v26, v103
    v_mfma_f32_16x16x32_bf16 v[152:155], a[200:203], a[12:15], v[152:155]
    v_mul_f32 v104, v26, v104
    v_mul_f32 v105, v26, v105
    v_mfma_f32_16x16x32_bf16 v[152:155], a[184:187], a[8:11], v[152:155]
    buffer_load_dwordx4 a[60:63], v50, s[20:23], s47 offen offset:2048 sc1
    v_mfma_f32_16x16x32_bf16 v[148:151], a[180:183], a[8:11], v[148:151]
    v_mul_f32 v106, v26, v106
    v_mul_f32 v107, v26, v107
    v_mfma_f32_16x16x32_bf16 v[148:151], a[196:199], a[12:15], v[148:151]
    v_mul_f32 v108, v26, v108
    v_mul_f32 v109, v26, v109
    v_mfma_f32_16x16x32_bf16 v[144:147], a[192:195], a[12:15], v[144:147]
    v_mul_f32 v110, v26, v110
    v_mul_f32 v111, v26, v111
    v_mfma_f32_16x16x32_bf16 v[144:147], a[176:179], a[8:11], v[144:147]
    s_waitcnt vmcnt(7) lgkmcnt(0)
    v_mul_f32 v112, v27, v112
    v_mul_f32 v113, v27, v113
    v_mfma_f32_16x16x32_bf16 v[64:67], a[208:211], a[16:19], v[64:67]
    buffer_load_dwordx4 a[64:67], v50, s[20:23], s48 offen offset:2048 sc1
    v_mfma_f32_16x16x32_bf16 v[64:67], a[224:227], a[20:23], v[64:67]
    v_mul_f32 v114, v27, v114
    v_mul_f32 v115, v27, v115
    v_mfma_f32_16x16x32_bf16 v[64:67], a[240:243], a[24:27], v[64:67]
    v_mul_f32 v116, v27, v116
    v_mul_f32 v117, v27, v117
    v_mfma_f32_16x16x32_bf16 v[64:67], a[80:83], a[28:31], v[64:67]
    buffer_load_dwordx4 a[68:71], v50, s[20:23], s65 offen offset:2048 sc1
    v_mfma_f32_16x16x32_bf16 v[64:67], a[96:99], a[32:35], v[64:67]
    v_mul_f32 v118, v27, v118
    v_mul_f32 v119, v27, v119
    v_mfma_f32_16x16x32_bf16 v[68:71], a[212:215], a[16:19], v[68:71]
    v_mul_f32 v120, v27, v120
    v_mul_f32 v121, v27, v121
    v_mfma_f32_16x16x32_bf16 v[68:71], a[228:231], a[20:23], v[68:71]
    v_mul_f32 v122, v27, v122
    v_mul_f32 v123, v27, v123
    v_mfma_f32_16x16x32_bf16 v[68:71], a[244:247], a[24:27], v[68:71]
    buffer_load_dwordx4 a[72:75], v50, s[20:23], s84 offen offset:2048 sc1
    v_mfma_f32_16x16x32_bf16 v[68:71], a[84:87], a[28:31], v[68:71]
    v_mul_f32 v124, v27, v124
    v_mul_f32 v125, v27, v125
    v_mfma_f32_16x16x32_bf16 v[68:71], a[100:103], a[32:35], v[68:71]
    v_mul_f32 v126, v27, v126
    v_mul_f32 v127, v27, v127
    v_mfma_f32_16x16x32_bf16 v[72:75], a[216:219], a[16:19], v[72:75]
    ds_write_b128 v8, v[64:67] offset:0
    v_mfma_f32_16x16x32_bf16 v[72:75], a[232:235], a[20:23], v[72:75]
    buffer_load_dwordx4 a[76:79], v52, s[20:23], s45 offen offset:3072 sc1
    v_mfma_f32_16x16x32_bf16 v[72:75], a[248:251], a[24:27], v[72:75]
    v_mul_f32 v128, v28, v128
    v_mul_f32 v129, v28, v129
    v_mfma_f32_16x16x32_bf16 v[72:75], a[88:91], a[28:31], v[72:75]
    v_mul_f32 v130, v28, v130
    v_mul_f32 v131, v28, v131
    v_mfma_f32_16x16x32_bf16 v[72:75], a[104:107], a[32:35], v[72:75]
    v_mul_f32 v132, v28, v132
    v_mul_f32 v133, v28, v133
    v_mfma_f32_16x16x32_bf16 v[76:79], a[220:223], a[16:19], v[76:79]
    ds_write_b128 v9, v[68:71] offset:0
    v_mfma_f32_16x16x32_bf16 v[76:79], a[236:239], a[20:23], v[76:79]
    buffer_load_dwordx4 a[0:3], v52, s[20:23], s47 offen offset:3072 sc1
    v_mfma_f32_16x16x32_bf16 v[76:79], a[252:255], a[24:27], v[76:79]
    v_mul_f32 v134, v28, v134
    v_mul_f32 v135, v28, v135
    v_mfma_f32_16x16x32_bf16 v[76:79], a[92:95], a[28:31], v[76:79]
    v_mul_f32 v136, v28, v136
    v_mul_f32 v137, v28, v137
    v_mfma_f32_16x16x32_bf16 v[76:79], a[108:111], a[32:35], v[76:79]
    s_waitcnt vmcnt(7)
    v_mul_f32 v138, v28, v138
    v_mul_f32 v139, v28, v139
    v_mfma_f32_16x16x32_bf16 v[80:83], a[208:211], a[36:39], v[80:83]
    ds_write_b128 v8, v[72:75] offset:128
    v_mfma_f32_16x16x32_bf16 v[80:83], a[224:227], a[40:43], v[80:83]
    buffer_load_dwordx4 a[4:7], v52, s[20:23], s48 offen offset:3072 sc1
    v_mfma_f32_16x16x32_bf16 v[80:83], a[240:243], a[44:47], v[80:83]
    v_mul_f32 v140, v28, v140
    v_mul_f32 v141, v28, v141
    v_mfma_f32_16x16x32_bf16 v[80:83], a[80:83], a[48:51], v[80:83]
    buffer_load_dwordx4 a[8:11], v52, s[20:23], s65 offen offset:3072 sc1
    v_mfma_f32_16x16x32_bf16 v[80:83], a[96:99], a[52:55], v[80:83]
    v_mul_f32 v142, v28, v142
    v_mul_f32 v143, v28, v143
    v_mfma_f32_16x16x32_bf16 v[84:87], a[212:215], a[36:39], v[84:87]
    ds_write_b128 v9, v[76:79] offset:128
    v_mfma_f32_16x16x32_bf16 v[84:87], a[228:231], a[40:43], v[84:87]
    v_mul_f32 v144, v29, v144
    v_mul_f32 v145, v29, v145
    v_mfma_f32_16x16x32_bf16 v[84:87], a[244:247], a[44:47], v[84:87]
    buffer_load_dwordx4 a[12:15], v52, s[20:23], s84 offen offset:3072 sc1
L_pad6:
    s_cmp_eq_u32 s92, 1
    s_cbranch_scc1 L_main
    v_mfma_f32_16x16x32_bf16 v[84:87], a[84:87], a[48:51], v[84:87]
    v_mul_f32 v146, v29, v146
    v_mul_f32 v147, v29, v147
    v_mfma_f32_16x16x32_bf16 v[84:87], a[100:103], a[52:55], v[84:87]
    buffer_load_dwordx4 a[16:19], v222, s[20:23], s45 offen offset:0 sc1
    v_mfma_f32_16x16x32_bf16 v[88:91], a[216:219], a[36:39], v[88:91]
    ds_write_b128 v8, v[80:83] offset:4096
    v_mfma_f32_16x16x32_bf16 v[88:91], a[232:235], a[40:43], v[88:91]
    v_mul_f32 v148, v29, v148
    v_mul_f32 v149, v29, v149
    v_mfma_f32_16x16x32_bf16 v[88:91], a[248:251], a[44:47], v[88:91]
    v_mul_f32 v150, v29, v150
    v_mul_f32 v151, v29, v151
    v_mfma_f32_16x16x32_bf16 v[88:91], a[88:91], a[48:51], v[88:91]
    buffer_load_dwordx4 a[20:23], v222, s[20:23], s47 offen offset:0 sc1
    v_mfma_f32_16x16x32_bf16 v[88:91], a[104:107], a[52:55], v[88:91]
    v_mul_f32 v152, v29, v152
    v_mul_f32 v153, v29, v153
    v_mfma_f32_16x16x32_bf16 v[92:95], a[220:223], a[36:39], v[92:95]
    ds_write_b128 v9, v[84:87] offset:4096
    v_mfma_f32_16x16x32_bf16 v[92:95], a[236:239], a[40:43], v[92:95]
    v_mul_f32 v154, v29, v154
    v_mul_f32 v155, v29, v155
    v_mfma_f32_16x16x32_bf16 v[92:95], a[252:255], a[44:47], v[92:95]
    buffer_load_dwordx4 a[24:27], v222, s[20:23], s48 offen offset:0 sc1
    v_mfma_f32_16x16x32_bf16 v[92:95], a[92:95], a[48:51], v[92:95]
    v_mul_f32 v156, v29, v156
    v_mul_f32 v157, v29, v157
    v_mfma_f32_16x16x32_bf16 v[92:95], a[108:111], a[52:55], v[92:95]
    s_waitcnt vmcnt(8)
    v_mul_f32 v158, v29, v158
    v_mul_f32 v159, v29, v159
    v_mfma_f32_16x16x32_bf16 v[96:99], a[208:211], a[56:59], v[96:99]
    ds_write_b128 v8, v[88:91] offset:4224
    v_mfma_f32_16x16x32_bf16 v[96:99], a[224:227], a[60:63], v[96:99]
    buffer_load_dwordx4 a[28:31], v222, s[20:23], s65 offen offset:0 sc1
    v_mfma_f32_16x16x32_bf16 v[96:99], a[240:243], a[64:67], v[96:99]
    v_mfma_f32_16x16x32_bf16 v[96:99], a[80:83], a[68:71], v[96:99]
    v_mfma_f32_16x16x32_bf16 v[96:99], a[96:99], a[72:75], v[96:99]
    v_mfma_f32_16x16x32_bf16 v[100:103], a[212:215], a[56:59], v[100:103]
    ds_write_b128 v9, v[92:95] offset:4224
    v_mfma_f32_16x16x32_bf16 v[100:103], a[228:231], a[60:63], v[100:103]
    buffer_load_dwordx4 a[32:35], v222, s[20:23], s84 offen offset:0 sc1
    v_mfma_f32_16x16x32_bf16 v[100:103], a[244:247], a[64:67], v[100:103]
    v_mfma_f32_16x16x32_bf16 v[100:103], a[84:87], a[68:71], v[100:103]
    v_mfma_f32_16x16x32_bf16 v[100:103], a[100:103], a[72:75], v[100:103]
    s_waitcnt lgkmcnt(0)
    s_barrier
    v_mfma_f32_16x16x32_bf16 v[104:107], a[216:219], a[56:59], v[104:107]
    ds_write_b128 v8, v[96:99] offset:32768
    v_mfma_f32_16x16x32_bf16 v[104:107], a[232:235], a[60:63], v[104:107]
    s_nop 0
    ds_read_b128 v[160:163], v16 offset:0
    ds_read_b128 v[164:167], v17 offset:0
    v_mfma_f32_16x16x32_bf16 v[104:107], a[248:251], a[64:67], v[104:107]
    s_nop 0
    ds_read_b128 v[168:171], v16 offset:8192
    ds_read_b128 v[172:175], v17 offset:8192
    v_mfma_f32_16x16x32_bf16 v[104:107], a[88:91], a[68:71], v[104:107]
    s_nop 0
    ds_read_b128 v[176:179], v16 offset:16384
    ds_read_b128 v[180:183], v17 offset:16384
    v_mfma_f32_16x16x32_bf16 v[104:107], a[104:107], a[72:75], v[104:107]
    s_nop 0
    ds_read_b128 v[184:187], v16 offset:24576
    ds_read_b128 v[188:191], v17 offset:24576
    v_mfma_f32_16x16x32_bf16 v[108:111], a[220:223], a[56:59], v[108:111]
    ds_write_b128 v9, v[100:103] offset:32768
    v_mfma_f32_16x16x32_bf16 v[108:111], a[236:239], a[60:63], v[108:111]
    buffer_load_dwordx4 a[36:39], v223, s[20:23], s45 offen offset:1024 sc1
    v_mfma_f32_16x16x32_bf16 v[108:111], a[252:255], a[64:67], v[108:111]
    buffer_load_dwordx4 a[40:43], v223, s[20:23], s47 offen offset:1024 sc1
    v_mfma_f32_16x16x32_bf16 v[108:111], a[92:95], a[68:71], v[108:111]
    buffer_load_dwordx4 a[44:47], v223, s[20:23], s48 offen offset:1024 sc1
    v_mfma_f32_16x16x32_bf16 v[108:111], a[108:111], a[72:75], v[108:111]
    s_waitcnt vmcnt(8)
    v_mfma_f32_16x16x32_bf16 v[112:115], a[208:211], a[76:79], v[112:115]
    ds_write_b128 v8, v[104:107] offset:32896
    s_waitcnt lgkmcnt(2)
    v_mfma_f32_16x16x32_bf16 v[112:115], a[224:227], a[0:3], v[112:115]
    buffer_load_dwordx4 a[48:51], v223, s[20:23], s65 offen offset:1024 sc1
    v_mfma_f32_16x16x32_bf16 v[112:115], a[240:243], a[4:7], v[112:115]
    v_add_f32 v160, v160, v168
    v_add_f32 v161, v161, v169
    v_mfma_f32_16x16x32_bf16 v[112:115], a[80:83], a[8:11], v[112:115]
    v_add_f32 v162, v162, v170
    v_add_f32 v163, v163, v171
    v_mfma_f32_16x16x32_bf16 v[112:115], a[96:99], a[12:15], v[112:115]
    v_add_f32 v164, v164, v172
    v_add_f32 v165, v165, v173
    v_mfma_f32_16x16x32_bf16 v[116:119], a[212:215], a[76:79], v[116:119]
    ds_write_b128 v9, v[108:111] offset:32896
    v_mfma_f32_16x16x32_bf16 v[116:119], a[228:231], a[0:3], v[116:119]
    buffer_load_dwordx4 a[52:55], v223, s[20:23], s84 offen offset:1024 sc1
    v_mfma_f32_16x16x32_bf16 v[116:119], a[244:247], a[4:7], v[116:119]
    v_add_f32 v166, v166, v174
    v_add_f32 v167, v167, v175
    v_mfma_f32_16x16x32_bf16 v[116:119], a[84:87], a[8:11], v[116:119]
    v_add_f32 v176, v176, v184
    v_add_f32 v177, v177, v185
    v_mfma_f32_16x16x32_bf16 v[116:119], a[100:103], a[12:15], v[116:119]
    v_add_f32 v178, v178, v186
    v_add_f32 v179, v179, v187
    v_mfma_f32_16x16x32_bf16 v[120:123], a[216:219], a[76:79], v[120:123]
    ds_write_b128 v8, v[112:115] offset:36864
    v_mfma_f32_16x16x32_bf16 v[120:123], a[232:235], a[0:3], v[120:123]
    v_add_f32 v180, v180, v188
    v_add_f32 v181, v181, v189
    v_mfma_f32_16x16x32_bf16 v[120:123], a[248:251], a[4:7], v[120:123]
    v_add_f32 v182, v182, v190
    v_add_f32 v183, v183, v191
    v_mfma_f32_16x16x32_bf16 v[120:123], a[88:91], a[8:11], v[120:123]
    v_add_f32 v160, v160, v176
    v_add_f32 v161, v161, v177
    v_mfma_f32_16x16x32_bf16 v[120:123], a[104:107], a[12:15], v[120:123]
    v_add_f32 v162, v162, v178
    v_add_f32 v163, v163, v179
    v_mfma_f32_16x16x32_bf16 v[124:127], a[220:223], a[76:79], v[124:127]
    ds_write_b128 v9, v[116:119] offset:36864
    v_mfma_f32_16x16x32_bf16 v[124:127], a[236:239], a[0:3], v[124:127]
    v_add_f32 v164, v164, v180
    v_add_f32 v165, v165, v181
    v_mfma_f32_16x16x32_bf16 v[124:127], a[252:255], a[4:7], v[124:127]
    v_add_f32 v166, v166, v182
    v_add_f32 v167, v167, v183
    v_mfma_f32_16x16x32_bf16 v[124:127], a[92:95], a[8:11], v[124:127]
    v_cvt_pk_bf16_f32 v208, v160, v161
    v_cvt_pk_bf16_f32 v209, v162, v163
    v_mfma_f32_16x16x32_bf16 v[124:127], a[108:111], a[12:15], v[124:127]
    s_waitcnt vmcnt(5)
    v_cvt_pk_bf16_f32 v210, v164, v165
    v_cvt_pk_bf16_f32 v211, v166, v167
    v_mfma_f32_16x16x32_bf16 v[128:131], a[208:211], a[16:19], v[128:131]
    ds_write_b128 v8, v[120:123] offset:36992
    v_mfma_f32_16x16x32_bf16 v[128:131], a[224:227], a[20:23], v[128:131]
    buffer_store_dwordx4 v[208:211], v20, s[32:35], 0 offen sc1
    v_mfma_f32_16x16x32_bf16 v[128:131], a[240:243], a[24:27], v[128:131]
    v_mfma_f32_16x16x32_bf16 v[128:131], a[80:83], a[28:31], v[128:131]
    v_mfma_f32_16x16x32_bf16 v[128:131], a[96:99], a[32:35], v[128:131]
    v_mfma_f32_16x16x32_bf16 v[132:135], a[212:215], a[16:19], v[132:135]
    ds_write_b128 v9, v[124:127] offset:36992
    v_mfma_f32_16x16x32_bf16 v[132:135], a[228:231], a[20:23], v[132:135]
    v_mfma_f32_16x16x32_bf16 v[132:135], a[244:247], a[24:27], v[132:135]
    v_mfma_f32_16x16x32_bf16 v[132:135], a[84:87], a[28:31], v[132:135]
    v_mfma_f32_16x16x32_bf16 v[132:135], a[100:103], a[32:35], v[132:135]
    s_waitcnt lgkmcnt(0)
    s_barrier
    v_mfma_f32_16x16x32_bf16 v[136:139], a[216:219], a[16:19], v[136:139]
    ds_write_b128 v10, v[128:131] offset:0
    v_mfma_f32_16x16x32_bf16 v[136:139], a[232:235], a[20:23], v[136:139]
    s_nop 0
    ds_read_b128 v[160:163], v16 offset:32768
    ds_read_b128 v[164:167], v17 offset:32768
    v_mfma_f32_16x16x32_bf16 v[136:139], a[248:251], a[24:27], v[136:139]
    s_nop 0
    ds_read_b128 v[168:171], v16 offset:40960
    ds_read_b128 v[172:175], v17 offset:40960
    v_mfma_f32_16x16x32_bf16 v[136:139], a[88:91], a[28:31], v[136:139]
    s_nop 0
    ds_read_b128 v[176:179], v16 offset:49152
    ds_read_b128 v[180:183], v17 offset:49152
    v_mfma_f32_16x16x32_bf16 v[136:139], a[104:107], a[32:35], v[136:139]
    s_nop 0
    ds_read_b128 v[184:187], v16 offset:57344
    ds_read_b128 v[188:191], v17 offset:57344
    v_mfma_f32_16x16x32_bf16 v[140:143], a[220:223], a[16:19], v[140:143]
    ds_write_b128 v11, v[132:135] offset:0
    v_mfma_f32_16x16x32_bf16 v[140:143], a[236:239], a[20:23], v[140:143]
    v_mfma_f32_16x16x32_bf16 v[140:143], a[252:255], a[24:27], v[140:143]
    v_mfma_f32_16x16x32_bf16 v[140:143], a[92:95], a[28:31], v[140:143]
    v_mfma_f32_16x16x32_bf16 v[140:143], a[108:111], a[32:35], v[140:143]
    s_waitcnt vmcnt(1)
    v_mfma_f32_16x16x32_bf16 v[144:147], a[208:211], a[36:39], v[144:147]
    ds_write_b128 v10, v[136:139] offset:128
    s_waitcnt lgkmcnt(2)
    v_mfma_f32_16x16x32_bf16 v[144:147], a[224:227], a[40:43], v[144:147]
    v_add_f32 v160, v160, v168
    v_add_f32 v161, v161, v169
    v_mfma_f32_16x16x32_bf16 v[144:147], a[240:243], a[44:47], v[144:147]
    v_add_f32 v162, v162, v170
    v_add_f32 v163, v163, v171
    v_mfma_f32_16x16x32_bf16 v[144:147], a[80:83], a[48:51], v[144:147]
    v_add_f32 v164, v164, v172
    v_add_f32 v165, v165, v173
    v_mfma_f32_16x16x32_bf16 v[144:147], a[96:99], a[52:55], v[144:147]
    v_add_f32 v166, v166, v174
    v_add_f32 v167, v167, v175
    v_mfma_f32_16x16x32_bf16 v[148:151], a[212:215], a[36:39], v[148:151]
    ds_write_b128 v11, v[140:143] offset:128
    v_mfma_f32_16x16x32_bf16 v[148:151], a[228:231], a[40:43], v[148:151]
    v_add_f32 v176, v176, v184
    v_add_f32 v177, v177, v185
    v_mfma_f32_16x16x32_bf16 v[148:151], a[244:247], a[44:47], v[148:151]
    v_add_f32 v178, v178, v186
    v_add_f32 v179, v179, v187
    v_mfma_f32_16x16x32_bf16 v[148:151], a[84:87], a[48:51], v[148:151]
    v_add_f32 v180, v180, v188
    v_add_f32 v181, v181, v189
    v_mfma_f32_16x16x32_bf16 v[148:151], a[100:103], a[52:55], v[148:151]
    v_add_f32 v182, v182, v190
    v_add_f32 v183, v183, v191
    v_mfma_f32_16x16x32_bf16 v[152:155], a[216:219], a[36:39], v[152:155]
    ds_write_b128 v10, v[144:147] offset:4096
    v_mfma_f32_16x16x32_bf16 v[152:155], a[232:235], a[40:43], v[152:155]
    v_add_f32 v160, v160, v176
    v_add_f32 v161, v161, v177
    v_mfma_f32_16x16x32_bf16 v[152:155], a[248:251], a[44:47], v[152:155]
    v_add_f32 v162, v162, v178
    v_add_f32 v163, v163, v179
    v_mfma_f32_16x16x32_bf16 v[152:155], a[88:91], a[48:51], v[152:155]
    v_add_f32 v164, v164, v180
    v_add_f32 v165, v165, v181
    v_mfma_f32_16x16x32_bf16 v[152:155], a[104:107], a[52:55], v[152:155]
    v_add_f32 v166, v166, v182
    v_add_f32 v167, v167, v183
    v_mfma_f32_16x16x32_bf16 v[156:159], a[220:223], a[36:39], v[156:159]
    ds_write_b128 v11, v[148:151] offset:4096
    v_mfma_f32_16x16x32_bf16 v[156:159], a[236:239], a[40:43], v[156:159]
    v_cvt_pk_bf16_f32 v208, v160, v161
    v_cvt_pk_bf16_f32 v209, v162, v163
    v_mfma_f32_16x16x32_bf16 v[156:159], a[252:255], a[44:47], v[156:159]
    v_cvt_pk_bf16_f32 v210, v164, v165
    v_cvt_pk_bf16_f32 v211, v166, v167
    v_mfma_f32_16x16x32_bf16 v[156:159], a[92:95], a[48:51], v[156:159]
    buffer_store_dwordx4 v[208:211], v21, s[32:35], 0 offen sc1
    v_mfma_f32_16x16x32_bf16 v[156:159], a[108:111], a[52:55], v[156:159]
    ds_write_b128 v10, v[152:155] offset:4224
    s_nop 6
    ds_write_b128 v11, v[156:159] offset:4224
    s_waitcnt lgkmcnt(0)
    s_barrier
    ds_read_b128 v[160:163], v18 offset:0
    ds_read_b128 v[164:167], v19 offset:0
    ds_read_b128 v[168:171], v18 offset:8192
    ds_read_b128 v[172:175], v19 offset:8192
    ds_read_b128 v[176:179], v18 offset:16384
    ds_read_b128 v[180:183], v19 offset:16384
    ds_read_b128 v[184:187], v18 offset:24576
    ds_read_b128 v[188:191], v19 offset:24576
    s_waitcnt lgkmcnt(5)
    v_pk_add_f32 v[160:161], v[160:161], v[168:169]
    v_pk_add_f32 v[162:163], v[162:163], v[170:171]
    s_waitcnt lgkmcnt(4)
    v_pk_add_f32 v[164:165], v[164:165], v[172:173]
    v_pk_add_f32 v[166:167], v[166:167], v[174:175]
    s_waitcnt lgkmcnt(1)
    v_pk_add_f32 v[176:177], v[176:177], v[184:185]
    v_pk_add_f32 v[178:179], v[178:179], v[186:187]
    s_waitcnt lgkmcnt(0)
    v_pk_add_f32 v[180:181], v[180:181], v[188:189]
    v_pk_add_f32 v[182:183], v[182:183], v[190:191]
    v_pk_add_f32 v[160:161], v[160:161], v[176:177]
    v_pk_add_f32 v[162:163], v[162:163], v[178:179]
    v_pk_add_f32 v[164:165], v[164:165], v[180:181]
    v_pk_add_f32 v[166:167], v[166:167], v[182:183]
    v_cvt_pk_bf16_f32 v208, v160, v161
    v_cvt_pk_bf16_f32 v209, v162, v163
    v_cvt_pk_bf16_f32 v210, v164, v165
    v_cvt_pk_bf16_f32 v211, v166, v167
    buffer_store_dwordx4 v[208:211], v22, s[32:35], 0 offen sc1
L_fin_5:
L_done_1:
    s_endpgm
L_spin_7:
    s_mov_b32 s76, 400000
L_spin_7_l:
    s_sleep 1
    buffer_load_dword v56, v54, s[20:23], 0 offen offset:0 sc1
    s_waitcnt vmcnt(0)
    v_cmp_ne_u32 vcc, 1, v56
    s_sub_u32 s76, s76, 1
    s_cbranch_scc1 L_ok_8
    s_cbranch_vccnz L_spin_7_l
    s_branch L_ok_8
L_spin_11:
    s_mov_b32 s76, 400000
L_spin_11_l:
    s_sleep 1
    buffer_load_dword v56, v63, s[36:39], 0 offen sc1
    s_waitcnt vmcnt(0)
    v_cmp_eq_u32 vcc, 0, v56
    s_sub_u32 s76, s76, 1
    s_cbranch_scc1 L_ok_12
    s_cbranch_vccnz L_spin_11_l
    s_branch L_ok_12
L_spin_13:
    s_mov_b32 s76, 400000
L_spin_13_l:
    s_sleep 1
    buffer_load_dword v56, v63, s[36:39], 0 offen sc1
    s_waitcnt vmcnt(0)
    v_cmp_eq_u32 vcc, 0, v56
    s_sub_u32 s76, s76, 1
    s_cbranch_scc1 L_ok_14
    s_cbranch_vccnz L_spin_13_l
    s_branch L_ok_14
L_vrole_9:
    s_waitcnt lgkmcnt(10)
    v_mfma_f32_16x16x32_bf16 v[96:99], a[0:3], v[64:67], 0
    s_waitcnt lgkmcnt(6)
    ds_read_b64_tr_b16 v[88:89], v11 offset:0
    ds_read_b64_tr_b16 v[90:91], v11 offset:512
    v_mfma_f32_16x16x32_bf16 v[96:99], a[8:11], v[68:71], v[96:99]
    buffer_load_dwordx4 v24, s[8:11], s93 offen offset:0 lds
    v_lshl_add_u32 v31, v3, 10, v6
    v_lshlrev_b32 v6, 1, v3
    s_lshr_b32 s76, s6, 3
    s_xor_b32 s76, s76, 1
    s_lshl_b32 s76, s76, 13
    s_and_b32 s49, s6, 7
    v_mfma_f32_16x16x32_bf16 v[100:103], a[12:15], v[68:71], 0
    s_waitcnt lgkmcnt(6)
    ds_read_b64_tr_b16 v[92:93], v11 offset:8192
    ds_read_b64_tr_b16 v[94:95], v11 offset:8704
    v_mfma_f32_16x16x32_bf16 v[100:103], a[4:7], v[64:67], v[100:103]
    s_waitcnt vmcnt(3)
    s_barrier
    buffer_load_dwordx4 v25, s[8:11], s93 offen offset:1024 lds
    s_lshl_b32 s49, s49, 22
    s_add_u32 s49, s49, s76
    s_add_u32 s49, s49, 4195840
    s_lshr_b32 s76, s5, 1
    s_mul_i32 s76, s76, 11264
    v_mfma_f32_16x16x32_bf16 v[108:111], a[4:7], v[72:75], 0
    s_waitcnt lgkmcnt(6)
    ds_read_b64_tr_b16 v[64:65], v8 offset:2048
    ds_read_b64_tr_b16 v[66:67], v8 offset:2560
    v_mfma_f32_16x16x32_bf16 v[108:111], a[12:15], v[76:79], v[108:111]
    s_nop 0
    ds_read_b128 a[16:19], v28 offset:16384
    ds_read_b128 a[24:27], v29 offset:16384
    buffer_load_dwordx4 v26, s[8:11], s93 offen offset:2048 lds
    s_add_u32 s66, s49, s76
    s_mul_i32 s76, s5, 2560
    s_add_u32 s49, s66, s76
    s_lshr_b32 s76, s6, 3
    s_lshl_b32 s76, s76, 13
    s_and_b32 s68, s6, 7
    v_mfma_f32_16x16x32_bf16 v[104:107], a[8:11], v[76:79], 0
    s_waitcnt lgkmcnt(8)
    ds_read_b64_tr_b16 v[68:69], v8 offset:10240
    ds_read_b64_tr_b16 v[70:71], v8 offset:10752
    v_mfma_f32_16x16x32_bf16 v[104:107], a[0:3], v[72:75], v[104:107]
    buffer_load_dwordx4 v27, s[8:11], s93 offen offset:3072 lds
    s_lshl_b32 s68, s68, 22
    s_add_u32 s68, s68, s76
    s_add_u32 s68, s68, 2097152
    s_lshl_b32 s76, s5, 11
    s_add_u32 s68, s68, s76
    v_mfma_f32_16x16x32_bf16 v[244:247], v[136:139], a[0:3], 0
    v_mfma_f32_16x16x32_bf16 v[248:251], v[136:139], a[4:7], 0
    ds_read_b128 v[136:139], v33 offset:0
    v_mfma_f32_16x16x32_bf16 v[112:115], a[0:3], v[80:83], 0
    s_add_u32 m0, s44, 18432
    ds_read_b64_tr_b16 v[72:73], v9 offset:2048
    ds_read_b64_tr_b16 v[74:75], v9 offset:2560
    v_mfma_f32_16x16x32_bf16 v[112:115], a[8:11], v[84:87], v[112:115]
    s_nop 0
    ds_read_b128 a[20:23], v28 offset:17408
    ds_read_b128 a[28:31], v29 offset:17408
    buffer_load_dwordx4 v20, s[12:15], s65 offen offset:0 lds
    s_cmp_ge_u32 s7, 10
    s_cselect_b64 vcc, -1, 0
    s_cselect_b32 s53, 1, 0
    s_cselect_b32 s79, 0, 640
    s_add_u32 s50, s49, s79
    v_cndmask_b32 v238, v2, v6, vcc
    v_cndmask_b32 v6, v6, v2, vcc
    s_lshl_b32 s76, s7, 4
    v_mfma_f32_16x16x32_bf16 v[116:119], a[12:15], v[84:87], 0
    s_waitcnt lgkmcnt(11)
    ds_read_b64_tr_b16 v[76:77], v9 offset:10240
    ds_read_b64_tr_b16 v[78:79], v9 offset:10752
    v_mfma_f32_16x16x32_bf16 v[116:119], a[4:7], v[80:83], v[116:119]
    buffer_load_dwordx4 v21, s[12:15], s65 offen offset:1024 lds
    v_add_u32 v238, s76, v238
    v_mul_u32_u24 v6, 640, v6
    v_add_u32 v239, v6, v5
    s_mov_b32 s64, 32128
    s_lshl_b32 s76, s81, 8
    s_add_u32 s94, s68, s76
    v_mfma_f32_16x16x32_bf16 v[124:127], a[4:7], v[88:91], 0
    s_add_u32 m0, s44, 114688
    ds_read_b64_tr_b16 v[80:81], v10 offset:2048
    ds_read_b64_tr_b16 v[82:83], v10 offset:2560
    v_mfma_f32_16x16x32_bf16 v[124:127], a[12:15], v[92:95], v[124:127]
    buffer_load_dwordx4 v24, s[8:11], s100 offen offset:0 lds
    s_add_u32 s95, s94, 16384
    s_and_b32 s76, s52, 0x80000000
    s_add_u32 s76, s76, 32768
    s_add_u32 s96, s94, s76
    s_add_u32 s97, s95, s76
    v_mfma_f32_16x16x32_bf16 v[120:123], a[8:11], v[92:95], 0
    s_waitcnt lgkmcnt(4)
    ds_read_b64_tr_b16 v[84:85], v10 offset:10240
    ds_read_b64_tr_b16 v[86:87], v10 offset:10752
    v_mfma_f32_16x16x32_bf16 v[120:123], a[0:3], v[88:91], v[120:123]
    buffer_load_dwordx4 v25, s[8:11], s100 offen offset:1024 lds
    s_lshl_b32 s76, s75, 7
    s_add_u32 s76, s76, 1703936
    s_cmp_lg_u32 s7, 10
    s_cmov_b32 s76, 0x80000000
    v_lshl_add_u32 v4, v3, 4, v4
    v_lshl_add_u32 v4, v2, 3, v4
    v_mfma_f32_16x16x32_bf16 v[244:247], v[140:143], a[8:11], v[244:247]
    v_mfma_f32_16x16x32_bf16 v[248:251], v[140:143], a[12:15], v[248:251]
    ds_read_b128 v[140:143], v33 offset:64
    v_add_u32 v33, s93, v34
    v_mfma_f32_16x16x32_bf16 v[96:99], a[16:19], v[64:67], v[96:99]
    ds_read_b64_tr_b16 v[88:89], v11 offset:2048
    ds_read_b64_tr_b16 v[90:91], v11 offset:2560
    v_mfma_f32_16x16x32_bf16 v[96:99], a[24:27], v[68:71], v[96:99]
    buffer_load_dwordx4 v26, s[8:11], s100 offen offset:2048 lds
    v_lshl_add_u32 v4, v4, 2, s76
    v_lshrrev_b32 v5, 5, v1
    v_lshlrev_b32 v5, 31, v5
    v_or_b32 v32, v4, v5
    s_cmp_ge_u32 s4, 30
    s_cselect_b32 s73, 0x80000000, 0
    s_lshl_b32 s76, s7, 15
    v_mfma_f32_16x16x32_bf16 v[100:103], a[28:31], v[68:71], v[100:103]
    s_waitcnt lgkmcnt(7)
    ds_read_b64_tr_b16 v[92:93], v11 offset:10240
    ds_read_b64_tr_b16 v[94:95], v11 offset:10752
    v_mfma_f32_16x16x32_bf16 v[100:103], a[20:23], v[64:67], v[100:103]
    s_waitcnt vmcnt(5)
    s_barrier
    buffer_load_dwordx4 v27, s[8:11], s100 offen offset:3072 lds
    s_add_u32 s66, s66, s76
    s_add_u32 s68, s68, 884736
    s_cmp_ge_u32 s5, 2
    s_mov_b32 s78, 0x80000
    s_cmov_b32 s78, 0x100000
    s_mov_b32 s80, 0x1400
    s_cmov_b32 s80, 0x1410
    s_mov_b32 s81, 0x0
    s_cmov_b32 s81, 0x8000
    s_and_b32 s82, s5, 1
    s_add_u32 s78, s78, s76
    v_mfma_f32_16x16x32_bf16 v[108:111], a[20:23], v[72:75], v[108:111]
    s_add_u32 m0, s44, 32768
    ds_read_b64_tr_b16 v[64:65], v8 offset:16384
    ds_read_b64_tr_b16 v[66:67], v8 offset:16896
    v_mfma_f32_16x16x32_bf16 v[108:111], a[28:31], v[76:79], v[108:111]
    s_nop 0
    ds_read_b128 a[32:35], v28 offset:32768
    ds_read_b128 a[40:43], v29 offset:32768
    buffer_load_dwordx4 v20, s[12:15], s84 offen offset:0 lds
    s_lshl_b32 s76, s82, 14
    s_add_u32 s78, s78, s76
    s_mul_i32 s83, s6, 86
    s_lshr_b32 s83, s83, 8
    s_mul_i32 s83, s83, 3
    v_mfma_f32_16x16x32_bf16 v[104:107], a[24:27], v[76:79], v[104:107]
    s_waitcnt lgkmcnt(9)
    ds_read_b64_tr_b16 v[68:69], v8 offset:24576
    ds_read_b64_tr_b16 v[70:71], v8 offset:25088
    v_mfma_f32_16x16x32_bf16 v[104:107], a[16:19], v[72:75], v[104:107]
    buffer_load_dwordx4 v21, s[12:15], s84 offen offset:1024 lds
    s_sub_u32 s83, s6, s83
    s_sub_u32 s79, s6, s83
    s_lshr_b32 s76, s79, 3
    s_xor_b32 s76, s76, 1
    s_lshl_b32 s76, s76, 13
    s_and_b32 s79, s79, 7
    v_mfma_f32_16x16x32_bf16 v[244:247], v[136:139], a[16:19], v[244:247]
    v_mfma_f32_16x16x32_bf16 v[248:251], v[136:139], a[20:23], v[248:251]
    ds_read_b128 v[136:139], v33 offset:0
    v_mfma_f32_16x16x32_bf16 v[112:115], a[16:19], v[80:83], v[112:115]
    s_add_u32 m0, s44, 65536
    ds_read_b64_tr_b16 v[72:73], v9 offset:16384
    ds_read_b64_tr_b16 v[74:75], v9 offset:16896
    v_mfma_f32_16x16x32_bf16 v[112:115], a[24:27], v[84:87], v[112:115]
    s_nop 0
    ds_read_b128 a[36:39], v28 offset:33792
    s_waitcnt lgkmcnt(8)
    ds_read_b128 a[44:47], v29 offset:33792
    buffer_load_dwordx4 v24, s[8:11], s101 offen offset:0 lds
    s_lshl_b32 s79, s79, 22
    s_add_u32 s79, s79, s76
    s_add_u32 s79, s79, 4195840
    s_add_u32 s58, s79, s78
    s_cmp_lt_u32 s6, s83
    s_cmov_b32 s58, 0x80000000
    v_mfma_f32_16x16x32_bf16 v[116:119], a[28:31], v[84:87], v[116:119]
    ds_read_b64_tr_b16 v[76:77], v9 offset:24576
    ds_read_b64_tr_b16 v[78:79], v9 offset:25088
    v_mfma_f32_16x16x32_bf16 v[116:119], a[20:23], v[80:83], v[116:119]
    buffer_load_dwordx4 v25, s[8:11], s101 offen offset:1024 lds
    s_lshl_b32 s79, s83, 1
    s_sub_u32 s79, s82, s79
    s_add_u32 s79, s79, 4
    s_mul_i32 s79, s79, s80
    s_add_u32 s61, s79, s81
    v_mfma_f32_16x16x32_bf16 v[124:127], a[20:23], v[88:91], v[124:127]
    s_waitcnt lgkmcnt(10)
    ds_read_b64_tr_b16 v[80:81], v10 offset:16384
    ds_read_b64_tr_b16 v[82:83], v10 offset:16896
    v_mfma_f32_16x16x32_bf16 v[124:127], a[28:31], v[92:95], v[124:127]
    buffer_load_dwordx4 v26, s[8:11], s101 offen offset:2048 lds
    s_sub_u32 s83, s83, 1
    s_cmov_b32 s83, 2
    s_sub_u32 s79, s6, s83
    s_lshr_b32 s76, s79, 3
    s_xor_b32 s76, s76, 1
    s_lshl_b32 s76, s76, 13
    s_and_b32 s79, s79, 7
    v_mfma_f32_16x16x32_bf16 v[120:123], a[24:27], v[92:95], v[120:123]
    s_waitcnt lgkmcnt(4)
    ds_read_b64_tr_b16 v[84:85], v10 offset:24576
    ds_read_b64_tr_b16 v[86:87], v10 offset:25088
    v_mfma_f32_16x16x32_bf16 v[120:123], a[16:19], v[88:91], v[120:123]
    buffer_load_dwordx4 v27, s[8:11], s101 offen offset:3072 lds
    s_lshl_b32 s79, s79, 22
    s_add_u32 s79, s79, s76
    s_add_u32 s79, s79, 4195840
    s_add_u32 s59, s79, s78
    s_cmp_lt_u32 s6, s83
    s_cmov_b32 s59, 0x80000000
    v_mfma_f32_16x16x32_bf16 v[244:247], v[140:143], a[24:27], v[244:247]
    v_mfma_f32_16x16x32_bf16 v[248:251], v[140:143], a[28:31], v[248:251]
    ds_read_b128 v[140:143], v33 offset:64
    v_add_u32 v33, s100, v34
    v_mfma_f32_16x16x32_bf16 v[96:99], a[32:35], v[64:67], v[96:99]
    s_add_u32 m0, s44, 34816
    ds_read_b64_tr_b16 v[88:89], v11 offset:16384
    ds_read_b64_tr_b16 v[90:91], v11 offset:16896
    v_mfma_f32_16x16x32_bf16 v[96:99], a[40:43], v[68:71], v[96:99]
    buffer_load_dwordx4 v20, s[12:15], s85 offen offset:0 lds
    s_lshl_b32 s79, s83, 1
    s_sub_u32 s79, s82, s79
    s_add_u32 s79, s79, 4
    s_mul_i32 s79, s79, s80
    s_add_u32 s62, s79, s81
    v_mfma_f32_16x16x32_bf16 v[100:103], a[44:47], v[68:71], v[100:103]
    s_waitcnt lgkmcnt(7)
    ds_read_b64_tr_b16 v[92:93], v11 offset:24576
    ds_read_b64_tr_b16 v[94:95], v11 offset:25088
    v_mfma_f32_16x16x32_bf16 v[100:103], a[36:39], v[64:67], v[100:103]
    s_waitcnt vmcnt(7)
    s_barrier
    buffer_load_dwordx4 v21, s[12:15], s85 offen offset:1024 lds
    s_sub_u32 s83, s83, 1
    s_cmov_b32 s83, 2
    s_sub_u32 s79, s6, s83
    s_lshr_b32 s76, s79, 3
    s_xor_b32 s76, s76, 1
    s_lshl_b32 s76, s76, 13
    s_and_b32 s79, s79, 7
    v_mfma_f32_16x16x32_bf16 v[108:111], a[36:39], v[72:75], v[108:111]
    s_add_u32 m0, s44, 81920
    ds_read_b64_tr_b16 v[64:65], v8 offset:18432
    ds_read_b64_tr_b16 v[66:67], v8 offset:18944
    v_mfma_f32_16x16x32_bf16 v[108:111], a[44:47], v[76:79], v[108:111]
    s_nop 0
    ds_read_b128 a[48:51], v28 offset:49152
    ds_read_b128 a[56:59], v29 offset:49152
    buffer_load_dwordx4 v24, s[8:11], s41 offen offset:0 lds
    s_lshl_b32 s79, s79, 22
    s_add_u32 s79, s79, s76
    s_add_u32 s79, s79, 4195840
    s_add_u32 s60, s79, s78
    s_cmp_lt_u32 s6, s83
    s_cmov_b32 s60, 0x80000000
    v_mfma_f32_16x16x32_bf16 v[104:107], a[40:43], v[76:79], v[104:107]
    s_waitcnt lgkmcnt(9)
    ds_read_b64_tr_b16 v[68:69], v8 offset:26624
    ds_read_b64_tr_b16 v[70:71], v8 offset:27136
    v_mfma_f32_16x16x32_bf16 v[104:107], a[32:35], v[72:75], v[104:107]
    buffer_load_dwordx4 v25, s[8:11], s41 offen offset:1024 lds
    s_lshl_b32 s79, s83, 1
    s_sub_u32 s79, s82, s79
    s_add_u32 s79, s79, 4
    s_mul_i32 s79, s79, s80
    s_add_u32 s63, s79, s81
    v_mfma_f32_16x16x32_bf16 v[244:247], v[136:139], a[32:35], v[244:247]
    v_mfma_f32_16x16x32_bf16 v[248:251], v[136:139], a[36:39], v[248:251]
    ds_read_b128 v[136:139], v33 offset:0
    v_mfma_f32_16x16x32_bf16 v[112:115], a[32:35], v[80:83], v[112:115]
    s_waitcnt lgkmcnt(9)
    ds_read_b64_tr_b16 v[72:73], v9 offset:18432
    ds_read_b64_tr_b16 v[74:75], v9 offset:18944
    v_mfma_f32_16x16x32_bf16 v[112:115], a[40:43], v[84:87], v[112:115]
    s_nop 0
    ds_read_b128 a[52:55], v28 offset:50176
    ds_read_b128 a[60:63], v29 offset:50176
    buffer_load_dwordx4 v26, s[8:11], s41 offen offset:2048 lds
    s_lshl_b32 s67, s75, 7
    s_add_u32 s67, s67, 1703936
    s_lshr_b32 s78, s3, 1
    s_mul_i32 s78, s78, 30
    s_add_u32 s78, s78, s4
    s_mul_i32 s56, s78, 205
    v_mfma_f32_16x16x32_bf16 v[116:119], a[44:47], v[84:87], v[116:119]
    s_waitcnt lgkmcnt(11)
    ds_read_b64_tr_b16 v[76:77], v9 offset:26624
    ds_read_b64_tr_b16 v[78:79], v9 offset:27136
    v_mfma_f32_16x16x32_bf16 v[116:119], a[36:39], v[80:83], v[116:119]
    buffer_load_dwordx4 v27, s[8:11], s41 offen offset:3072 lds
    s_lshr_b32 s56, s56, 10
    s_mul_i32 s77, s56, 5
    s_sub_u32 s77, s78, s77
    s_and_b32 s78, s3, 1
    s_mul_i32 s78, s78, 5
    v_mfma_f32_16x16x32_bf16 v[124:127], a[36:39], v[88:91], v[124:127]
    s_add_u32 m0, s44, 49152
    ds_read_b64_tr_b16 v[80:81], v10 offset:18432
    ds_read_b64_tr_b16 v[82:83], v10 offset:18944
    v_mfma_f32_16x16x32_bf16 v[124:127], a[44:47], v[92:95], v[124:127]
    buffer_load_dwordx4 v20, s[12:15], s86 offen offset:0 lds
    s_add_u32 s57, s78, s77
    s_mul_i32 s76, s5, 14
    s_min_u32 s76, s76, 41
    s_mul_i32 s69, s76, 40960
    s_mul_i32 s70, s5, 204800
    v_mfma_f32_16x16x32_bf16 v[120:123], a[40:43], v[92:95], v[120:123]
    s_waitcnt lgkmcnt(4)
    ds_read_b64_tr_b16 v[84:85], v10 offset:26624
    ds_read_b64_tr_b16 v[86:87], v10 offset:27136
    v_mfma_f32_16x16x32_bf16 v[120:123], a[32:35], v[88:91], v[120:123]
    buffer_load_dwordx4 v21, s[12:15], s86 offen offset:1024 lds
    s_lshl_b32 s71, s76, 14
    s_add_u32 s72, s71, 16384
    s_lshr_b32 s74, s5, 1
    s_lshl_b32 s74, s74, 30
    v_lshrrev_b32 v2, 3, v1
    v_bfe_u32 v3, v1, 4, 1
    v_mfma_f32_16x16x32_bf16 v[244:247], v[140:143], a[40:43], v[244:247]
    v_mfma_f32_16x16x32_bf16 v[248:251], v[140:143], a[44:47], v[248:251]
    ds_read_b128 v[140:143], v33 offset:64
    v_add_u32 v33, s101, v34
    v_mfma_f32_16x16x32_bf16 v[96:99], a[48:51], v[64:67], v[96:99]
    s_add_u32 m0, s44, 98304
    ds_read_b64_tr_b16 v[88:89], v11 offset:18432
    ds_read_b64_tr_b16 v[90:91], v11 offset:18944
    v_mfma_f32_16x16x32_bf16 v[96:99], a[56:59], v[68:71], v[96:99]
    buffer_load_dwordx4 v24, s[8:11], s42 offen offset:0 lds
    v_lshlrev_b32 v3, 2, v3
    v_and_b32 v4, 7, v1
    v_xor_b32 v3, v3, v4
    v_mul_u32_u24 v5, 1280, v2
    v_lshl_add_u32 v5, v3, 4, v5
    v_mfma_f32_16x16x32_bf16 v[100:103], a[60:63], v[68:71], v[100:103]
    s_waitcnt lgkmcnt(7)
    ds_read_b64_tr_b16 v[92:93], v11 offset:26624
    ds_read_b64_tr_b16 v[94:95], v11 offset:27136
    v_mfma_f32_16x16x32_bf16 v[100:103], a[52:55], v[64:67], v[100:103]
L_pad7:
    s_cmp_eq_u32 s92, 1
    s_cbranch_scc1 L_main
    s_waitcnt vmcnt(9)
    s_barrier
    buffer_load_dwordx4 v25, s[8:11], s42 offen offset:1024 lds
    s_lshl_b32 s76, s57, 7
    s_or_b32 s76, s76, s73
    v_add_u32 v35, s76, v5
    v_add_u32 v37, 18432, v35
    v_xor_b32 v2, 4, v2
    v_mfma_f32_16x16x32_bf16 v[108:111], a[52:55], v[72:75], v[108:111]
    s_waitcnt lgkmcnt(7)
    ds_read_b64_tr_b16 v[64:65], v8 offset:32768
    ds_read_b64_tr_b16 v[66:67], v8 offset:33280
    v_mfma_f32_16x16x32_bf16 v[108:111], a[60:63], v[76:79], v[108:111]
    s_nop 0
    ds_read_b128 a[64:67], v28 offset:0
    ds_read_b128 a[72:75], v29 offset:0
    buffer_load_dwordx4 v26, s[8:11], s42 offen offset:2048 lds
    v_xor_b32 v3, 2, v3
    v_mul_u32_u24 v5, 1280, v2
    v_lshl_add_u32 v5, v3, 4, v5
    v_add_u32 v5, s76, v5
    v_xor_b32 v6, 32, v35
    v_add_u32 v36, 9216, v5
    v_mfma_f32_16x16x32_bf16 v[104:107], a[56:59], v[76:79], v[104:107]
    s_waitcnt lgkmcnt(9)
    ds_read_b64_tr_b16 v[68:69], v8 offset:40960
    ds_read_b64_tr_b16 v[70:71], v8 offset:41472
    v_mfma_f32_16x16x32_bf16 v[104:107], a[48:51], v[72:75], v[104:107]
    buffer_load_dwordx4 v27, s[8:11], s42 offen offset:3072 lds
    v_add_u32 v39, 9216, v6
    v_add_u32 v38, 27648, v5
    v_add_u32 v40, 27648, v6
    v_lshrrev_b32 v2, 4, v1
    v_bfe_u32 v3, v1, 2, 2
    v_mfma_f32_16x16x32_bf16 v[244:247], v[136:139], a[48:51], v[244:247]
    v_mfma_f32_16x16x32_bf16 v[248:251], v[136:139], a[52:55], v[248:251]
    ds_read_b128 v[136:139], v33 offset:0
    v_mfma_f32_16x16x32_bf16 v[112:115], a[48:51], v[80:83], v[112:115]
    s_add_u32 m0, s44, 51200
    ds_read_b64_tr_b16 v[72:73], v9 offset:32768
    ds_read_b64_tr_b16 v[74:75], v9 offset:33280
    v_mfma_f32_16x16x32_bf16 v[112:115], a[56:59], v[84:87], v[112:115]
    s_nop 0
    ds_read_b128 a[68:71], v28 offset:1024
    s_waitcnt lgkmcnt(8)
    ds_read_b128 a[76:79], v29 offset:1024
    buffer_load_dwordx4 v20, s[12:15], s0 offen offset:0 lds
    v_lshl_add_u32 v5, v2, 3, v3
    v_lshlrev_b32 v5, 7, v5
    v_bfe_u32 v6, v1, 3, 1
    v_lshl_add_u32 v5, v6, 6, v5
    v_and_b32 v6, 3, v1
    v_mfma_f32_16x16x32_bf16 v[116:119], a[60:63], v[84:87], v[116:119]
    ds_read_b64_tr_b16 v[76:77], v9 offset:40960
    ds_read_b64_tr_b16 v[78:79], v9 offset:41472
    v_mfma_f32_16x16x32_bf16 v[116:119], a[52:55], v[80:83], v[116:119]
    buffer_load_dwordx4 v21, s[12:15], s0 offen offset:1024 lds
    v_lshl_add_u32 v5, v6, 3, v5
    v_bfe_u32 v6, v1, 4, 1
    v_lshl_add_u32 v5, v6, 5, v5
    s_add_u32 s76, s44, 0x10000
    v_add_u32 v41, s76, v5
    v_xor_b32 v42, 32, v41
    v_mfma_f32_16x16x32_bf16 v[124:127], a[52:55], v[88:91], v[124:127]
    s_add_u32 m0, s44, 114688
    ds_read_b64_tr_b16 v[80:81], v10 offset:32768
    ds_read_b64_tr_b16 v[82:83], v10 offset:33280
    v_mfma_f32_16x16x32_bf16 v[124:127], a[60:63], v[92:95], v[124:127]
    buffer_load_dwordx4 v24, s[8:11], s43 offen offset:0 lds
    v_xor_b32 v43, 64, v41
    v_xor_b32 v44, 96, v41
    v_add_u32 v45, 0x10000, v41
    v_add_u32 v46, 0x10000, v42
    v_add_u32 v241, 0x10000, v43
    v_mfma_f32_16x16x32_bf16 v[120:123], a[56:59], v[92:95], v[120:123]
    s_waitcnt lgkmcnt(4)
    ds_read_b64_tr_b16 v[84:85], v10 offset:40960
    ds_read_b64_tr_b16 v[86:87], v10 offset:41472
    v_mfma_f32_16x16x32_bf16 v[120:123], a[48:51], v[88:91], v[120:123]
    buffer_load_dwordx4 v25, s[8:11], s43 offen offset:1024 lds
    v_add_u32 v242, 0x10000, v44
    v_lshlrev_b32 v4, 4, v4
    v_lshl_add_u32 v6, v2, 7, v4
    v_bfe_u32 v5, v1, 3, 1
    s_mul_i32 s77, s56, 11
    v_mfma_f32_16x16x32_bf16 v[244:247], v[140:143], a[56:59], v[244:247]
    v_mfma_f32_16x16x32_bf16 v[248:251], v[140:143], a[60:63], v[248:251]
    ds_read_b128 v[140:143], v33 offset:64
    v_add_u32 v33, s41, v34
    v_mfma_f32_16x16x32_bf16 v[96:99], a[64:67], v[64:67], v[96:99]
    ds_read_b64_tr_b16 v[88:89], v11 offset:32768
    ds_read_b64_tr_b16 v[90:91], v11 offset:33280
    v_mfma_f32_16x16x32_bf16 v[96:99], a[72:75], v[68:71], v[96:99]
    buffer_load_dwordx4 v26, s[8:11], s43 offen offset:2048 lds
    s_lshr_b32 s80, s77, 4
    s_lshr_b32 s76, s80, 3
    s_lshl_b32 s76, s76, 13
    s_and_b32 s78, s80, 7
    s_lshl_b32 s78, s78, 22
    s_add_u32 s78, s78, s76
    v_mfma_f32_16x16x32_bf16 v[100:103], a[76:79], v[68:71], v[100:103]
    s_waitcnt lgkmcnt(7)
    ds_read_b64_tr_b16 v[92:93], v11 offset:40960
    ds_read_b64_tr_b16 v[94:95], v11 offset:41472
    v_mfma_f32_16x16x32_bf16 v[100:103], a[68:71], v[64:67], v[100:103]
    s_waitcnt vmcnt(11)
    s_barrier
    buffer_load_dwordx4 v27, s[8:11], s43 offen offset:3072 lds
    s_add_u32 s78, s78, 2097152
    s_or_b32 s78, s78, s73
    s_add_u32 s80, s80, 1
    s_lshr_b32 s76, s80, 3
    s_lshl_b32 s76, s76, 13
    v_mfma_f32_16x16x32_bf16 v[108:111], a[68:71], v[72:75], v[108:111]
    s_add_u32 m0, s44, 0
    ds_read_b64_tr_b16 v[64:65], v8 offset:34816
    ds_read_b64_tr_b16 v[66:67], v8 offset:35328
    v_mfma_f32_16x16x32_bf16 v[108:111], a[76:79], v[76:79], v[108:111]
    s_nop 0
    ds_read_b128 a[80:83], v28 offset:16384
    ds_read_b128 a[88:91], v29 offset:16384
    s_and_b32 s79, s80, 7
    s_lshl_b32 s79, s79, 22
    s_add_u32 s79, s79, s76
    s_add_u32 s79, s79, 2097152
    s_sub_u32 s79, s79, 8192
    v_mfma_f32_16x16x32_bf16 v[104:107], a[72:75], v[76:79], v[104:107]
    s_waitcnt lgkmcnt(9)
    ds_read_b64_tr_b16 v[68:69], v8 offset:43008
    ds_read_b64_tr_b16 v[70:71], v8 offset:43520
    v_mfma_f32_16x16x32_bf16 v[104:107], a[64:67], v[72:75], v[104:107]
    buffer_load_dwordx4 v20, s[12:15], s1 offen offset:0 lds
    s_or_b32 s79, s79, s73
    s_cmp_ge_u32 s80, 16
    s_cmov_b32 s79, 0x80000000
    s_and_b32 s76, s77, 15
    v_add_u32 v3, s76, v5
    v_lshl_add_u32 v6, v3, 9, v6
    v_add_u32 v7, s79, v6
    v_mfma_f32_16x16x32_bf16 v[244:247], v[136:139], a[64:67], v[244:247]
    v_mfma_f32_16x16x32_bf16 v[248:251], v[136:139], a[68:71], v[248:251]
    ds_read_b128 v[136:139], v33 offset:0
    v_mfma_f32_16x16x32_bf16 v[112:115], a[64:67], v[80:83], v[112:115]
    s_waitcnt lgkmcnt(9)
    ds_read_b64_tr_b16 v[72:73], v9 offset:34816
    ds_read_b64_tr_b16 v[74:75], v9 offset:35328
    v_mfma_f32_16x16x32_bf16 v[112:115], a[72:75], v[84:87], v[112:115]
    s_nop 0
    ds_read_b128 a[84:87], v28 offset:17408
    ds_read_b128 a[92:95], v29 offset:17408
    v_add_u32 v6, s78, v6
    v_cmp_le_u32 vcc, 16, v3
    s_nop 1
    v_cndmask_b32 v48, v6, v7, vcc
    v_cmp_le_u32 vcc, 14, v3
    s_nop 1
    v_cndmask_b32 v49, v6, v7, vcc
    v_mfma_f32_16x16x32_bf16 v[116:119], a[76:79], v[84:87], v[116:119]
    s_waitcnt lgkmcnt(11)
    ds_read_b64_tr_b16 v[76:77], v9 offset:43008
    ds_read_b64_tr_b16 v[78:79], v9 offset:43520
    v_mfma_f32_16x16x32_bf16 v[116:119], a[68:71], v[80:83], v[116:119]
    buffer_load_dwordx4 v21, s[12:15], s1 offen offset:1024 lds
    v_cmp_le_u32 vcc, 12, v3
    s_nop 1
    v_cndmask_b32 v50, v6, v7, vcc
    v_cmp_le_u32 vcc, 10, v3
    s_nop 1
    v_cndmask_b32 v52, v6, v7, vcc
    v_cmp_le_u32 vcc, 8, v3
    v_mfma_f32_16x16x32_bf16 v[124:127], a[68:71], v[88:91], v[124:127]
    s_add_u32 m0, s44, 65536
    ds_read_b64_tr_b16 v[80:81], v10 offset:34816
    ds_read_b64_tr_b16 v[82:83], v10 offset:35328
    v_mfma_f32_16x16x32_bf16 v[124:127], a[76:79], v[92:95], v[124:127]
    buffer_load_dwordx4 v24, s[8:11], s54 offen offset:0 lds
    v_add_u32 v6, 4096, v6
    v_add_u32 v7, 4096, v7
    v_cndmask_b32 v222, v6, v7, vcc
    v_cmp_le_u32 vcc, 6, v3
    s_nop 1
    v_cndmask_b32 v223, v6, v7, vcc
    v_lshlrev_b32 v5, 31, v5
    v_mfma_f32_16x16x32_bf16 v[120:123], a[72:75], v[92:95], v[120:123]
    s_waitcnt lgkmcnt(4)
    ds_read_b64_tr_b16 v[84:85], v10 offset:43008
    ds_read_b64_tr_b16 v[86:87], v10 offset:43520
    v_mfma_f32_16x16x32_bf16 v[120:123], a[64:67], v[88:91], v[120:123]
    buffer_load_dwordx4 v25, s[8:11], s54 offen offset:1024 lds
    v_or_b32 v223, v5, v223
    v_lshrrev_b32 v2, 5, v1
    v_bfe_u32 v5, v1, 3, 2
    v_lshl_add_u32 v6, v5, 9, v4
    s_mul_i32 s76, s7, 5
    v_mfma_f32_16x16x32_bf16 v[244:247], v[140:143], a[72:75], v[244:247]
    v_mfma_f32_16x16x32_bf16 v[248:251], v[140:143], a[76:79], v[248:251]
    ds_read_b128 v[140:143], v33 offset:64
    v_add_u32 v33, s42, v34
    v_mfma_f32_16x16x32_bf16 v[96:99], a[80:83], v[64:67], v[96:99]
    ds_read_b64_tr_b16 v[88:89], v11 offset:34816
    ds_read_b64_tr_b16 v[90:91], v11 offset:35328
    v_mfma_f32_16x16x32_bf16 v[96:99], a[88:91], v[68:71], v[96:99]
    buffer_load_dwordx4 v26, s[8:11], s54 offen offset:2048 lds
    v_add3_u32 v3, v2, s76, 0
    v_and_b32 v7, 3, v3
    v_lshl_add_u32 v7, v7, 7, v6
    v_lshrrev_b32 v3, 2, v3
    v_lshl_add_u32 v57, v3, 14, v7
    v_mfma_f32_16x16x32_bf16 v[100:103], a[92:95], v[68:71], v[100:103]
    s_waitcnt lgkmcnt(7)
    ds_read_b64_tr_b16 v[92:93], v11 offset:43008
    ds_read_b64_tr_b16 v[94:95], v11 offset:43520
    v_mfma_f32_16x16x32_bf16 v[100:103], a[84:87], v[64:67], v[100:103]
    s_waitcnt vmcnt(11)
    s_barrier
    buffer_load_dwordx4 v27, s[8:11], s54 offen offset:3072 lds
    v_add3_u32 v3, v2, s76, 3
    v_and_b32 v7, 3, v3
    v_lshl_add_u32 v7, v7, 7, v6
    v_lshrrev_b32 v3, 2, v3
    v_lshl_add_u32 v59, v3, 14, v7
    v_add3_u32 v3, v2, s76, 2
    v_mfma_f32_16x16x32_bf16 v[108:111], a[84:87], v[72:75], v[108:111]
    s_add_u32 m0, s44, 2048
    ds_read_b64_tr_b16 v[64:65], v8 offset:49152
    ds_read_b64_tr_b16 v[66:67], v8 offset:49664
    v_mfma_f32_16x16x32_bf16 v[108:111], a[92:95], v[76:79], v[108:111]
    s_nop 0
    ds_read_b128 a[96:99], v28 offset:32768
    ds_read_b128 a[104:107], v29 offset:32768
    v_and_b32 v7, 3, v3
    v_lshl_add_u32 v7, v7, 7, v6
    v_lshrrev_b32 v3, 2, v3
    v_lshl_add_u32 v60, v3, 14, v7
    v_mov_b32 v7, 0x80000000
    v_mfma_f32_16x16x32_bf16 v[104:107], a[88:91], v[76:79], v[104:107]
    s_waitcnt lgkmcnt(9)
    ds_read_b64_tr_b16 v[68:69], v8 offset:57344
    ds_read_b64_tr_b16 v[70:71], v8 offset:57856
    v_mfma_f32_16x16x32_bf16 v[104:107], a[80:83], v[72:75], v[104:107]
    buffer_load_dwordx4 v20, s[12:15], s40 offen offset:0 lds
    v_mul_u32_u24 v6, 640, v5
    s_mul_i32 s78, s5, 2560
    v_add3_u32 v6, v6, v4, s78
    v_lshl_add_u32 v220, v2, 7, v6
    v_lshl_add_u32 v221, v2, 3, v6
    v_mfma_f32_16x16x32_bf16 v[244:247], v[136:139], a[80:83], v[244:247]
    v_mfma_f32_16x16x32_bf16 v[248:251], v[136:139], a[84:87], v[248:251]
    ds_read_b128 v[136:139], v33 offset:0
    v_mfma_f32_16x16x32_bf16 v[112:115], a[80:83], v[80:83], v[112:115]
    s_waitcnt lgkmcnt(9)
    ds_read_b64_tr_b16 v[72:73], v9 offset:49152
    ds_read_b64_tr_b16 v[74:75], v9 offset:49664
    v_mfma_f32_16x16x32_bf16 v[112:115], a[88:91], v[84:87], v[112:115]
    s_nop 0
    ds_read_b128 a[100:103], v28 offset:33792
    ds_read_b128 a[108:111], v29 offset:33792
    v_cmp_eq_u32 vcc, 0, v0
    s_lshr_b32 s76, s6, 3
    s_and_b32 s78, s6, 7
    s_lshl_b32 s78, s78, 1
    s_sub_u32 s78, s78, s76
    s_lshl_b32 s78, s78, 13
    v_mfma_f32_16x16x32_bf16 v[116:119], a[92:95], v[84:87], v[116:119]
    s_waitcnt lgkmcnt(11)
    ds_read_b64_tr_b16 v[76:77], v9 offset:57344
    ds_read_b64_tr_b16 v[78:79], v9 offset:57856
    v_mfma_f32_16x16x32_bf16 v[116:119], a[84:87], v[80:83], v[116:119]
    buffer_load_dwordx4 v21, s[12:15], s40 offen offset:1024 lds
    v_add_u32 v20, 128, v20
    v_add_u32 v21, 128, v21
    s_add_u32 s78, s78, 1581056
    s_mul_i32 s76, s7, 384
    s_add_u32 s76, s76, s78
    v_mov_b32 v4, s76
    v_cndmask_b32 v51, v7, v4, vcc
    v_mfma_f32_16x16x32_bf16 v[124:127], a[84:87], v[88:91], v[124:127]
    s_add_u32 m0, s44, 81920
    ds_read_b64_tr_b16 v[80:81], v10 offset:49152
    ds_read_b64_tr_b16 v[82:83], v10 offset:49664
    v_mfma_f32_16x16x32_bf16 v[124:127], a[92:95], v[92:95], v[124:127]
    buffer_load_dwordx4 v24, s[8:11], s55 offen offset:0 lds
    v_mov_b32 v53, 1
    s_min_u32 s78, s5, 2
    s_sub_u32 s78, s6, s78
    s_max_i32 s78, s78, 0
    s_lshr_b32 s76, s78, 3
    v_mfma_f32_16x16x32_bf16 v[120:123], a[88:91], v[92:95], v[120:123]
    s_waitcnt lgkmcnt(4)
    ds_read_b64_tr_b16 v[84:85], v10 offset:57344
    ds_read_b64_tr_b16 v[86:87], v10 offset:57856
    v_mfma_f32_16x16x32_bf16 v[120:123], a[80:83], v[88:91], v[120:123]
    buffer_load_dwordx4 v25, s[8:11], s55 offen offset:1024 lds
    s_and_b32 s78, s78, 7
    s_lshl_b32 s78, s78, 1
    s_sub_u32 s78, s78, s76
    s_lshl_b32 s78, s78, 13
    s_add_u32 s78, s78, 1581056
    s_cmp_eq_u32 s5, 3
    s_cselect_b32 s76, 0, 384
    v_mfma_f32_16x16x32_bf16 v[244:247], v[140:143], a[88:91], v[244:247]
    v_mfma_f32_16x16x32_bf16 v[248:251], v[140:143], a[92:95], v[248:251]
    ds_read_b128 v[140:143], v33 offset:64
    v_add_u32 v33, s43, v34
    v_mfma_f32_16x16x32_bf16 v[96:99], a[96:99], v[64:67], v[96:99]
    ds_read_b64_tr_b16 v[88:89], v11 offset:49152
    ds_read_b64_tr_b16 v[90:91], v11 offset:49664
    v_mfma_f32_16x16x32_bf16 v[96:99], a[104:107], v[68:71], v[96:99]
    buffer_load_dwordx4 v26, s[8:11], s55 offen offset:2048 lds
    v_lshrrev_b32 v4, 2, v1
    v_mul_u32_u24 v4, s76, v4
    v_add_u32 v54, s78, v4
    s_bitcmp1_b32 s7, 0
    s_cselect_b32 s98, 0, -1
    s_cselect_b32 s99, -1, 0
    s_lshr_b32 s76, s5, 1
    v_mfma_f32_16x16x32_bf16 v[100:103], a[108:111], v[68:71], v[100:103]
    s_waitcnt lgkmcnt(7)
    ds_read_b64_tr_b16 v[92:93], v11 offset:57344
    ds_read_b64_tr_b16 v[94:95], v11 offset:57856
    v_mfma_f32_16x16x32_bf16 v[100:103], a[100:103], v[64:67], v[100:103]
    s_waitcnt vmcnt(11)
    s_barrier
    buffer_load_dwordx4 v27, s[8:11], s55 offen offset:3072 lds
    s_mul_i32 s76, s76, 10
    s_add_u32 s76, s76, s77
    s_lshr_b32 s76, s76, 4
    s_min_u32 s76, s76, 15
    s_lshr_b32 s78, s76, 3
    v_mfma_f32_16x16x32_bf16 v[108:111], a[100:103], v[72:75], v[108:111]
    s_add_u32 m0, s44, 16384
    ds_read_b64_tr_b16 v[64:65], v8 offset:51200
    ds_read_b64_tr_b16 v[66:67], v8 offset:51712
    v_mfma_f32_16x16x32_bf16 v[108:111], a[108:111], v[76:79], v[108:111]
    s_nop 0
    ds_read_b128 a[112:115], v28 offset:49152
    ds_read_b128 a[120:123], v29 offset:49152
    buffer_load_dwordx4 v20, s[12:15], s45 offen offset:0 lds
    s_and_b32 s76, s76, 7
    s_lshl_b32 s76, s76, 1
    s_sub_u32 s76, s76, s78
    s_lshl_b32 s76, s76, 13
    s_add_u32 s76, s76, 1581056
    s_and_b32 s78, s5, 1
    v_mfma_f32_16x16x32_bf16 v[104:107], a[104:107], v[76:79], v[104:107]
    s_waitcnt lgkmcnt(9)
    ds_read_b64_tr_b16 v[68:69], v8 offset:59392
    ds_read_b64_tr_b16 v[70:71], v8 offset:59904
    v_mfma_f32_16x16x32_bf16 v[104:107], a[96:99], v[72:75], v[104:107]
    s_mul_i32 s78, s78, 3072
    s_add_u32 s76, s76, s78
    v_lshrrev_b32 v4, 3, v1
    v_mul_u32_u24 v4, 384, v4
    v_add_u32 v55, s76, v4
    v_mfma_f32_16x16x32_bf16 v[244:247], v[136:139], a[96:99], v[244:247]
    v_mfma_f32_16x16x32_bf16 v[248:251], v[136:139], a[100:103], v[248:251]
    ds_read_b128 v[136:139], v33 offset:0
    v_mfma_f32_16x16x32_bf16 v[112:115], a[96:99], v[80:83], v[112:115]
    s_waitcnt lgkmcnt(9)
    ds_read_b64_tr_b16 v[72:73], v9 offset:51200
    ds_read_b64_tr_b16 v[74:75], v9 offset:51712
    v_mfma_f32_16x16x32_bf16 v[112:115], a[104:107], v[84:87], v[112:115]
    s_nop 0
    ds_read_b128 a[116:119], v28 offset:50176
    ds_read_b128 a[124:127], v29 offset:50176
    buffer_load_dwordx4 v21, s[12:15], s45 offen offset:1024 lds
    v_and_b32 v63, 60, v1
    v_add_u32 v30, 0, v238
    v_mul_u32_u24 v255, 205, v30
    v_lshl_add_u32 v30, v30, 7, v239
    v_lshrrev_b32 v255, 10, v255
    v_mfma_f32_16x16x32_bf16 v[116:119], a[108:111], v[84:87], v[116:119]
    s_waitcnt lgkmcnt(11)
    ds_read_b64_tr_b16 v[76:77], v9 offset:59392
    ds_read_b64_tr_b16 v[78:79], v9 offset:59904
    v_mfma_f32_16x16x32_bf16 v[116:119], a[100:103], v[80:83], v[116:119]
    v_mad_u32_u24 v30, v255, s64, v30
    v_add3_u32 v240, v238, s53, 0
    v_mul_u32_u24 v255, 205, v240
    v_lshl_add_u32 v240, v240, 7, v239
    v_lshrrev_b32 v255, 10, v255
    v_mad_u32_u24 v240, v255, s64, v240
    v_mfma_f32_16x16x32_bf16 v[124:127], a[100:103], v[88:91], v[124:127]
    s_add_u32 m0, s44, 18432
    ds_read_b64_tr_b16 v[80:81], v10 offset:51200
    ds_read_b64_tr_b16 v[82:83], v10 offset:51712
    v_mfma_f32_16x16x32_bf16 v[124:127], a[108:111], v[92:95], v[124:127]
    buffer_load_dwordx4 v20, s[12:15], s47 offen offset:0 lds
    v_add_u32 v243, 4, v238
    v_mul_u32_u24 v255, 205, v243
    v_lshl_add_u32 v243, v243, 7, v239
    v_lshrrev_b32 v255, 10, v255
    v_mad_u32_u24 v243, v255, s64, v243
    v_mfma_f32_16x16x32_bf16 v[120:123], a[104:107], v[92:95], v[120:123]
    s_waitcnt lgkmcnt(4)
    ds_read_b64_tr_b16 v[84:85], v10 offset:59392
    ds_read_b64_tr_b16 v[86:87], v10 offset:59904
    v_mfma_f32_16x16x32_bf16 v[120:123], a[96:99], v[88:91], v[120:123]
    v_add3_u32 v254, v238, s53, 4
    v_mul_u32_u24 v255, 205, v254
    v_lshl_add_u32 v254, v254, 7, v239
    v_lshrrev_b32 v255, 10, v255
    v_mad_u32_u24 v254, v255, s64, v254
    v_mfma_f32_16x16x32_bf16 v[244:247], v[140:143], a[104:107], v[244:247]
    v_mfma_f32_16x16x32_bf16 v[248:251], v[140:143], a[108:111], v[248:251]
    ds_read_b128 v[140:143], v33 offset:64
    v_add_u32 v33, s54, v34
    v_mfma_f32_16x16x32_bf16 v[96:99], a[112:115], v[64:67], v[96:99]
    ds_read_b64_tr_b16 v[88:89], v11 offset:51200
    ds_read_b64_tr_b16 v[90:91], v11 offset:51712
    v_mfma_f32_16x16x32_bf16 v[96:99], a[120:123], v[68:71], v[96:99]
    buffer_load_dwordx4 v21, s[12:15], s47 offen offset:1024 lds
    v_mfma_f32_16x16x32_bf16 v[100:103], a[124:127], v[68:71], v[100:103]
    s_waitcnt lgkmcnt(7)
    ds_read_b64_tr_b16 v[92:93], v11 offset:59392
    ds_read_b64_tr_b16 v[94:95], v11 offset:59904
    v_mfma_f32_16x16x32_bf16 v[100:103], a[116:119], v[64:67], v[100:103]
    s_waitcnt vmcnt(10)
    s_barrier
    v_mfma_f32_16x16x32_bf16 v[108:111], a[116:119], v[72:75], v[108:111]
    s_add_u32 m0, s44, 32768
    ds_read_b64_tr_b16 v[64:65], v8 offset:0
    ds_read_b64_tr_b16 v[66:67], v8 offset:512
    v_mfma_f32_16x16x32_bf16 v[108:111], a[124:127], v[76:79], v[108:111]
    s_nop 0
    ds_read_b128 a[128:131], v28 offset:0
    ds_read_b128 a[136:139], v29 offset:0
    buffer_load_dwordx4 v20, s[12:15], s48 offen offset:0 lds
    v_mfma_f32_16x16x32_bf16 v[104:107], a[120:123], v[76:79], v[104:107]
    s_waitcnt lgkmcnt(9)
    ds_read_b64_tr_b16 v[68:69], v8 offset:8192
    ds_read_b64_tr_b16 v[70:71], v8 offset:8704
    v_mfma_f32_16x16x32_bf16 v[104:107], a[112:115], v[72:75], v[104:107]
    v_mfma_f32_16x16x32_bf16 v[244:247], v[136:139], a[112:115], v[244:247]
    v_mfma_f32_16x16x32_bf16 v[248:251], v[136:139], a[116:119], v[248:251]
    ds_read_b128 v[136:139], v33 offset:0
    v_mfma_f32_16x16x32_bf16 v[112:115], a[112:115], v[80:83], v[112:115]
    s_waitcnt lgkmcnt(9)
    ds_read_b64_tr_b16 v[72:73], v9 offset:0
    ds_read_b64_tr_b16 v[74:75], v9 offset:512
    v_mfma_f32_16x16x32_bf16 v[112:115], a[120:123], v[84:87], v[112:115]
    s_nop 0
    ds_read_b128 a[132:135], v28 offset:1024
    ds_read_b128 a[140:143], v29 offset:1024
    buffer_load_dwordx4 v21, s[12:15], s48 offen offset:1024 lds
    v_mfma_f32_16x16x32_bf16 v[116:119], a[124:127], v[84:87], v[116:119]
    s_waitcnt lgkmcnt(11)
    ds_read_b64_tr_b16 v[76:77], v9 offset:8192
    ds_read_b64_tr_b16 v[78:79], v9 offset:8704
    v_mfma_f32_16x16x32_bf16 v[116:119], a[116:119], v[80:83], v[116:119]
    v_mfma_f32_16x16x32_bf16 v[124:127], a[116:119], v[88:91], v[124:127]
    s_add_u32 m0, s44, 34816
    ds_read_b64_tr_b16 v[80:81], v10 offset:0
    ds_read_b64_tr_b16 v[82:83], v10 offset:512
    v_mfma_f32_16x16x32_bf16 v[124:127], a[124:127], v[92:95], v[124:127]
    buffer_load_dwordx4 v20, s[12:15], s65 offen offset:0 lds
    v_mfma_f32_16x16x32_bf16 v[120:123], a[120:123], v[92:95], v[120:123]
    s_waitcnt lgkmcnt(4)
    ds_read_b64_tr_b16 v[84:85], v10 offset:8192
    ds_read_b64_tr_b16 v[86:87], v10 offset:8704
    v_mfma_f32_16x16x32_bf16 v[120:123], a[112:115], v[88:91], v[120:123]
    v_mfma_f32_16x16x32_bf16 v[244:247], v[140:143], a[120:123], v[244:247]
    v_mfma_f32_16x16x32_bf16 v[248:251], v[140:143], a[124:127], v[248:251]
    ds_read_b128 v[140:143], v33 offset:64
    v_add_u32 v33, s55, v34
    v_mfma_f32_16x16x32_bf16 v[96:99], a[128:131], v[64:67], v[96:99]
    ds_read_b64_tr_b16 v[88:89], v11 offset:0
    ds_read_b64_tr_b16 v[90:91], v11 offset:512
    v_mfma_f32_16x16x32_bf16 v[96:99], a[136:139], v[68:71], v[96:99]
    buffer_load_dwordx4 v21, s[12:15], s65 offen offset:1024 lds
    v_mfma_f32_16x16x32_bf16 v[100:103], a[140:143], v[68:71], v[100:103]
    s_waitcnt lgkmcnt(7)
    ds_read_b64_tr_b16 v[92:93], v11 offset:8192
    ds_read_b64_tr_b16 v[94:95], v11 offset:8704
    v_mfma_f32_16x16x32_bf16 v[100:103], a[132:135], v[64:67], v[100:103]
    s_waitcnt vmcnt(8)
    s_barrier
    v_mfma_f32_16x16x32_bf16 v[108:111], a[132:135], v[72:75], v[108:111]
    s_add_u32 m0, s44, 49152
    ds_read_b64_tr_b16 v[64:65], v8 offset:2048
    ds_read_b64_tr_b16 v[66:67], v8 offset:2560
    v_mfma_f32_16x16x32_bf16 v[108:111], a[140:143], v[76:79], v[108:111]
    s_nop 0
    ds_read_b128 a[144:147], v28 offset:16384
    ds_read_b128 a[152:155], v29 offset:16384
    buffer_load_dwordx4 v20, s[12:15], s84 offen offset:0 lds
    v_mfma_f32_16x16x32_bf16 v[104:107], a[136:139], v[76:79], v[104:107]
    s_waitcnt lgkmcnt(9)
    ds_read_b64_tr_b16 v[68:69], v8 offset:10240
    ds_read_b64_tr_b16 v[70:71], v8 offset:10752
    v_mfma_f32_16x16x32_bf16 v[104:107], a[128:131], v[72:75], v[104:107]
    buffer_load_dword v56, v63, s[36:39], 0 offen sc1
    v_mfma_f32_16x16x32_bf16 v[244:247], v[136:139], a[128:131], v[244:247]
    v_mfma_f32_16x16x32_bf16 v[248:251], v[136:139], a[132:135], v[248:251]
    ds_read_b128 v[136:139], v33 offset:0
    v_mfma_f32_16x16x32_bf16 v[112:115], a[128:131], v[80:83], v[112:115]
    s_waitcnt lgkmcnt(9)
    ds_read_b64_tr_b16 v[72:73], v9 offset:2048
    ds_read_b64_tr_b16 v[74:75], v9 offset:2560
    v_mfma_f32_16x16x32_bf16 v[112:115], a[136:139], v[84:87], v[112:115]
    s_nop 0
    ds_read_b128 a[148:151], v28 offset:17408
    ds_read_b128 a[156:159], v29 offset:17408
    buffer_load_dwordx4 v21, s[12:15], s84 offen offset:1024 lds
    v_mfma_f32_16x16x32_bf16 v[116:119], a[140:143], v[84:87], v[116:119]
    s_waitcnt lgkmcnt(11)
    ds_read_b64_tr_b16 v[76:77], v9 offset:10240
    ds_read_b64_tr_b16 v[78:79], v9 offset:10752
    v_mfma_f32_16x16x32_bf16 v[116:119], a[132:135], v[80:83], v[116:119]
    v_mfma_f32_16x16x32_bf16 v[124:127], a[132:135], v[88:91], v[124:127]
    s_add_u32 m0, s44, 51200
    ds_read_b64_tr_b16 v[80:81], v10 offset:2048
    ds_read_b64_tr_b16 v[82:83], v10 offset:2560
    v_mfma_f32_16x16x32_bf16 v[124:127], a[140:143], v[92:95], v[124:127]
    buffer_load_dwordx4 v20, s[12:15], s85 offen offset:0 lds
    v_mfma_f32_16x16x32_bf16 v[120:123], a[136:139], v[92:95], v[120:123]
    s_waitcnt lgkmcnt(4)
    ds_read_b64_tr_b16 v[84:85], v10 offset:10240
    ds_read_b64_tr_b16 v[86:87], v10 offset:10752
    v_mfma_f32_16x16x32_bf16 v[120:123], a[128:131], v[88:91], v[120:123]
    v_mfma_f32_16x16x32_bf16 v[244:247], v[140:143], a[136:139], v[244:247]
    v_mfma_f32_16x16x32_bf16 v[248:251], v[140:143], a[140:143], v[248:251]
    ds_read_b128 v[140:143], v33 offset:64
    v_mfma_f32_16x16x32_bf16 v[96:99], a[144:147], v[64:67], v[96:99]
    ds_read_b64_tr_b16 v[88:89], v11 offset:2048
    ds_read_b64_tr_b16 v[90:91], v11 offset:2560
    v_mfma_f32_16x16x32_bf16 v[96:99], a[152:155], v[68:71], v[96:99]
    buffer_load_dwordx4 v21, s[12:15], s85 offen offset:1024 lds
    v_mfma_f32_16x16x32_bf16 v[100:103], a[156:159], v[68:71], v[100:103]
    s_waitcnt lgkmcnt(7)
    ds_read_b64_tr_b16 v[92:93], v11 offset:10240
    ds_read_b64_tr_b16 v[94:95], v11 offset:10752
    v_mfma_f32_16x16x32_bf16 v[100:103], a[148:151], v[64:67], v[100:103]
    s_waitcnt vmcnt(9)
    s_barrier
    v_mfma_f32_16x16x32_bf16 v[108:111], a[148:151], v[72:75], v[108:111]
    s_add_u32 m0, s44, 0
    ds_read_b64_tr_b16 v[64:65], v8 offset:16384
    ds_read_b64_tr_b16 v[66:67], v8 offset:16896
    v_mfma_f32_16x16x32_bf16 v[108:111], a[156:159], v[76:79], v[108:111]
    buffer_load_dwordx4 v20, s[12:15], s86 offen offset:0 lds
    v_mfma_f32_16x16x32_bf16 v[104:107], a[152:155], v[76:79], v[104:107]
    s_waitcnt lgkmcnt(7)
    ds_read_b64_tr_b16 v[68:69], v8 offset:24576
    ds_read_b64_tr_b16 v[70:71], v8 offset:25088
    v_mfma_f32_16x16x32_bf16 v[104:107], a[144:147], v[72:75], v[104:107]
    v_mfma_f32_16x16x32_bf16 v[244:247], v[136:139], a[144:147], v[244:247]
    v_mfma_f32_16x16x32_bf16 v[248:251], v[136:139], a[148:151], v[248:251]
    v_mfma_f32_16x16x32_bf16 v[112:115], a[144:147], v[80:83], v[112:115]
    s_waitcnt lgkmcnt(6)
    ds_read_b64_tr_b16 v[72:73], v9 offset:16384
    ds_read_b64_tr_b16 v[74:75], v9 offset:16896
    v_mfma_f32_16x16x32_bf16 v[112:115], a[152:155], v[84:87], v[112:115]
    buffer_load_dwordx4 v21, s[12:15], s86 offen offset:1024 lds
    v_mfma_f32_16x16x32_bf16 v[116:119], a[156:159], v[84:87], v[116:119]
    s_waitcnt lgkmcnt(6)
    ds_read_b64_tr_b16 v[76:77], v9 offset:24576
    ds_read_b64_tr_b16 v[78:79], v9 offset:25088
    v_mfma_f32_16x16x32_bf16 v[116:119], a[148:151], v[80:83], v[116:119]
    s_mul_i32 s46, s46, 1728
    v_mfma_f32_16x16x32_bf16 v[124:127], a[148:151], v[88:91], v[124:127]
    s_add_u32 m0, s44, 131072
    ds_read_b64_tr_b16 v[80:81], v10 offset:16384
    ds_read_b64_tr_b16 v[82:83], v10 offset:16896
    v_mfma_f32_16x16x32_bf16 v[124:127], a[156:159], v[92:95], v[124:127]
    buffer_load_dwordx4 v22, s[16:19], s46 offen offset:0 lds
    v_mfma_f32_16x16x32_bf16 v[120:123], a[152:155], v[92:95], v[120:123]
    s_waitcnt lgkmcnt(6)
    ds_read_b64_tr_b16 v[84:85], v10 offset:24576
    ds_read_b64_tr_b16 v[86:87], v10 offset:25088
    v_mfma_f32_16x16x32_bf16 v[120:123], a[144:147], v[88:91], v[120:123]
    v_mfma_f32_16x16x32_bf16 v[244:247], v[140:143], a[152:155], v[244:247]
    v_mfma_f32_16x16x32_bf16 v[248:251], v[140:143], a[156:159], v[248:251]
    v_mfma_f32_16x16x32_bf16 v[128:131], a[0:3], v[64:67], 0
    s_waitcnt lgkmcnt(6)
    ds_read_b64_tr_b16 v[88:89], v11 offset:16384
    ds_read_b64_tr_b16 v[90:91], v11 offset:16896
    v_mfma_f32_16x16x32_bf16 v[128:131], a[8:11], v[68:71], v[128:131]
    buffer_load_dwordx4 v23, s[16:19], s46 offen offset:1024 lds
    v_mfma_f32_16x16x32_bf16 v[132:135], a[12:15], v[68:71], 0
    s_waitcnt lgkmcnt(6)
    ds_read_b64_tr_b16 v[92:93], v11 offset:24576
    ds_read_b64_tr_b16 v[94:95], v11 offset:25088
    v_mfma_f32_16x16x32_bf16 v[132:135], a[4:7], v[64:67], v[132:135]
    s_mul_i32 s87, s87, 1728
    v_cvt_pk_bf16_f32 v192, v96, v97
    v_mfma_f32_16x16x32_bf16 v[140:143], a[4:7], v[72:75], 0
    s_add_u32 m0, s44, 133120
    ds_read_b64_tr_b16 v[64:65], v8 offset:18432
    ds_read_b64_tr_b16 v[66:67], v8 offset:18944
    v_mfma_f32_16x16x32_bf16 v[140:143], a[12:15], v[76:79], v[140:143]
    buffer_load_dwordx4 v22, s[16:19], s87 offen offset:0 lds
    v_mfma_f32_16x16x32_bf16 v[136:139], a[8:11], v[76:79], 0
    s_waitcnt lgkmcnt(6)
    ds_read_b64_tr_b16 v[68:69], v8 offset:26624
    ds_read_b64_tr_b16 v[70:71], v8 offset:27136
    v_mfma_f32_16x16x32_bf16 v[136:139], a[0:3], v[72:75], v[136:139]
    s_waitcnt vmcnt(8)
    v_cmp_eq_u32 vcc, 0, v56
    s_nop 0
    s_cbranch_vccnz L_spin_13
L_ok_14:
L_pad8:
    s_cmp_eq_u32 s92, 1
    s_cbranch_scc1 L_main
    v_cmp_eq_u32 vcc, 3, v56
    s_nop 0
    s_bcnt1_i32_b64 s76, vcc
    v_cmp_eq_u32 vcc, 5, v56
    s_nop 0
    s_bcnt1_i32_b64 s77, vcc
    s_cmp_lt_u32 s76, s77
    s_cselect_b32 s3, 0x200000, 0
    s_add_u32 s20, s20, s3
    s_addc_u32 s21, s21, 0
    v_cvt_pk_bf16_f32 v193, v98, v99
    v_cvt_pk_bf16_f32 v194, v100, v101
    v_mfma_f32_16x16x32_bf16 v[144:147], a[0:3], v[80:83], 0
    s_waitcnt lgkmcnt(6)
    ds_read_b64_tr_b16 v[72:73], v9 offset:18432
    ds_read_b64_tr_b16 v[74:75], v9 offset:18944
    v_mfma_f32_16x16x32_bf16 v[144:147], a[8:11], v[84:87], v[144:147]
    buffer_load_dwordx4 v23, s[16:19], s87 offen offset:1024 lds
    v_subrev_u32 v24, 0x10000, v41
    v_subrev_u32 v25, 0x10000, v42
    v_subrev_u32 v26, 0x10000, v43
    v_subrev_u32 v27, 0x10000, v44
    v_mfma_f32_16x16x32_bf16 v[148:151], a[12:15], v[84:87], 0
    s_waitcnt lgkmcnt(6)
    ds_read_b64_tr_b16 v[76:77], v9 offset:26624
    ds_read_b64_tr_b16 v[78:79], v9 offset:27136
    v_mfma_f32_16x16x32_bf16 v[148:151], a[4:7], v[80:83], v[148:151]
    v_cvt_pk_bf16_f32 v195, v102, v103
    v_cvt_pk_bf16_f32 v196, v104, v105
    v_lshlrev_b32 v236, 4, v1
    v_add_u32 v237, 4096, v236
    v_and_b32 v3, 31, v1
    v_mfma_f32_16x16x32_bf16 v[156:159], a[4:7], v[88:91], 0
    s_waitcnt lgkmcnt(6)
    ds_read_b64_tr_b16 v[80:81], v10 offset:18432
    ds_read_b64_tr_b16 v[82:83], v10 offset:18944
    v_mfma_f32_16x16x32_bf16 v[156:159], a[12:15], v[92:95], v[156:159]
    buffer_store_dwordx4 v[192:195], v30, s[20:23], s49 offen sc1
    v_lshlrev_b32 v61, 2, v3
    v_min_u32 v6, 5, v1
    v_lshrrev_b32 v4, 1, v6
    v_mfma_f32_16x16x32_bf16 v[152:155], a[8:11], v[92:95], 0
    s_waitcnt lgkmcnt(6)
    ds_read_b64_tr_b16 v[84:85], v10 offset:26624
    ds_read_b64_tr_b16 v[86:87], v10 offset:27136
    v_mfma_f32_16x16x32_bf16 v[152:155], a[0:3], v[88:91], v[152:155]
    v_cvt_pk_bf16_f32 v197, v106, v107
    v_cvt_pk_bf16_f32 v198, v108, v109
    v_add_u32 v4, s6, v4
    v_cmp_le_u32 s[78:79], 2, v4
    v_mov_b32 v5, 0x3f803f80
    v_mfma_f32_16x16x32_bf16 v[128:131], a[16:19], v[64:67], v[128:131]
    s_waitcnt lgkmcnt(6)
    ds_read_b64_tr_b16 v[88:89], v11 offset:18432
    ds_read_b64_tr_b16 v[90:91], v11 offset:18944
    v_mfma_f32_16x16x32_bf16 v[128:131], a[24:27], v[68:71], v[128:131]
    v_cvt_pk_bf16_f32 v199, v110, v111
    v_cvt_pk_bf16_f32 v200, v112, v113
    v_mul_u32_u24 v62, 5136, v6
    v_cndmask_b32 v232, 0, v5, s[78:79]
    v_cndmask_b32 v233, 0, v5, s[78:79]
    v_mfma_f32_16x16x32_bf16 v[132:135], a[28:31], v[68:71], v[132:135]
    s_waitcnt lgkmcnt(6)
    ds_read_b64_tr_b16 v[92:93], v11 offset:26624
    ds_read_b64_tr_b16 v[94:95], v11 offset:27136
    v_mfma_f32_16x16x32_bf16 v[132:135], a[20:23], v[64:67], v[132:135]
    s_barrier
    v_cndmask_b32 v234, 0, v5, s[78:79]
    v_cndmask_b32 v235, 0, v5, s[78:79]
    v_lshrrev_b32 v2, 5, v1
    v_mfma_f32_16x16x32_bf16 v[140:143], a[20:23], v[72:75], v[140:143]
    s_add_u32 m0, s44, 2048
    ds_read_b64_tr_b16 v[64:65], v8 offset:32768
    ds_read_b64_tr_b16 v[66:67], v8 offset:33280
    v_mfma_f32_16x16x32_bf16 v[140:143], a[28:31], v[76:79], v[140:143]
    buffer_load_dwordx4 v20, s[12:15], s0 offen offset:0 lds
    v_and_b32 v3, 31, v1
    v_cmp_gt_u32 s[78:79], 16, v3
    v_and_b32 v6, 3, v1
    v_bfe_u32 v7, v1, 2, 1
    v_mfma_f32_16x16x32_bf16 v[136:139], a[24:27], v[76:79], v[136:139]
    s_waitcnt lgkmcnt(6)
    ds_read_b64_tr_b16 v[68:69], v8 offset:40960
    ds_read_b64_tr_b16 v[70:71], v8 offset:41472
    v_mfma_f32_16x16x32_bf16 v[136:139], a[16:19], v[72:75], v[136:139]
    buffer_store_dwordx4 v[196:199], v240, s[20:23], s50 offen sc1
    v_lshl_add_u32 v7, v7, 3, v6
    v_bfe_u32 v4, v1, 3, 1
    v_lshl_add_u32 v7, v4, 2, v7
    v_mfma_f32_16x16x32_bf16 v[144:147], a[16:19], v[80:83], v[144:147]
    s_waitcnt lgkmcnt(6)
    ds_read_b64_tr_b16 v[72:73], v9 offset:32768
    ds_read_b64_tr_b16 v[74:75], v9 offset:33280
    v_mfma_f32_16x16x32_bf16 v[144:147], a[24:27], v[84:87], v[144:147]
    buffer_load_dwordx4 v21, s[12:15], s0 offen offset:1024 lds
    v_add_u32 v5, 16, v6
    v_cndmask_b32 v7, v5, v7, s[78:79]
    v_cndmask_b32 v4, 4, 24, s[78:79]
    v_mfma_f32_16x16x32_bf16 v[148:151], a[28:31], v[84:87], v[148:151]
    s_waitcnt lgkmcnt(6)
    ds_read_b64_tr_b16 v[76:77], v9 offset:40960
    ds_read_b64_tr_b16 v[78:79], v9 offset:41472
    v_mfma_f32_16x16x32_bf16 v[148:151], a[20:23], v[80:83], v[148:151]
    v_cvt_pk_bf16_f32 v201, v114, v115
    v_cvt_pk_bf16_f32 v202, v116, v117
    v_mul_u32_u24 v5, 640, v2
    v_cmp_gt_u32 s[78:79], 24, v3
    v_lshl_add_u32 v6, v7, 4, v5
    v_mfma_f32_16x16x32_bf16 v[156:159], a[20:23], v[88:91], v[156:159]
    s_add_u32 m0, s44, 16384
    ds_read_b64_tr_b16 v[80:81], v10 offset:32768
    ds_read_b64_tr_b16 v[82:83], v10 offset:33280
    v_mfma_f32_16x16x32_bf16 v[156:159], a[28:31], v[92:95], v[156:159]
    buffer_load_dwordx4 v20, s[12:15], s1 offen offset:0 lds
    v_lshl_add_u32 v7, v4, 4, v6
    v_mov_b32 v5, 1280
    v_cndmask_b32 v5, 0, v5, s[78:79]
    v_mfma_f32_16x16x32_bf16 v[152:155], a[24:27], v[92:95], v[152:155]
    s_waitcnt lgkmcnt(6)
    ds_read_b64_tr_b16 v[84:85], v10 offset:40960
    ds_read_b64_tr_b16 v[86:87], v10 offset:41472
    v_mfma_f32_16x16x32_bf16 v[152:155], a[16:19], v[88:91], v[152:155]
    v_cvt_pk_bf16_f32 v203, v118, v119
    v_cvt_pk_bf16_f32 v204, v120, v121
    s_add_u32 s80, s5, 0
    s_lshr_b32 s81, s80, 1
    s_mul_i32 s81, s81, 5136
    v_mfma_f32_16x16x32_bf16 v[128:131], a[32:35], v[64:67], v[128:131]
    s_waitcnt lgkmcnt(6)
    ds_read_b64_tr_b16 v[88:89], v11 offset:32768
    ds_read_b64_tr_b16 v[90:91], v11 offset:33280
    v_mfma_f32_16x16x32_bf16 v[128:131], a[40:43], v[68:71], v[128:131]
    buffer_load_dwordx4 v21, s[12:15], s1 offen offset:1024 lds
    s_and_b32 s80, s80, 1
    s_mul_i32 s80, s80, 2560
    s_add_u32 s80, s80, s81
    s_add_u32 s81, s81, 5120
    v_mfma_f32_16x16x32_bf16 v[132:135], a[44:47], v[68:71], v[132:135]
    s_waitcnt lgkmcnt(6)
    ds_read_b64_tr_b16 v[92:93], v11 offset:40960
    ds_read_b64_tr_b16 v[94:95], v11 offset:41472
    v_mfma_f32_16x16x32_bf16 v[132:135], a[36:39], v[64:67], v[132:135]
    buffer_store_dwordx4 v[200:203], v243, s[20:23], s49 offen sc1
    v_mov_b32 v0, s81
    v_add_u32 v4, s80, v6
    v_cndmask_b32 v224, v0, v4, s[78:79]
    v_mfma_f32_16x16x32_bf16 v[140:143], a[36:39], v[72:75], v[140:143]
    s_waitcnt lgkmcnt(6)
    ds_read_b64_tr_b16 v[64:65], v8 offset:34816
    ds_read_b64_tr_b16 v[66:67], v8 offset:35328
    v_mfma_f32_16x16x32_bf16 v[140:143], a[44:47], v[76:79], v[140:143]
    v_cvt_pk_bf16_f32 v205, v122, v123
    v_cvt_pk_bf16_f32 v206, v124, v125
    v_add_u32 v225, v5, v224
    v_add_u32 v4, s80, v7
    v_cndmask_b32 v228, v0, v4, s[78:79]
    v_mfma_f32_16x16x32_bf16 v[136:139], a[40:43], v[76:79], v[136:139]
    s_waitcnt lgkmcnt(6)
    ds_read_b64_tr_b16 v[68:69], v8 offset:43008
    ds_read_b64_tr_b16 v[70:71], v8 offset:43520
    v_mfma_f32_16x16x32_bf16 v[136:139], a[32:35], v[72:75], v[136:139]
    s_mul_i32 s93, s93, 1728
    v_cvt_pk_bf16_f32 v207, v126, v127
    v_add_u32 v229, v5, v228
    s_add_u32 s80, s5, 1
    s_lshr_b32 s81, s80, 1
    v_mfma_f32_16x16x32_bf16 v[144:147], a[32:35], v[80:83], v[144:147]
    s_add_u32 m0, s44, 98304
    ds_read_b64_tr_b16 v[72:73], v9 offset:34816
    ds_read_b64_tr_b16 v[74:75], v9 offset:35328
    v_mfma_f32_16x16x32_bf16 v[144:147], a[40:43], v[84:87], v[144:147]
    buffer_load_dwordx4 v22, s[16:19], s93 offen offset:0 lds
    s_mul_i32 s81, s81, 5136
    s_and_b32 s80, s80, 1
    s_mul_i32 s80, s80, 2560
    v_mfma_f32_16x16x32_bf16 v[148:151], a[44:47], v[84:87], v[148:151]
    s_waitcnt lgkmcnt(6)
    ds_read_b64_tr_b16 v[76:77], v9 offset:43008
    ds_read_b64_tr_b16 v[78:79], v9 offset:43520
    v_mfma_f32_16x16x32_bf16 v[148:151], a[36:39], v[80:83], v[148:151]
    buffer_store_dwordx4 v[204:207], v254, s[20:23], s50 offen sc1
    s_add_u32 s80, s80, s81
    s_add_u32 s81, s81, 5120
    v_mov_b32 v0, s81
    v_mfma_f32_16x16x32_bf16 v[156:159], a[36:39], v[88:91], v[156:159]
    s_waitcnt lgkmcnt(6)
    ds_read_b64_tr_b16 v[80:81], v10 offset:34816
    ds_read_b64_tr_b16 v[82:83], v10 offset:35328
    v_mfma_f32_16x16x32_bf16 v[156:159], a[44:47], v[92:95], v[156:159]
    buffer_load_dwordx4 v23, s[16:19], s93 offen offset:1024 lds
    v_add_u32 v4, s80, v6
    v_cndmask_b32 v226, v0, v4, s[78:79]
    v_add_u32 v227, v5, v226
    v_add_u32 v4, s80, v7
    v_mfma_f32_16x16x32_bf16 v[152:155], a[40:43], v[92:95], v[152:155]
    s_waitcnt lgkmcnt(6)
    ds_read_b64_tr_b16 v[84:85], v10 offset:43008
    ds_read_b64_tr_b16 v[86:87], v10 offset:43520
    v_mfma_f32_16x16x32_bf16 v[152:155], a[32:35], v[88:91], v[152:155]
    v_cmp_gt_u32 vcc, 16, v1
    s_nop 1
    v_cndmask_b32 v252, v248, v244, vcc
    v_cndmask_b32 v230, v0, v4, s[78:79]
    v_add_u32 v231, v5, v230
    v_lshlrev_b32 v4, 2, v2
    v_mfma_f32_16x16x32_bf16 v[128:131], a[48:51], v[64:67], v[128:131]
    s_waitcnt lgkmcnt(6)
    ds_read_b64_tr_b16 v[88:89], v11 offset:34816
    ds_read_b64_tr_b16 v[90:91], v11 offset:35328
    v_mfma_f32_16x16x32_bf16 v[128:131], a[56:59], v[68:71], v[128:131]
    v_mul_f32 v252, 0xbfb8aa3b, v252
    v_add_u32 v30, 8, v238
    v_sub_u32 v4, v3, v4
    v_mov_b32 v5, 0xf1800000
    v_cmp_le_i32 s[78:79], 0, v4
    v_mfma_f32_16x16x32_bf16 v[132:135], a[60:63], v[68:71], v[132:135]
    s_waitcnt lgkmcnt(6)
    ds_read_b64_tr_b16 v[92:93], v11 offset:43008
    ds_read_b64_tr_b16 v[94:95], v11 offset:43520
    v_mfma_f32_16x16x32_bf16 v[132:135], a[52:55], v[64:67], v[132:135]
    s_waitcnt vmcnt(16)
    s_barrier
    v_cmp_le_i32 s[80:81], 1, v4
    v_cndmask_b32 v160, 0, v5, s[78:79]
    v_cndmask_b32 v176, v5, 0, s[78:79]
    v_mfma_f32_16x16x32_bf16 v[140:143], a[52:55], v[72:75], v[140:143]
    s_add_u32 m0, s44, 18432
    ds_read_b64_tr_b16 v[64:65], v8 offset:49152
    ds_read_b64_tr_b16 v[66:67], v8 offset:49664
    v_mfma_f32_16x16x32_bf16 v[140:143], a[60:63], v[76:79], v[140:143]
    buffer_load_dwordx4 v20, s[12:15], s40 offen offset:0 lds
    v_cmp_le_i32 s[78:79], 2, v4
    v_cndmask_b32 v161, 0, v5, s[80:81]
    v_cndmask_b32 v177, v5, 0, s[80:81]
    v_mfma_f32_16x16x32_bf16 v[136:139], a[56:59], v[76:79], v[136:139]
    s_waitcnt lgkmcnt(6)
    ds_read_b64_tr_b16 v[68:69], v8 offset:57344
    ds_read_b64_tr_b16 v[70:71], v8 offset:57856
    v_mfma_f32_16x16x32_bf16 v[136:139], a[48:51], v[72:75], v[136:139]
    v_exp_f32 v252, v252
    v_cmp_le_i32 s[80:81], 3, v4
    v_cndmask_b32 v162, 0, v5, s[78:79]
    v_cndmask_b32 v178, v5, 0, s[78:79]
    v_mfma_f32_16x16x32_bf16 v[144:147], a[48:51], v[80:83], v[144:147]
    s_waitcnt lgkmcnt(6)
    ds_read_b64_tr_b16 v[72:73], v9 offset:49152
    ds_read_b64_tr_b16 v[74:75], v9 offset:49664
    v_mfma_f32_16x16x32_bf16 v[144:147], a[56:59], v[84:87], v[144:147]
    buffer_load_dwordx4 v21, s[12:15], s40 offen offset:1024 lds
    v_cmp_le_i32 s[78:79], 8, v4
    v_cndmask_b32 v163, 0, v5, s[80:81]
    v_cndmask_b32 v179, v5, 0, s[80:81]
    v_cmp_le_i32 s[80:81], 9, v4
    v_mfma_f32_16x16x32_bf16 v[148:151], a[60:63], v[84:87], v[148:151]
    s_waitcnt lgkmcnt(6)
    ds_read_b64_tr_b16 v[76:77], v9 offset:57344
    ds_read_b64_tr_b16 v[78:79], v9 offset:57856
    v_mfma_f32_16x16x32_bf16 v[148:151], a[52:55], v[80:83], v[148:151]
    s_mul_i32 s100, s100, 1728
    v_add_f32 v252, 1.0, v252
    v_cndmask_b32 v164, 0, v5, s[78:79]
    v_cndmask_b32 v180, v5, 0, s[78:79]
    v_cmp_le_i32 s[78:79], 10, v4
    v_mfma_f32_16x16x32_bf16 v[156:159], a[52:55], v[88:91], v[156:159]
    s_add_u32 m0, s44, 100352
    ds_read_b64_tr_b16 v[80:81], v10 offset:49152
    ds_read_b64_tr_b16 v[82:83], v10 offset:49664
    v_mfma_f32_16x16x32_bf16 v[156:159], a[60:63], v[92:95], v[156:159]
    buffer_load_dwordx4 v22, s[16:19], s100 offen offset:0 lds
    v_cndmask_b32 v165, 0, v5, s[80:81]
    v_cndmask_b32 v181, v5, 0, s[80:81]
    v_cmp_le_i32 s[80:81], 11, v4
    v_mfma_f32_16x16x32_bf16 v[152:155], a[56:59], v[92:95], v[152:155]
    s_waitcnt lgkmcnt(6)
    ds_read_b64_tr_b16 v[84:85], v10 offset:57344
    ds_read_b64_tr_b16 v[86:87], v10 offset:57856
    v_mfma_f32_16x16x32_bf16 v[152:155], a[48:51], v[88:91], v[152:155]
    v_rcp_f32 v252, v252
    v_cndmask_b32 v166, 0, v5, s[78:79]
    v_cndmask_b32 v182, v5, 0, s[78:79]
    v_cmp_le_i32 s[78:79], 16, v4
    v_mfma_f32_16x16x32_bf16 v[128:131], a[64:67], v[64:67], v[128:131]
    s_waitcnt lgkmcnt(6)
    ds_read_b64_tr_b16 v[88:89], v11 offset:49152
    ds_read_b64_tr_b16 v[90:91], v11 offset:49664
    v_mfma_f32_16x16x32_bf16 v[128:131], a[72:75], v[68:71], v[128:131]
    buffer_load_dwordx4 v23, s[16:19], s100 offen offset:1024 lds
    v_cndmask_b32 v167, 0, v5, s[80:81]
    v_cndmask_b32 v183, v5, 0, s[80:81]
    v_cmp_le_i32 s[80:81], 17, v4
    v_mfma_f32_16x16x32_bf16 v[132:135], a[76:79], v[68:71], v[132:135]
    s_waitcnt lgkmcnt(6)
    ds_read_b64_tr_b16 v[92:93], v11 offset:57344
    ds_read_b64_tr_b16 v[94:95], v11 offset:57856
    v_mfma_f32_16x16x32_bf16 v[132:135], a[68:71], v[64:67], v[132:135]
    buffer_store_dword v252, v32, s[20:23], 0 offen sc1
    v_cndmask_b32 v168, 0, v5, s[78:79]
    v_cndmask_b32 v184, v5, 0, s[78:79]
    v_cmp_le_i32 s[78:79], 18, v4
    v_mfma_f32_16x16x32_bf16 v[140:143], a[68:71], v[72:75], v[140:143]
    s_waitcnt lgkmcnt(6)
    ds_read_b64_tr_b16 v[64:65], v8 offset:51200
    ds_read_b64_tr_b16 v[66:67], v8 offset:51712
    v_mfma_f32_16x16x32_bf16 v[140:143], a[76:79], v[76:79], v[140:143]
    v_mul_u32_u24 v255, 205, v30
    v_lshl_add_u32 v30, v30, 7, v239
    v_cndmask_b32 v169, 0, v5, s[80:81]
    v_cndmask_b32 v185, v5, 0, s[80:81]
    v_cmp_le_i32 s[80:81], 19, v4
    v_cndmask_b32 v170, 0, v5, s[78:79]
    v_mfma_f32_16x16x32_bf16 v[136:139], a[72:75], v[76:79], v[136:139]
    s_waitcnt lgkmcnt(6)
    ds_read_b64_tr_b16 v[68:69], v8 offset:59392
    ds_read_b64_tr_b16 v[70:71], v8 offset:59904
    v_mfma_f32_16x16x32_bf16 v[136:139], a[64:67], v[72:75], v[136:139]
    v_lshrrev_b32 v255, 10, v255
    v_mad_u32_u24 v30, v255, s64, v30
    v_cndmask_b32 v186, v5, 0, s[78:79]
    v_cmp_le_i32 s[78:79], 24, v4
    v_cndmask_b32 v171, 0, v5, s[80:81]
    v_mfma_f32_16x16x32_bf16 v[144:147], a[64:67], v[80:83], v[144:147]
    s_waitcnt lgkmcnt(6)
    ds_read_b64_tr_b16 v[72:73], v9 offset:51200
    ds_read_b64_tr_b16 v[74:75], v9 offset:51712
    v_mfma_f32_16x16x32_bf16 v[144:147], a[72:75], v[84:87], v[144:147]
    v_add3_u32 v240, v238, s53, 8
    v_mul_u32_u24 v255, 205, v240
    v_cndmask_b32 v187, v5, 0, s[80:81]
    v_cmp_le_i32 s[80:81], 25, v4
    v_cndmask_b32 v172, 0, v5, s[78:79]
    v_mfma_f32_16x16x32_bf16 v[148:151], a[76:79], v[84:87], v[148:151]
    s_waitcnt lgkmcnt(6)
    ds_read_b64_tr_b16 v[76:77], v9 offset:59392
    ds_read_b64_tr_b16 v[78:79], v9 offset:59904
    v_mfma_f32_16x16x32_bf16 v[148:151], a[68:71], v[80:83], v[148:151]
    v_lshl_add_u32 v240, v240, 7, v239
    v_lshrrev_b32 v255, 10, v255
    v_cndmask_b32 v188, v5, 0, s[78:79]
    v_cmp_le_i32 s[78:79], 26, v4
    v_cndmask_b32 v173, 0, v5, s[80:81]
    v_mfma_f32_16x16x32_bf16 v[156:159], a[68:71], v[88:91], v[156:159]
    s_waitcnt lgkmcnt(6)
    ds_read_b64_tr_b16 v[80:81], v10 offset:51200
    ds_read_b64_tr_b16 v[82:83], v10 offset:51712
    v_mfma_f32_16x16x32_bf16 v[156:159], a[76:79], v[92:95], v[156:159]
    v_mad_u32_u24 v240, v255, s64, v240
    v_add_u32 v243, 12, v238
    v_cndmask_b32 v189, v5, 0, s[80:81]
    v_cmp_le_i32 s[80:81], 27, v4
    v_cndmask_b32 v174, 0, v5, s[78:79]
    v_mfma_f32_16x16x32_bf16 v[152:155], a[72:75], v[92:95], v[152:155]
    s_waitcnt lgkmcnt(6)
    ds_read_b64_tr_b16 v[84:85], v10 offset:59392
    ds_read_b64_tr_b16 v[86:87], v10 offset:59904
    v_mfma_f32_16x16x32_bf16 v[152:155], a[64:67], v[88:91], v[152:155]
    s_mul_i32 s101, s101, 1728
    v_mul_u32_u24 v255, 205, v243
    v_cndmask_b32 v190, v5, 0, s[78:79]
    v_cndmask_b32 v175, 0, v5, s[80:81]
    v_cndmask_b32 v191, v5, 0, s[80:81]
    v_mfma_f32_16x16x32_bf16 v[128:131], a[80:83], v[64:67], v[128:131]
    s_add_u32 m0, s44, 114688
    ds_read_b64_tr_b16 v[88:89], v11 offset:51200
    ds_read_b64_tr_b16 v[90:91], v11 offset:51712
    v_mfma_f32_16x16x32_bf16 v[128:131], a[88:91], v[68:71], v[128:131]
    buffer_load_dwordx4 v22, s[16:19], s101 offen offset:0 lds
    v_mfma_f32_16x16x32_bf16 v[132:135], a[92:95], v[68:71], v[132:135]
    s_waitcnt lgkmcnt(6)
    ds_read_b64_tr_b16 v[92:93], v11 offset:59392
    ds_read_b64_tr_b16 v[94:95], v11 offset:59904
    v_mfma_f32_16x16x32_bf16 v[132:135], a[84:87], v[64:67], v[132:135]
    s_waitcnt vmcnt(12)
    s_barrier
    v_lshl_add_u32 v243, v243, 7, v239
    v_mfma_f32_16x16x32_bf16 v[140:143], a[84:87], v[72:75], v[140:143]
    s_waitcnt lgkmcnt(6)
    ds_read_b64_tr_b16 v[64:65], v8 offset:0
    ds_read_b64_tr_b16 v[66:67], v8 offset:512
    v_mfma_f32_16x16x32_bf16 v[140:143], a[92:95], v[76:79], v[140:143]
    buffer_load_dwordx4 v23, s[16:19], s101 offen offset:1024 lds
    v_mfma_f32_16x16x32_bf16 v[136:139], a[88:91], v[76:79], v[136:139]
    s_waitcnt lgkmcnt(6)
    ds_read_b64_tr_b16 v[68:69], v8 offset:8192
    ds_read_b64_tr_b16 v[70:71], v8 offset:8704
    v_mfma_f32_16x16x32_bf16 v[136:139], a[80:83], v[72:75], v[136:139]
    s_mul_i32 s41, s41, 1728
    v_lshrrev_b32 v255, 10, v255
    v_mfma_f32_16x16x32_bf16 v[144:147], a[80:83], v[80:83], v[144:147]
    s_add_u32 m0, s44, 116736
    ds_read_b64_tr_b16 v[72:73], v9 offset:0
    ds_read_b64_tr_b16 v[74:75], v9 offset:512
    v_mfma_f32_16x16x32_bf16 v[144:147], a[88:91], v[84:87], v[144:147]
    buffer_load_dwordx4 v22, s[16:19], s41 offen offset:0 lds
    v_mfma_f32_16x16x32_bf16 v[148:151], a[92:95], v[84:87], v[148:151]
    s_waitcnt lgkmcnt(6)
    ds_read_b64_tr_b16 v[76:77], v9 offset:8192
    ds_read_b64_tr_b16 v[78:79], v9 offset:8704
    v_mfma_f32_16x16x32_bf16 v[148:151], a[84:87], v[80:83], v[148:151]
    v_mad_u32_u24 v243, v255, s64, v243
    v_add3_u32 v254, v238, s53, 12
    v_mfma_f32_16x16x32_bf16 v[156:159], a[84:87], v[88:91], v[156:159]
    s_waitcnt lgkmcnt(6)
    ds_read_b64_tr_b16 v[80:81], v10 offset:0
    ds_read_b64_tr_b16 v[82:83], v10 offset:512
    v_mfma_f32_16x16x32_bf16 v[156:159], a[92:95], v[92:95], v[156:159]
    buffer_load_dwordx4 v23, s[16:19], s41 offen offset:1024 lds
    v_mfma_f32_16x16x32_bf16 v[152:155], a[88:91], v[92:95], v[152:155]
    s_waitcnt lgkmcnt(6)
    ds_read_b64_tr_b16 v[84:85], v10 offset:8192
    ds_read_b64_tr_b16 v[86:87], v10 offset:8704
    v_mfma_f32_16x16x32_bf16 v[152:155], a[80:83], v[88:91], v[152:155]
    v_mul_u32_u24 v255, 205, v254
    v_lshl_add_u32 v254, v254, 7, v239
    v_mfma_f32_16x16x32_bf16 v[128:131], a[96:99], v[64:67], v[128:131]
    s_waitcnt lgkmcnt(6)
    ds_read_b64_tr_b16 v[88:89], v11 offset:0
    ds_read_b64_tr_b16 v[90:91], v11 offset:512
    v_mfma_f32_16x16x32_bf16 v[128:131], a[104:107], v[68:71], v[128:131]
    v_lshrrev_b32 v255, 10, v255
    v_mad_u32_u24 v254, v255, s64, v254
    v_mfma_f32_16x16x32_bf16 v[132:135], a[108:111], v[68:71], v[132:135]
    s_waitcnt lgkmcnt(6)
    ds_read_b64_tr_b16 v[92:93], v11 offset:8192
    ds_read_b64_tr_b16 v[94:95], v11 offset:8704
    v_mfma_f32_16x16x32_bf16 v[132:135], a[100:103], v[64:67], v[132:135]
    v_mfma_f32_16x16x32_bf16 v[140:143], a[100:103], v[72:75], v[140:143]
    s_add_u32 m0, s44, 32768
    ds_read_b64_tr_b16 v[64:65], v8 offset:2048
    ds_read_b64_tr_b16 v[66:67], v8 offset:2560
    v_mfma_f32_16x16x32_bf16 v[140:143], a[108:111], v[76:79], v[140:143]
    buffer_load_dwordx4 v35, s[24:27], s69 offen offset:0 lds
    v_mfma_f32_16x16x32_bf16 v[136:139], a[104:107], v[76:79], v[136:139]
    s_waitcnt lgkmcnt(6)
    ds_read_b64_tr_b16 v[68:69], v8 offset:10240
    ds_read_b64_tr_b16 v[70:71], v8 offset:10752
    v_mfma_f32_16x16x32_bf16 v[136:139], a[96:99], v[72:75], v[136:139]
    v_mfma_f32_16x16x32_bf16 v[144:147], a[96:99], v[80:83], v[144:147]
    s_waitcnt lgkmcnt(6)
    ds_read_b64_tr_b16 v[72:73], v9 offset:2048
    ds_read_b64_tr_b16 v[74:75], v9 offset:2560
    v_mfma_f32_16x16x32_bf16 v[144:147], a[104:107], v[84:87], v[144:147]
    buffer_load_dwordx4 v36, s[24:27], s69 offen offset:1024 lds
    v_mfma_f32_16x16x32_bf16 v[148:151], a[108:111], v[84:87], v[148:151]
    s_waitcnt lgkmcnt(6)
    ds_read_b64_tr_b16 v[76:77], v9 offset:10240
    ds_read_b64_tr_b16 v[78:79], v9 offset:10752
    v_mfma_f32_16x16x32_bf16 v[148:151], a[100:103], v[80:83], v[148:151]
    v_mfma_f32_16x16x32_bf16 v[156:159], a[100:103], v[88:91], v[156:159]
    s_waitcnt lgkmcnt(6)
    ds_read_b64_tr_b16 v[80:81], v10 offset:2048
    ds_read_b64_tr_b16 v[82:83], v10 offset:2560
    v_mfma_f32_16x16x32_bf16 v[156:159], a[108:111], v[92:95], v[156:159]
    buffer_load_dwordx4 v37, s[24:27], s69 offen offset:2048 lds
    v_mfma_f32_16x16x32_bf16 v[152:155], a[104:107], v[92:95], v[152:155]
    s_waitcnt lgkmcnt(6)
    ds_read_b64_tr_b16 v[84:85], v10 offset:10240
    ds_read_b64_tr_b16 v[86:87], v10 offset:10752
    v_mfma_f32_16x16x32_bf16 v[152:155], a[96:99], v[88:91], v[152:155]
    v_mfma_f32_16x16x32_bf16 v[128:131], a[112:115], v[64:67], v[128:131]
    s_waitcnt lgkmcnt(6)
    ds_read_b64_tr_b16 v[88:89], v11 offset:2048
    ds_read_b64_tr_b16 v[90:91], v11 offset:2560
    v_mfma_f32_16x16x32_bf16 v[128:131], a[120:123], v[68:71], v[128:131]
    buffer_load_dwordx4 v38, s[24:27], s69 offen offset:3072 lds
    v_mfma_f32_16x16x32_bf16 v[132:135], a[124:127], v[68:71], v[132:135]
    s_waitcnt lgkmcnt(6)
    ds_read_b64_tr_b16 v[92:93], v11 offset:10240
    ds_read_b64_tr_b16 v[94:95], v11 offset:10752
    v_mfma_f32_16x16x32_bf16 v[132:135], a[116:119], v[64:67], v[132:135]
    s_waitcnt vmcnt(11)
    s_barrier
    s_add_u32 s69, s69, 40960
    v_mfma_f32_16x16x32_bf16 v[140:143], a[116:119], v[72:75], v[140:143]
    s_waitcnt lgkmcnt(6)
    ds_read_b64_tr_b16 v[64:65], v8 offset:16384
    ds_read_b64_tr_b16 v[66:67], v8 offset:16896
    v_mfma_f32_16x16x32_bf16 v[140:143], a[124:127], v[76:79], v[140:143]
    v_mfma_f32_16x16x32_bf16 v[136:139], a[120:123], v[76:79], v[136:139]
    s_waitcnt lgkmcnt(6)
    ds_read_b64_tr_b16 v[68:69], v8 offset:24576
    ds_read_b64_tr_b16 v[70:71], v8 offset:25088
    v_mfma_f32_16x16x32_bf16 v[136:139], a[112:115], v[72:75], v[136:139]
    s_mul_i32 s42, s42, 1728
    v_mfma_f32_16x16x32_bf16 v[144:147], a[112:115], v[80:83], v[144:147]
    s_add_u32 m0, s44, 65536
    ds_read_b64_tr_b16 v[72:73], v9 offset:16384
    ds_read_b64_tr_b16 v[74:75], v9 offset:16896
    v_mfma_f32_16x16x32_bf16 v[144:147], a[120:123], v[84:87], v[144:147]
    buffer_load_dwordx4 v22, s[16:19], s42 offen offset:0 lds
    v_mfma_f32_16x16x32_bf16 v[148:151], a[124:127], v[84:87], v[148:151]
    s_waitcnt lgkmcnt(6)
    ds_read_b64_tr_b16 v[76:77], v9 offset:24576
    ds_read_b64_tr_b16 v[78:79], v9 offset:25088
    v_mfma_f32_16x16x32_bf16 v[148:151], a[116:119], v[80:83], v[148:151]
    v_mfma_f32_16x16x32_bf16 v[156:159], a[116:119], v[88:91], v[156:159]
    s_waitcnt lgkmcnt(6)
    ds_read_b64_tr_b16 v[80:81], v8 offset:18432
    ds_read_b64_tr_b16 v[82:83], v8 offset:18944
    v_mfma_f32_16x16x32_bf16 v[156:159], a[124:127], v[92:95], v[156:159]
    buffer_load_dwordx4 v23, s[16:19], s42 offen offset:1024 lds
    v_mfma_f32_16x16x32_bf16 v[152:155], a[120:123], v[92:95], v[152:155]
    s_waitcnt lgkmcnt(6)
    ds_read_b64_tr_b16 v[84:85], v8 offset:26624
    ds_read_b64_tr_b16 v[86:87], v8 offset:27136
    v_mfma_f32_16x16x32_bf16 v[152:155], a[112:115], v[88:91], v[152:155]
    s_mul_i32 s43, s43, 1728
    v_mfma_f32_16x16x32_bf16 v[128:131], a[128:131], v[64:67], v[128:131]
    s_add_u32 m0, s44, 67584
    ds_read_b64_tr_b16 v[88:89], v9 offset:18432
    ds_read_b64_tr_b16 v[90:91], v9 offset:18944
    v_mfma_f32_16x16x32_bf16 v[128:131], a[136:139], v[68:71], v[128:131]
    buffer_load_dwordx4 v22, s[16:19], s43 offen offset:0 lds
    v_mfma_f32_16x16x32_bf16 v[132:135], a[140:143], v[68:71], v[132:135]
    s_waitcnt lgkmcnt(6)
    ds_read_b64_tr_b16 v[92:93], v9 offset:26624
    ds_read_b64_tr_b16 v[94:95], v9 offset:27136
    v_mfma_f32_16x16x32_bf16 v[132:135], a[132:135], v[64:67], v[132:135]
    v_mfma_f32_16x16x32_bf16 v[140:143], a[132:135], v[72:75], v[140:143]
    s_waitcnt lgkmcnt(6)
    ds_read_b64_tr_b16 v[64:65], v10 offset:16384
    ds_read_b64_tr_b16 v[66:67], v10 offset:16896
    v_mfma_f32_16x16x32_bf16 v[140:143], a[140:143], v[76:79], v[140:143]
    buffer_load_dwordx4 v23, s[16:19], s43 offen offset:1024 lds
    v_mfma_f32_16x16x32_bf16 v[136:139], a[136:139], v[76:79], v[136:139]
    s_waitcnt lgkmcnt(6)
    ds_read_b64_tr_b16 v[68:69], v10 offset:24576
    ds_read_b64_tr_b16 v[70:71], v10 offset:25088
    v_mfma_f32_16x16x32_bf16 v[136:139], a[128:131], v[72:75], v[136:139]
    v_mfma_f32_16x16x32_bf16 v[128:131], a[144:147], v[80:83], v[128:131]
    s_waitcnt lgkmcnt(6)
    ds_read_b64_tr_b16 v[72:73], v11 offset:16384
    ds_read_b64_tr_b16 v[74:75], v11 offset:16896
    v_mfma_f32_16x16x32_bf16 v[128:131], a[152:155], v[84:87], v[128:131]
    v_mfma_f32_16x16x32_bf16 v[132:135], a[156:159], v[84:87], v[132:135]
    s_waitcnt lgkmcnt(6)
    ds_read_b64_tr_b16 v[76:77], v11 offset:24576
    ds_read_b64_tr_b16 v[78:79], v11 offset:25088
    v_mfma_f32_16x16x32_bf16 v[132:135], a[148:151], v[80:83], v[132:135]
    v_mfma_f32_16x16x32_bf16 v[140:143], a[148:151], v[88:91], v[140:143]
    s_add_u32 m0, s44, 49152
    ds_read_b64_tr_b16 v[80:81], v10 offset:18432
    ds_read_b64_tr_b16 v[82:83], v10 offset:18944
    v_mfma_f32_16x16x32_bf16 v[140:143], a[156:159], v[92:95], v[140:143]
    buffer_load_dwordx4 v35, s[24:27], s69 offen offset:0 lds
    v_mfma_f32_16x16x32_bf16 v[136:139], a[152:155], v[92:95], v[136:139]
    s_waitcnt lgkmcnt(6)
    ds_read_b64_tr_b16 v[84:85], v10 offset:26624
    ds_read_b64_tr_b16 v[86:87], v10 offset:27136
    v_mfma_f32_16x16x32_bf16 v[136:139], a[144:147], v[88:91], v[136:139]
    v_mfma_f32_16x16x32_bf16 v[144:147], a[128:131], v[64:67], v[144:147]
    s_waitcnt lgkmcnt(6)
    ds_read_b64_tr_b16 v[88:89], v11 offset:18432
    ds_read_b64_tr_b16 v[90:91], v11 offset:18944
    v_mfma_f32_16x16x32_bf16 v[144:147], a[136:139], v[68:71], v[144:147]
    buffer_load_dwordx4 v36, s[24:27], s69 offen offset:1024 lds
    v_mfma_f32_16x16x32_bf16 v[148:151], a[140:143], v[68:71], v[148:151]
    s_waitcnt lgkmcnt(6)
    ds_read_b64_tr_b16 v[92:93], v11 offset:26624
    ds_read_b64_tr_b16 v[94:95], v11 offset:27136
    v_mfma_f32_16x16x32_bf16 v[148:151], a[132:135], v[64:67], v[148:151]
    s_barrier
    v_cvt_pk_bf16_f32 v192, v128, v129
    v_mfma_f32_16x16x32_bf16 v[156:159], a[132:135], v[72:75], v[156:159]
    s_waitcnt lgkmcnt(6)
    ds_read_b64_tr_b16 v[64:65], v16 offset:0
    ds_read_b64_tr_b16 v[66:67], v16 offset:512
    v_mfma_f32_16x16x32_bf16 v[156:159], a[140:143], v[76:79], v[156:159]
    buffer_load_dwordx4 v37, s[24:27], s69 offen offset:2048 lds
    v_mfma_f32_16x16x32_bf16 v[152:155], a[136:139], v[76:79], v[152:155]
    s_waitcnt lgkmcnt(6)
    ds_read_b64_tr_b16 v[68:69], v16 offset:8192
L_pad9:
    s_cmp_eq_u32 s92, 1
    s_cbranch_scc1 L_main
    ds_read_b64_tr_b16 v[70:71], v16 offset:8704
    v_mfma_f32_16x16x32_bf16 v[152:155], a[128:131], v[72:75], v[152:155]
    v_cvt_pk_bf16_f32 v193, v130, v131
    v_cvt_pk_bf16_f32 v194, v132, v133
    v_mfma_f32_16x16x32_bf16 v[144:147], a[144:147], v[80:83], v[144:147]
    s_waitcnt lgkmcnt(6)
    ds_read_b64_tr_b16 v[72:73], v17 offset:0
    ds_read_b64_tr_b16 v[74:75], v17 offset:512
    v_mfma_f32_16x16x32_bf16 v[144:147], a[152:155], v[84:87], v[144:147]
    buffer_load_dwordx4 v38, s[24:27], s69 offen offset:3072 lds
    v_mfma_f32_16x16x32_bf16 v[148:151], a[156:159], v[84:87], v[148:151]
    s_waitcnt lgkmcnt(6)
    ds_read_b64_tr_b16 v[76:77], v17 offset:8192
    ds_read_b64_tr_b16 v[78:79], v17 offset:8704
    v_mfma_f32_16x16x32_bf16 v[148:151], a[148:151], v[80:83], v[148:151]
    s_add_u32 s69, s69, 40960
    v_cvt_pk_bf16_f32 v195, v134, v135
    v_cvt_pk_bf16_f32 v196, v136, v137
    v_mfma_f32_16x16x32_bf16 v[156:159], a[148:151], v[88:91], v[156:159]
    s_waitcnt lgkmcnt(6)
    ds_read_b64_tr_b16 v[80:81], v18 offset:0
    ds_read_b64_tr_b16 v[82:83], v18 offset:512
    v_mfma_f32_16x16x32_bf16 v[156:159], a[156:159], v[92:95], v[156:159]
    buffer_store_dwordx4 v[192:195], v30, s[20:23], s49 offen sc1
    v_mfma_f32_16x16x32_bf16 v[152:155], a[152:155], v[92:95], v[152:155]
    s_waitcnt lgkmcnt(6)
    ds_read_b64_tr_b16 v[84:85], v18 offset:8192
    ds_read_b64_tr_b16 v[86:87], v18 offset:8704
    v_mfma_f32_16x16x32_bf16 v[152:155], a[144:147], v[88:91], v[152:155]
    v_cvt_pk_bf16_f32 v197, v138, v139
    v_cvt_pk_bf16_f32 v198, v140, v141
    s_branch L_partb_10

L_spin_15:
    s_mov_b32 s76, 400000
L_spin_15_l:
    s_sleep 1
    buffer_load_dword v56, v55, s[20:23], 0 offen offset:128 sc1
    s_waitcnt vmcnt(0)
    v_cmp_ne_u32 vcc, 1, v56
    s_sub_u32 s76, s76, 1
    s_cbranch_scc1 L_ok_16
    s_cbranch_vccnz L_spin_15_l
    s_branch L_ok_16
L_spin_31:
    s_mov_b32 s76, 400000
L_spin_31_l:
    s_sleep 1
    buffer_load_dword v56, v55, s[20:23], 0 offen offset:256 sc1
    s_waitcnt vmcnt(0)
    v_cmp_ne_u32 vcc, 1, v56
    s_sub_u32 s76, s76, 1
    s_cbranch_scc1 L_ok_32
    s_cbranch_vccnz L_spin_31_l
    s_branch L_ok_32
L_spin_36:
    s_mov_b32 s76, 400000
L_spin_36_l:
    s_sleep 1
    buffer_load_dword v56, v63, s[36:39], 0 offen sc1
    s_waitcnt vmcnt(0)
    v_cmp_eq_u32 vcc, 0, v56
    s_sub_u32 s76, s76, 1
    s_cbranch_scc1 L_ok_37
    s_cbranch_vccnz L_spin_36_l
    s_branch L_ok_37
L_spin_38:
    s_mov_b32 s76, 400000
L_spin_38_l:
    s_sleep 1
    buffer_load_dword v56, v54, s[20:23], 0 offen offset:0 sc1
    s_waitcnt vmcnt(0)
    v_cmp_ne_u32 vcc, 1, v56
    s_sub_u32 s76, s76, 1
    s_cbranch_scc1 L_ok_39
    s_cbranch_vccnz L_spin_38_l
    s_branch L_ok_39
L_hexit_4:
    s_waitcnt vmcnt(0)
    s_barrier
    buffer_store_dword v53, v51, s[20:23], 0 offen offset:256 sc1
    s_endpgm
L_helper_rest:
    v_mov_b32 v88, v2
    s_mov_b32 s47, s3
    v_cmp_eq_u32 vcc, 0, v56
    s_nop 0
    s_cbranch_vccnz L_spin_36
L_ok_37:
    v_cmp_eq_u32 vcc, 3, v56
    s_nop 0
    s_bcnt1_i32_b64 s76, vcc
    v_cmp_eq_u32 vcc, 5, v56
    s_nop 0
    s_bcnt1_i32_b64 s77, vcc
    s_cmp_lt_u32 s76, s77
    s_cselect_b32 s3, 0x200000, 0
    s_add_u32 s20, s20, s3
    s_addc_u32 s21, s21, 0
    s_mov_b32 s48, s3
    s_mov_b32 s3, s47
    s_mov_b32 s45, 0
    buffer_load_dwordx4 v[84:87], v88, s[28:31], s45 offen
    s_lshr_b32 s76, s6, 3
    s_xor_b32 s76, s76, 1
    s_lshl_b32 s76, s76, 13
    s_and_b32 s49, s6, 7
    s_lshl_b32 s49, s49, 22
    s_add_u32 s49, s49, s76
    s_add_u32 s49, s49, 4195840
    s_lshr_b32 s76, s5, 1
    s_mul_i32 s76, s76, 11264
    s_add_u32 s66, s49, s76
    s_mul_i32 s76, s5, 2560
    s_add_u32 s49, s66, s76
    s_lshr_b32 s76, s6, 3
    s_lshl_b32 s76, s76, 13
    s_and_b32 s68, s6, 7
    s_lshl_b32 s68, s68, 22
    s_add_u32 s68, s68, s76
    s_add_u32 s68, s68, 2097152
    s_lshl_b32 s76, s5, 11
    s_add_u32 s68, s68, s76
    s_cmp_ge_u32 s4, 30
    s_cselect_b32 s73, 0x80000000, 0
    s_lshl_b32 s76, s7, 15
    s_add_u32 s66, s66, s76
    s_add_u32 s68, s68, 884736
    s_cmp_ge_u32 s5, 2
    s_mov_b32 s78, 0x80000
    s_cmov_b32 s78, 0x100000
    s_mov_b32 s80, 0x1400
    s_cmov_b32 s80, 0x1410
    s_mov_b32 s81, 0x0
    s_cmov_b32 s81, 0x8000
    s_and_b32 s82, s5, 1
    s_add_u32 s78, s78, s76
    s_lshl_b32 s76, s82, 14
    s_mov_b32 s45, 16384
    buffer_load_dwordx4 v[84:87], v88, s[28:31], s45 offen
    s_add_u32 s78, s78, s76
    s_mul_i32 s83, s6, 86
    s_lshr_b32 s83, s83, 8
    s_mul_i32 s83, s83, 3
    s_sub_u32 s83, s6, s83
    s_sub_u32 s79, s6, s83
    s_lshr_b32 s76, s79, 3
    s_xor_b32 s76, s76, 1
    s_lshl_b32 s76, s76, 13
    s_and_b32 s79, s79, 7
    s_lshl_b32 s79, s79, 22
    s_add_u32 s79, s79, s76
    s_add_u32 s79, s79, 4195840
    s_add_u32 s58, s79, s78
    s_cmp_lt_u32 s6, s83
    s_cmov_b32 s58, 0x80000000
    s_lshl_b32 s79, s83, 1
    s_sub_u32 s79, s82, s79
    s_add_u32 s79, s79, 4
    s_mul_i32 s79, s79, s80
    s_add_u32 s61, s79, s81
    s_sub_u32 s83, s83, 1
    s_cmov_b32 s83, 2
    s_sub_u32 s79, s6, s83
    s_lshr_b32 s76, s79, 3
    s_xor_b32 s76, s76, 1
    s_lshl_b32 s76, s76, 13
    s_and_b32 s79, s79, 7
    s_lshl_b32 s79, s79, 22
    s_add_u32 s79, s79, s76
    s_mov_b32 s45, 32768
    buffer_load_dwordx4 v[84:87], v88, s[28:31], s45 offen
    s_add_u32 s79, s79, 4195840
    s_add_u32 s59, s79, s78
    s_cmp_lt_u32 s6, s83
    s_cmov_b32 s59, 0x80000000
    s_lshl_b32 s79, s83, 1
    s_sub_u32 s79, s82, s79
    s_add_u32 s79, s79, 4
    s_mul_i32 s79, s79, s80
    s_add_u32 s62, s79, s81
    s_sub_u32 s83, s83, 1
    s_cmov_b32 s83, 2
    s_sub_u32 s79, s6, s83
    s_lshr_b32 s76, s79, 3
    s_xor_b32 s76, s76, 1
    s_lshl_b32 s76, s76, 13
    s_and_b32 s79, s79, 7
    s_lshl_b32 s79, s79, 22
    s_add_u32 s79, s79, s76
    s_add_u32 s79, s79, 4195840
    s_add_u32 s60, s79, s78
    s_cmp_lt_u32 s6, s83
    s_cmov_b32 s60, 0x80000000
    s_lshl_b32 s79, s83, 1
    s_sub_u32 s79, s82, s79
    s_add_u32 s79, s79, 4
    s_mul_i32 s79, s79, s80
    s_add_u32 s63, s79, s81
    s_lshl_b32 s67, s75, 7
    s_add_u32 s67, s67, 1703936
    s_lshr_b32 s78, s3, 1
    s_mul_i32 s78, s78, 30
    s_mov_b32 s45, 49152
    buffer_load_dwordx4 v[84:87], v88, s[28:31], s45 offen
    s_add_u32 s78, s78, s4
    s_mul_i32 s56, s78, 205
    s_lshr_b32 s56, s56, 10
    s_mul_i32 s77, s56, 5
    s_sub_u32 s77, s78, s77
    s_and_b32 s78, s3, 1
    s_mul_i32 s78, s78, 5
    s_add_u32 s57, s78, s77
    s_mul_i32 s76, s5, 14
    s_min_u32 s76, s76, 41
    s_mul_i32 s69, s76, 40960
    s_mul_i32 s70, s5, 204800
    s_lshl_b32 s71, s76, 14
    s_add_u32 s72, s71, 16384
    s_lshr_b32 s74, s5, 1
    s_lshl_b32 s74, s74, 30
    v_lshrrev_b32 v2, 3, v1
    v_bfe_u32 v3, v1, 4, 1
    v_lshlrev_b32 v3, 2, v3
    v_and_b32 v4, 7, v1
    v_xor_b32 v3, v3, v4
    v_mul_u32_u24 v5, 1280, v2
    v_lshl_add_u32 v5, v3, 4, v5
    s_lshl_b32 s76, s57, 7
    s_or_b32 s76, s76, s73
    v_add_u32 v35, s76, v5
    v_add_u32 v37, 18432, v35
    v_xor_b32 v2, 4, v2
    s_mov_b32 s45, 65536
    buffer_load_dwordx4 v[84:87], v88, s[28:31], s45 offen
    v_xor_b32 v3, 2, v3
    v_mul_u32_u24 v5, 1280, v2
    v_lshl_add_u32 v5, v3, 4, v5
    v_add_u32 v5, s76, v5
    v_xor_b32 v6, 32, v35
    v_add_u32 v36, 9216, v5
    v_add_u32 v39, 9216, v6
    v_add_u32 v38, 27648, v5
    v_add_u32 v40, 27648, v6
    v_lshrrev_b32 v2, 4, v1
    v_bfe_u32 v3, v1, 2, 2
    v_lshl_add_u32 v5, v2, 3, v3
    v_lshlrev_b32 v5, 7, v5
    v_bfe_u32 v6, v1, 3, 1
    v_lshl_add_u32 v5, v6, 6, v5
    v_and_b32 v6, 3, v1
    v_lshl_add_u32 v5, v6, 3, v5
    v_bfe_u32 v6, v1, 4, 1
    v_lshl_add_u32 v5, v6, 5, v5
    s_add_u32 s76, s44, 0x10000
    v_add_u32 v41, s76, v5
    v_xor_b32 v42, 32, v41
    v_xor_b32 v43, 64, v41
    v_xor_b32 v44, 96, v41
    v_add_u32 v45, 0x10000, v41
    v_add_u32 v46, 0x10000, v42
    v_add_u32 v241, 0x10000, v43
    v_add_u32 v242, 0x10000, v44
    s_mov_b32 s45, 81920
    buffer_load_dwordx4 v[84:87], v88, s[28:31], s45 offen
    v_lshlrev_b32 v4, 4, v4
    v_lshl_add_u32 v6, v2, 7, v4
    v_bfe_u32 v5, v1, 3, 1
    s_mul_i32 s77, s56, 11
    s_lshr_b32 s80, s77, 4
    s_lshr_b32 s76, s80, 3
    s_lshl_b32 s76, s76, 13
    s_and_b32 s78, s80, 7
    s_lshl_b32 s78, s78, 22
    s_add_u32 s78, s78, s76
    s_add_u32 s78, s78, 2097152
    s_or_b32 s78, s78, s73
    s_add_u32 s80, s80, 1
    s_lshr_b32 s76, s80, 3
    s_lshl_b32 s76, s76, 13
    s_and_b32 s79, s80, 7
    s_lshl_b32 s79, s79, 22
    s_add_u32 s79, s79, s76
    s_add_u32 s79, s79, 2097152
    s_sub_u32 s79, s79, 8192
    s_or_b32 s79, s79, s73
    s_cmp_ge_u32 s80, 16
    s_cmov_b32 s79, 0x80000000
    s_and_b32 s76, s77, 15
    v_add_u32 v3, s76, v5
    v_lshl_add_u32 v6, v3, 9, v6
    v_add_u32 v7, s79, v6
    v_add_u32 v6, s78, v6
    v_cmp_le_u32 vcc, 16, v3
    s_mov_b32 s45, 98304
    buffer_load_dwordx4 v[84:87], v88, s[28:31], s45 offen
    v_cndmask_b32 v48, v6, v7, vcc
    v_cmp_le_u32 vcc, 14, v3
    s_nop 1
    v_cndmask_b32 v49, v6, v7, vcc
    v_cmp_le_u32 vcc, 12, v3
    s_nop 1
    v_cndmask_b32 v50, v6, v7, vcc
    v_cmp_le_u32 vcc, 10, v3
    s_nop 1
    v_cndmask_b32 v52, v6, v7, vcc
    v_cmp_le_u32 vcc, 8, v3
    v_add_u32 v6, 4096, v6
    v_add_u32 v7, 4096, v7
    v_cndmask_b32 v222, v6, v7, vcc
    v_cmp_le_u32 vcc, 6, v3
    s_nop 1
    v_cndmask_b32 v223, v6, v7, vcc
    v_lshlrev_b32 v5, 31, v5
    v_or_b32 v223, v5, v223
    v_lshrrev_b32 v2, 5, v1
    v_bfe_u32 v5, v1, 3, 2
    v_lshl_add_u32 v6, v5, 9, v4
    s_mul_i32 s76, s7, 5
    v_add3_u32 v3, v2, s76, 0
    v_and_b32 v7, 3, v3
    v_lshl_add_u32 v7, v7, 7, v6
    v_lshrrev_b32 v3, 2, v3
    v_lshl_add_u32 v57, v3, 14, v7
    v_add3_u32 v3, v2, s76, 3
    v_and_b32 v7, 3, v3
    v_lshl_add_u32 v7, v7, 7, v6
    v_lshrrev_b32 v3, 2, v3
    v_lshl_add_u32 v59, v3, 14, v7
    s_mov_b32 s45, 114688
    buffer_load_dwordx4 v[84:87], v88, s[28:31], s45 offen
    v_add3_u32 v3, v2, s76, 2
    v_and_b32 v7, 3, v3
    v_lshl_add_u32 v7, v7, 7, v6
    v_lshrrev_b32 v3, 2, v3
    v_lshl_add_u32 v60, v3, 14, v7
    v_mov_b32 v7, 0x80000000
    v_mul_u32_u24 v6, 640, v5
    s_mul_i32 s78, s5, 2560
    v_add3_u32 v6, v6, v4, s78
    v_lshl_add_u32 v220, v2, 7, v6
    v_lshl_add_u32 v221, v2, 3, v6
    v_cmp_eq_u32 vcc, 0, v0
    s_lshr_b32 s76, s6, 3
    s_and_b32 s78, s6, 7
    s_lshl_b32 s78, s78, 1
    s_sub_u32 s78, s78, s76
    s_lshl_b32 s78, s78, 13
    s_add_u32 s78, s78, 1581056
    s_mul_i32 s76, s7, 384
    s_add_u32 s76, s76, s78
    v_mov_b32 v4, s76
    v_cndmask_b32 v51, v7, v4, vcc
    v_mov_b32 v53, 1
    s_min_u32 s78, s5, 2
    s_sub_u32 s78, s6, s78
    s_max_i32 s78, s78, 0
    s_lshr_b32 s76, s78, 3
    s_and_b32 s78, s78, 7
    s_mov_b32 s45, 131072
    buffer_load_dwordx4 v[84:87], v88, s[28:31], s45 offen
    s_lshl_b32 s78, s78, 1
    s_sub_u32 s78, s78, s76
    s_lshl_b32 s78, s78, 13
    s_add_u32 s78, s78, 1581056
    s_cmp_eq_u32 s5, 3
    s_cselect_b32 s76, 0, 384
    v_lshrrev_b32 v4, 2, v1
    v_mul_u32_u24 v4, s76, v4
    v_add_u32 v54, s78, v4
    s_bitcmp1_b32 s7, 0
    s_cselect_b32 s98, 0, -1
    s_cselect_b32 s99, -1, 0
    s_lshr_b32 s76, s5, 1
    s_mul_i32 s76, s76, 10
    s_add_u32 s76, s76, s77
    s_lshr_b32 s76, s76, 4
    s_min_u32 s76, s76, 15
    s_lshr_b32 s78, s76, 3
    s_and_b32 s76, s76, 7
    s_lshl_b32 s76, s76, 1
    s_sub_u32 s76, s76, s78
    s_lshl_b32 s76, s76, 13
    s_add_u32 s76, s76, 1581056
    s_and_b32 s78, s5, 1
    s_mul_i32 s78, s78, 3072
    s_add_u32 s76, s76, s78
    v_lshrrev_b32 v4, 3, v1
    v_mul_u32_u24 v4, 384, v4
    v_add_u32 v55, s76, v4
    v_and_b32 v63, 60, v1
    v_subrev_u32 v24, 0x10000, v41
    s_mov_b32 s45, 147456
    buffer_load_dwordx4 v[84:87], v88, s[28:31], s45 offen
    v_subrev_u32 v25, 0x10000, v42
    v_subrev_u32 v26, 0x10000, v43
    v_subrev_u32 v27, 0x10000, v44
    v_lshlrev_b32 v236, 4, v1
    v_add_u32 v237, 4096, v236
    v_and_b32 v3, 31, v1
    v_lshlrev_b32 v61, 2, v3
    v_min_u32 v6, 5, v1
    v_lshrrev_b32 v4, 1, v6
    v_add_u32 v4, s6, v4
    v_cmp_le_u32 s[78:79], 2, v4
    v_mov_b32 v5, 0x3f803f80
    v_mul_u32_u24 v62, 5136, v6
    v_cndmask_b32 v232, 0, v5, s[78:79]
    v_cndmask_b32 v233, 0, v5, s[78:79]
    v_cndmask_b32 v234, 0, v5, s[78:79]
    v_cndmask_b32 v235, 0, v5, s[78:79]
    v_lshrrev_b32 v2, 5, v1
    v_and_b32 v3, 31, v1
    v_cmp_gt_u32 s[78:79], 16, v3
    v_and_b32 v6, 3, v1
    v_bfe_u32 v7, v1, 2, 1
    v_lshl_add_u32 v7, v7, 3, v6
    v_bfe_u32 v4, v1, 3, 1
    v_lshl_add_u32 v7, v4, 2, v7
    v_add_u32 v5, 16, v6
    v_cndmask_b32 v7, v5, v7, s[78:79]
    v_cndmask_b32 v4, 4, 24, s[78:79]
    s_mov_b32 s45, 163840
    buffer_load_dwordx4 v[84:87], v88, s[28:31], s45 offen
    v_mul_u32_u24 v5, 640, v2
    v_cmp_gt_u32 s[78:79], 24, v3
    v_lshl_add_u32 v6, v7, 4, v5
    v_lshl_add_u32 v7, v4, 4, v6
    v_mov_b32 v5, 1280
    v_cndmask_b32 v5, 0, v5, s[78:79]
    s_add_u32 s80, s5, 0
    s_lshr_b32 s81, s80, 1
    s_mul_i32 s81, s81, 5136
    s_and_b32 s80, s80, 1
    s_mul_i32 s80, s80, 2560
    s_add_u32 s80, s80, s81
    s_add_u32 s81, s81, 5120
    v_mov_b32 v0, s81
    v_add_u32 v4, s80, v6
    v_cndmask_b32 v224, v0, v4, s[78:79]
    v_add_u32 v225, v5, v224
    v_add_u32 v4, s80, v7
    v_cndmask_b32 v228, v0, v4, s[78:79]
    v_add_u32 v229, v5, v228
    s_add_u32 s80, s5, 1
    s_lshr_b32 s81, s80, 1
    s_mul_i32 s81, s81, 5136
    s_and_b32 s80, s80, 1
    s_mul_i32 s80, s80, 2560
    s_add_u32 s80, s80, s81
    s_add_u32 s81, s81, 5120
    v_mov_b32 v0, s81
    s_mov_b32 s45, 180224
    buffer_load_dwordx4 v[84:87], v88, s[28:31], s45 offen
    v_add_u32 v4, s80, v6
    v_cndmask_b32 v226, v0, v4, s[78:79]
    v_add_u32 v227, v5, v226
    v_add_u32 v4, s80, v7
    v_cndmask_b32 v230, v0, v4, s[78:79]
    v_add_u32 v231, v5, v230
    v_lshlrev_b32 v4, 2, v2
    v_sub_u32 v4, v3, v4
    v_mov_b32 v5, 0xf1800000
    v_cmp_le_i32 s[78:79], 0, v4
    v_cmp_le_i32 s[80:81], 1, v4
    s_nop 0
    v_cndmask_b32 v160, 0, v5, s[78:79]
    v_cndmask_b32 v176, v5, 0, s[78:79]
    v_cmp_le_i32 s[78:79], 2, v4
    v_cndmask_b32 v161, 0, v5, s[80:81]
    v_cndmask_b32 v177, v5, 0, s[80:81]
    v_cmp_le_i32 s[80:81], 3, v4
    v_cndmask_b32 v162, 0, v5, s[78:79]
    v_cndmask_b32 v178, v5, 0, s[78:79]
    v_cmp_le_i32 s[78:79], 8, v4
    v_cndmask_b32 v163, 0, v5, s[80:81]
    v_cndmask_b32 v179, v5, 0, s[80:81]
    v_cmp_le_i32 s[80:81], 9, v4
    v_cndmask_b32 v164, 0, v5, s[78:79]
    v_cndmask_b32 v180, v5, 0, s[78:79]
    v_cmp_le_i32 s[78:79], 10, v4
    v_cndmask_b32 v165, 0, v5, s[80:81]
    v_cndmask_b32 v181, v5, 0, s[80:81]
    s_mov_b32 s45, 196608
    buffer_load_dwordx4 v[84:87], v88, s[28:31], s45 offen
    v_cmp_le_i32 s[80:81], 11, v4
    v_cndmask_b32 v166, 0, v5, s[78:79]
    v_cndmask_b32 v182, v5, 0, s[78:79]
    v_cmp_le_i32 s[78:79], 16, v4
    v_cndmask_b32 v167, 0, v5, s[80:81]
    v_cndmask_b32 v183, v5, 0, s[80:81]
    v_cmp_le_i32 s[80:81], 17, v4
    v_cndmask_b32 v168, 0, v5, s[78:79]
    v_cndmask_b32 v184, v5, 0, s[78:79]
    v_cmp_le_i32 s[78:79], 18, v4
    v_cndmask_b32 v169, 0, v5, s[80:81]
    v_cndmask_b32 v185, v5, 0, s[80:81]
    v_cmp_le_i32 s[80:81], 19, v4
    v_cndmask_b32 v170, 0, v5, s[78:79]
    v_cndmask_b32 v186, v5, 0, s[78:79]
    v_cmp_le_i32 s[78:79], 24, v4
    v_cndmask_b32 v171, 0, v5, s[80:81]
    v_cndmask_b32 v187, v5, 0, s[80:81]
    v_cmp_le_i32 s[80:81], 25, v4
    v_cndmask_b32 v172, 0, v5, s[78:79]
    v_cndmask_b32 v188, v5, 0, s[78:79]
    v_cmp_le_i32 s[78:79], 26, v4
    v_cndmask_b32 v173, 0, v5, s[80:81]
    v_cndmask_b32 v189, v5, 0, s[80:81]
    v_cmp_le_i32 s[80:81], 27, v4
    v_cndmask_b32 v174, 0, v5, s[78:79]
    v_cndmask_b32 v190, v5, 0, s[78:79]
    v_cndmask_b32 v175, 0, v5, s[80:81]
    v_cndmask_b32 v191, v5, 0, s[80:81]
    s_mov_b32 s3, s48
    buffer_load_dword v56, v54, s[20:23], 0 offen offset:0 sc1
    s_waitcnt vmcnt(0)
    v_cmp_ne_u32 vcc, 1, v56
    s_nop 0
    s_cbranch_vccnz L_spin_38
L_ok_39:
    s_barrier
    ds_write_b128 v62, v[232:235] offset:37888
    buffer_load_dwordx4 v[208:211], v220, s[20:23], s66 offen sc1
    buffer_load_dwordx2 v[216:217], v221, s[20:23], s66 offen offset:256 sc1
    buffer_load_dwordx4 v[212:215], v220, s[20:23], s66 offen offset:384 sc1
    buffer_load_dword v58, v61, s[20:23], s67 offen sc1
    s_add_u32 m0, s61, 0
    s_nop 0
    buffer_load_dwordx4 v236, s[20:23], s58 offen offset:0 sc1 lds
    buffer_load_dwordx4 v236, s[20:23], s58 offen offset:1024 sc1 lds
    buffer_load_dwordx4 v236, s[20:23], s58 offen offset:2048 sc1 lds
    buffer_load_dwordx4 v236, s[20:23], s58 offen offset:3072 sc1 lds
    s_add_u32 m0, s61, 4096
    s_nop 0
    buffer_load_dwordx4 v237, s[20:23], s58 offen offset:0 sc1 lds
    s_add_u32 m0, s62, 0
    s_nop 0
    buffer_load_dwordx4 v236, s[20:23], s59 offen offset:0 sc1 lds
    buffer_load_dwordx4 v236, s[20:23], s59 offen offset:1024 sc1 lds
    buffer_load_dwordx4 v236, s[20:23], s59 offen offset:2048 sc1 lds
    buffer_load_dwordx4 v236, s[20:23], s59 offen offset:3072 sc1 lds
    s_add_u32 m0, s62, 4096
    s_nop 0
    buffer_load_dwordx4 v237, s[20:23], s59 offen offset:0 sc1 lds
    s_add_u32 m0, s63, 0
    s_nop 0
    buffer_load_dwordx4 v236, s[20:23], s60 offen offset:0 sc1 lds
    buffer_load_dwordx4 v236, s[20:23], s60 offen offset:1024 sc1 lds
    buffer_load_dwordx4 v236, s[20:23], s60 offen offset:2048 sc1 lds
    buffer_load_dwordx4 v236, s[20:23], s60 offen offset:3072 sc1 lds
    s_add_u32 m0, s63, 4096
    s_nop 0
    buffer_load_dwordx4 v237, s[20:23], s60 offen offset:0 sc1 lds
    s_waitcnt vmcnt(18)
    v_lshlrev_b32 v252, 16, v208
    v_and_b32 v253, 0xffff0000, v208
    v_mul_f32 v252, 0x3ea52b5c, v252
    v_mul_f32 v253, 0x3ea52b5c, v253
    v_cvt_pk_bf16_f32 v208, v252, v253
    v_lshlrev_b32 v252, 16, v209
    v_and_b32 v253, 0xffff0000, v209
    v_mul_f32 v252, 0x3ea52b5c, v252
    v_mul_f32 v253, 0x3ea52b5c, v253
    v_cvt_pk_bf16_f32 v209, v252, v253
    v_lshlrev_b32 v252, 16, v210
    v_and_b32 v253, 0xffff0000, v210
    v_mul_f32 v252, 0x3ea52b5c, v252
    v_mul_f32 v253, 0x3ea52b5c, v253
    v_cvt_pk_bf16_f32 v210, v252, v253
    v_lshlrev_b32 v252, 16, v211
    v_and_b32 v253, 0xffff0000, v211
    v_mul_f32 v252, 0x3ea52b5c, v252
    v_mul_f32 v253, 0x3ea52b5c, v253
    v_cvt_pk_bf16_f32 v211, v252, v253
    s_waitcnt vmcnt(16)
    v_lshlrev_b32 v252, 16, v212
    v_and_b32 v253, 0xffff0000, v212
    v_mul_f32 v252, 0x3ea52b5c, v252
    v_mul_f32 v253, 0x3ea52b5c, v253
    v_cvt_pk_bf16_f32 v212, v252, v253
    v_lshlrev_b32 v252, 16, v213
    v_and_b32 v253, 0xffff0000, v213
    v_mul_f32 v252, 0x3ea52b5c, v252
    v_mul_f32 v253, 0x3ea52b5c, v253
    v_cvt_pk_bf16_f32 v213, v252, v253
    v_lshlrev_b32 v252, 16, v214
    v_and_b32 v253, 0xffff0000, v214
    v_mul_f32 v252, 0x3ea52b5c, v252
    v_mul_f32 v253, 0x3ea52b5c, v253
    v_cvt_pk_bf16_f32 v214, v252, v253
    v_lshlrev_b32 v252, 16, v215
    v_and_b32 v253, 0xffff0000, v215
    v_mul_f32 v252, 0x3ea52b5c, v252
    v_mul_f32 v253, 0x3ea52b5c, v253
    v_cvt_pk_bf16_f32 v215, v252, v253
    v_lshlrev_b32 v252, 16, v216
    v_and_b32 v253, 0xffff0000, v216
    v_mul_f32 v252, 0x3ea52b5c, v252
    v_mul_f32 v253, 0x3ea52b5c, v253
    v_cvt_pk_bf16_f32 v216, v252, v253
    v_lshlrev_b32 v252, 16, v217
    v_and_b32 v253, 0xffff0000, v217
    v_mul_f32 v252, 0x3ea52b5c, v252
    v_mul_f32 v253, 0x3ea52b5c, v253
    v_cvt_pk_bf16_f32 v217, v252, v253
    v_cndmask_b32 v218, v216, 0, s[98:99]
    v_cndmask_b32 v216, 0, v216, s[98:99]
    v_cndmask_b32 v219, v217, 0, s[98:99]
    v_cndmask_b32 v217, 0, v217, s[98:99]
    s_waitcnt vmcnt(0) lgkmcnt(0)
    s_barrier
    ds_read_b128 v[112:115], v220 offset:0
    ds_read_b64 v[124:125], v221 offset:256
    ds_read_b128 v[116:119], v224 offset:32768
    s_waitcnt lgkmcnt(2)
    v_mfma_f32_32x32x16_bf16 v[64:79], v[112:115], v[208:211], v[160:175]
    ds_read_b128 v[112:115], v220 offset:384
    s_waitcnt lgkmcnt(2)
    v_mfma_f32_32x32x8_bf16 v[64:79], v[124:125], v[216:217], v[64:79]
    s_waitcnt lgkmcnt(0)
    v_mfma_f32_32x32x16_bf16 v[80:95], v[112:115], v[212:215], v[160:175]
    ds_read_b128 v[112:115], v220 offset:2560
    s_nop 8
    v_exp_f32 v96, v64
    v_exp_f32 v97, v65
    v_exp_f32 v98, v66
    v_exp_f32 v99, v67
    ds_read_b128 v[120:123], v225 offset:32768
    v_cvt_pk_bf16_f32 v104, v96, v97
    v_cvt_pk_bf16_f32 v105, v98, v99
    v_exp_f32 v100, v68
    v_exp_f32 v101, v69
    v_exp_f32 v102, v70
    v_exp_f32 v103, v71
    v_mfma_f32_32x32x8_bf16 v[80:95], v[124:125], v[218:219], v[80:95]
    ds_read_b64 v[124:125], v221 offset:2816
    v_cvt_pk_bf16_f32 v106, v100, v101
    v_cvt_pk_bf16_f32 v107, v102, v103
    v_exp_f32 v96, v72
    v_exp_f32 v97, v73
    v_exp_f32 v98, v74
    v_exp_f32 v99, v75
    v_mfma_f32_32x32x16_bf16 v[128:143], v[116:119], v[104:107], 0
    s_waitcnt lgkmcnt(2)
    ds_read_b128 v[116:119], v228 offset:32768
    v_cvt_pk_bf16_f32 v108, v96, v97
    v_cvt_pk_bf16_f32 v109, v98, v99
    v_exp_f32 v100, v76
    v_exp_f32 v101, v77
    v_exp_f32 v102, v78
    v_exp_f32 v103, v79
    v_mfma_f32_32x32x16_bf16 v[64:79], v[112:115], v[208:211], 0
    s_waitcnt lgkmcnt(2)
    ds_read_b128 v[112:115], v220 offset:2944
    v_cvt_pk_bf16_f32 v110, v100, v101
    v_cvt_pk_bf16_f32 v111, v102, v103
    v_exp_f32 v96, v80
    v_exp_f32 v97, v81
    v_exp_f32 v98, v82
    v_exp_f32 v99, v83
    v_mfma_f32_32x32x16_bf16 v[128:143], v[120:123], v[108:111], v[128:143]
    s_waitcnt lgkmcnt(2)
    ds_read_b128 v[120:123], v229 offset:32768
    v_cvt_pk_bf16_f32 v104, v96, v97
    v_cvt_pk_bf16_f32 v105, v98, v99
    v_exp_f32 v100, v84
    v_exp_f32 v101, v85
    v_exp_f32 v102, v86
    v_exp_f32 v103, v87
    v_mfma_f32_32x32x8_bf16 v[64:79], v[124:125], v[216:217], v[64:79]
    s_waitcnt lgkmcnt(2)
    v_cvt_pk_bf16_f32 v106, v100, v101
    v_cvt_pk_bf16_f32 v107, v102, v103
    v_exp_f32 v96, v88
    v_exp_f32 v97, v89
    v_exp_f32 v98, v90
    v_exp_f32 v99, v91
    v_mfma_f32_32x32x16_bf16 v[144:159], v[116:119], v[104:107], 0
    s_waitcnt lgkmcnt(1)
    ds_read_b128 v[116:119], v226 offset:32768
    v_cvt_pk_bf16_f32 v108, v96, v97
    v_cvt_pk_bf16_f32 v109, v98, v99
    v_exp_f32 v100, v92
    v_exp_f32 v101, v93
    v_exp_f32 v102, v94
    v_exp_f32 v103, v95
    v_mfma_f32_32x32x16_bf16 v[80:95], v[112:115], v[212:215], 0
    s_waitcnt lgkmcnt(1)
    ds_read_b128 v[112:115], v220 offset:5120
    v_cvt_pk_bf16_f32 v110, v100, v101
    v_cvt_pk_bf16_f32 v111, v102, v103
    v_exp_f32 v96, v64
    v_exp_f32 v97, v65
    v_exp_f32 v98, v66
    v_exp_f32 v99, v67
    v_mfma_f32_32x32x16_bf16 v[144:159], v[120:123], v[108:111], v[144:159]
    ds_read_b128 v[120:123], v227 offset:32768
    v_cvt_pk_bf16_f32 v104, v96, v97
    v_cvt_pk_bf16_f32 v105, v98, v99
    v_exp_f32 v100, v68
    v_exp_f32 v101, v69
    v_exp_f32 v102, v70
    v_exp_f32 v103, v71
    v_mfma_f32_32x32x8_bf16 v[80:95], v[124:125], v[218:219], v[80:95]
    s_waitcnt lgkmcnt(2)
    ds_read_b64 v[124:125], v221 offset:5376
    v_cvt_pk_bf16_f32 v106, v100, v101
    v_cvt_pk_bf16_f32 v107, v102, v103
    v_exp_f32 v96, v72
    v_exp_f32 v97, v73
    v_exp_f32 v98, v74
    v_exp_f32 v99, v75
    v_mfma_f32_32x32x16_bf16 v[128:143], v[116:119], v[104:107], v[128:143]
    s_waitcnt lgkmcnt(2)
    ds_read_b128 v[116:119], v230 offset:32768
    v_cvt_pk_bf16_f32 v108, v96, v97
    v_cvt_pk_bf16_f32 v109, v98, v99
    v_exp_f32 v100, v76
    v_exp_f32 v101, v77
    v_exp_f32 v102, v78
    v_exp_f32 v103, v79
    v_mfma_f32_32x32x16_bf16 v[64:79], v[112:115], v[208:211], 0
    s_waitcnt lgkmcnt(2)
    ds_read_b128 v[112:115], v220 offset:5504
    v_cvt_pk_bf16_f32 v110, v100, v101
    v_cvt_pk_bf16_f32 v111, v102, v103
    v_exp_f32 v96, v80
    v_exp_f32 v97, v81
    v_exp_f32 v98, v82
    v_exp_f32 v99, v83
    v_mfma_f32_32x32x16_bf16 v[128:143], v[120:123], v[108:111], v[128:143]
    s_waitcnt lgkmcnt(2)
    ds_read_b128 v[120:123], v231 offset:32768
    v_cvt_pk_bf16_f32 v104, v96, v97
    v_cvt_pk_bf16_f32 v105, v98, v99
    v_exp_f32 v100, v84
    v_exp_f32 v101, v85
    v_exp_f32 v102, v86
    v_exp_f32 v103, v87
    v_mfma_f32_32x32x8_bf16 v[64:79], v[124:125], v[216:217], v[64:79]
    s_waitcnt lgkmcnt(2)
    v_cvt_pk_bf16_f32 v106, v100, v101
    v_cvt_pk_bf16_f32 v107, v102, v103
    v_exp_f32 v96, v88
    v_exp_f32 v97, v89
    v_exp_f32 v98, v90
    v_exp_f32 v99, v91
    v_mfma_f32_32x32x16_bf16 v[144:159], v[116:119], v[104:107], v[144:159]
    s_waitcnt lgkmcnt(1)
    ds_read_b128 v[116:119], v224 offset:37904
    v_cvt_pk_bf16_f32 v108, v96, v97
    v_cvt_pk_bf16_f32 v109, v98, v99
    v_exp_f32 v100, v92
    v_exp_f32 v101, v93
    v_exp_f32 v102, v94
    v_exp_f32 v103, v95
    v_mfma_f32_32x32x16_bf16 v[80:95], v[112:115], v[212:215], 0
    s_waitcnt lgkmcnt(1)
    ds_read_b128 v[112:115], v220 offset:7680
    v_cvt_pk_bf16_f32 v110, v100, v101
    v_cvt_pk_bf16_f32 v111, v102, v103
    v_exp_f32 v96, v64
    v_exp_f32 v97, v65
    v_exp_f32 v98, v66
    v_exp_f32 v99, v67
    v_mfma_f32_32x32x16_bf16 v[144:159], v[120:123], v[108:111], v[144:159]
    ds_read_b128 v[120:123], v225 offset:37904
    v_cvt_pk_bf16_f32 v104, v96, v97
    v_cvt_pk_bf16_f32 v105, v98, v99
    v_exp_f32 v100, v68
    v_exp_f32 v101, v69
    v_exp_f32 v102, v70
    v_exp_f32 v103, v71
    v_mfma_f32_32x32x8_bf16 v[80:95], v[124:125], v[218:219], v[80:95]
    s_waitcnt lgkmcnt(2)
    ds_read_b64 v[124:125], v221 offset:7936
    v_cvt_pk_bf16_f32 v106, v100, v101
    v_cvt_pk_bf16_f32 v107, v102, v103
    v_exp_f32 v96, v72
    v_exp_f32 v97, v73
    v_exp_f32 v98, v74
    v_exp_f32 v99, v75
    v_mfma_f32_32x32x16_bf16 v[128:143], v[116:119], v[104:107], v[128:143]
    s_waitcnt lgkmcnt(2)
    ds_read_b128 v[116:119], v228 offset:37904
    v_cvt_pk_bf16_f32 v108, v96, v97
    v_cvt_pk_bf16_f32 v109, v98, v99
    v_exp_f32 v100, v76
    v_exp_f32 v101, v77
    v_exp_f32 v102, v78
    v_exp_f32 v103, v79
    v_mfma_f32_32x32x16_bf16 v[64:79], v[112:115], v[208:211], 0
    s_waitcnt lgkmcnt(2)
    ds_read_b128 v[112:115], v220 offset:8064
    v_cvt_pk_bf16_f32 v110, v100, v101
    v_cvt_pk_bf16_f32 v111, v102, v103
    v_exp_f32 v96, v80
    v_exp_f32 v97, v81
    v_exp_f32 v98, v82
    v_exp_f32 v99, v83
    v_mfma_f32_32x32x16_bf16 v[128:143], v[120:123], v[108:111], v[128:143]
    s_waitcnt lgkmcnt(2)
    ds_read_b128 v[120:123], v229 offset:37904
    v_cvt_pk_bf16_f32 v104, v96, v97
    v_cvt_pk_bf16_f32 v105, v98, v99
    v_exp_f32 v100, v84
    v_exp_f32 v101, v85
    v_exp_f32 v102, v86
    v_exp_f32 v103, v87
    v_mfma_f32_32x32x8_bf16 v[64:79], v[124:125], v[216:217], v[64:79]
    s_waitcnt lgkmcnt(2)
    v_cvt_pk_bf16_f32 v106, v100, v101
    v_cvt_pk_bf16_f32 v107, v102, v103
    v_exp_f32 v96, v88
    v_exp_f32 v97, v89
    v_exp_f32 v98, v90
    v_exp_f32 v99, v91
    v_mfma_f32_32x32x16_bf16 v[144:159], v[116:119], v[104:107], v[144:159]
    s_waitcnt lgkmcnt(1)
    ds_read_b128 v[116:119], v226 offset:37904
    v_cvt_pk_bf16_f32 v108, v96, v97
    v_cvt_pk_bf16_f32 v109, v98, v99
    v_exp_f32 v100, v92
    v_exp_f32 v101, v93
    v_exp_f32 v102, v94
    v_exp_f32 v103, v95
    v_mfma_f32_32x32x16_bf16 v[80:95], v[112:115], v[212:215], 0
    s_waitcnt lgkmcnt(1)
    ds_read_b128 v[112:115], v220 offset:10240
    v_cvt_pk_bf16_f32 v110, v100, v101
    v_cvt_pk_bf16_f32 v111, v102, v103
    v_exp_f32 v96, v64
    v_exp_f32 v97, v65
    v_exp_f32 v98, v66
    v_exp_f32 v99, v67
    v_mfma_f32_32x32x16_bf16 v[144:159], v[120:123], v[108:111], v[144:159]
    ds_read_b128 v[120:123], v227 offset:37904
    v_cvt_pk_bf16_f32 v104, v96, v97
    v_cvt_pk_bf16_f32 v105, v98, v99
    v_exp_f32 v100, v68
    v_exp_f32 v101, v69
    v_exp_f32 v102, v70
    v_exp_f32 v103, v71
    v_mfma_f32_32x32x8_bf16 v[80:95], v[124:125], v[218:219], v[80:95]
    s_waitcnt lgkmcnt(2)
    ds_read_b64 v[124:125], v221 offset:10496
    v_cvt_pk_bf16_f32 v106, v100, v101
    v_cvt_pk_bf16_f32 v107, v102, v103
    v_exp_f32 v96, v72
    v_exp_f32 v97, v73
    v_exp_f32 v98, v74
    v_exp_f32 v99, v75
    v_mfma_f32_32x32x16_bf16 v[128:143], v[116:119], v[104:107], v[128:143]
    s_waitcnt lgkmcnt(2)
    ds_read_b128 v[116:119], v230 offset:37904
    v_cvt_pk_bf16_f32 v108, v96, v97
    v_cvt_pk_bf16_f32 v109, v98, v99
    v_exp_f32 v100, v76
    v_exp_f32 v101, v77
    v_exp_f32 v102, v78
    v_exp_f32 v103, v79
    v_mfma_f32_32x32x16_bf16 v[64:79], v[112:115], v[208:211], 0
    s_waitcnt lgkmcnt(2)
    ds_read_b128 v[112:115], v220 offset:10624
    v_cvt_pk_bf16_f32 v110, v100, v101
    v_cvt_pk_bf16_f32 v111, v102, v103
    v_exp_f32 v96, v80
    v_exp_f32 v97, v81
    v_exp_f32 v98, v82
    v_exp_f32 v99, v83
    v_mfma_f32_32x32x16_bf16 v[128:143], v[120:123], v[108:111], v[128:143]
    s_waitcnt lgkmcnt(2)
    ds_read_b128 v[120:123], v231 offset:37904
    v_cvt_pk_bf16_f32 v104, v96, v97
    v_cvt_pk_bf16_f32 v105, v98, v99
    v_exp_f32 v100, v84
    v_exp_f32 v101, v85
    v_exp_f32 v102, v86
    v_exp_f32 v103, v87
    v_mfma_f32_32x32x8_bf16 v[64:79], v[124:125], v[216:217], v[64:79]
    s_waitcnt lgkmcnt(2)
    v_cvt_pk_bf16_f32 v106, v100, v101
    v_cvt_pk_bf16_f32 v107, v102, v103
    v_exp_f32 v96, v88
    v_exp_f32 v97, v89
    v_exp_f32 v98, v90
    v_exp_f32 v99, v91
    v_mfma_f32_32x32x16_bf16 v[144:159], v[116:119], v[104:107], v[144:159]
    s_waitcnt lgkmcnt(1)
    ds_read_b128 v[116:119], v224 offset:43040
    v_cvt_pk_bf16_f32 v108, v96, v97
    v_cvt_pk_bf16_f32 v109, v98, v99
    v_exp_f32 v100, v92
    v_exp_f32 v101, v93
    v_exp_f32 v102, v94
    v_exp_f32 v103, v95
    v_mfma_f32_32x32x16_bf16 v[80:95], v[112:115], v[212:215], 0
    s_waitcnt lgkmcnt(1)
    ds_read_b128 v[112:115], v220 offset:12800
    v_cvt_pk_bf16_f32 v110, v100, v101
    v_cvt_pk_bf16_f32 v111, v102, v103
    v_exp_f32 v96, v64
    v_exp_f32 v97, v65
    v_exp_f32 v98, v66
    v_exp_f32 v99, v67
    v_mfma_f32_32x32x16_bf16 v[144:159], v[120:123], v[108:111], v[144:159]
    ds_read_b128 v[120:123], v225 offset:43040
    v_cvt_pk_bf16_f32 v104, v96, v97
    v_cvt_pk_bf16_f32 v105, v98, v99
    v_exp_f32 v100, v68
    v_exp_f32 v101, v69
    v_exp_f32 v102, v70
    v_exp_f32 v103, v71
    v_mfma_f32_32x32x8_bf16 v[80:95], v[124:125], v[218:219], v[80:95]
    s_waitcnt lgkmcnt(2)
    ds_read_b64 v[124:125], v221 offset:13056
    v_cvt_pk_bf16_f32 v106, v100, v101
    v_cvt_pk_bf16_f32 v107, v102, v103
    v_exp_f32 v96, v72
    v_exp_f32 v97, v73
    v_exp_f32 v98, v74
    v_exp_f32 v99, v75
    v_mfma_f32_32x32x16_bf16 v[128:143], v[116:119], v[104:107], v[128:143]
    s_waitcnt lgkmcnt(2)
    ds_read_b128 v[116:119], v228 offset:43040
    v_cvt_pk_bf16_f32 v108, v96, v97
    v_cvt_pk_bf16_f32 v109, v98, v99
    v_exp_f32 v100, v76
    v_exp_f32 v101, v77
    v_exp_f32 v102, v78
    v_exp_f32 v103, v79
    v_mfma_f32_32x32x16_bf16 v[64:79], v[112:115], v[208:211], 0
    s_waitcnt lgkmcnt(2)
    ds_read_b128 v[112:115], v220 offset:13184
    v_cvt_pk_bf16_f32 v110, v100, v101
    v_cvt_pk_bf16_f32 v111, v102, v103
    v_exp_f32 v96, v80
    v_exp_f32 v97, v81
    v_exp_f32 v98, v82
    v_exp_f32 v99, v83
    v_mfma_f32_32x32x16_bf16 v[128:143], v[120:123], v[108:111], v[128:143]
    s_waitcnt lgkmcnt(2)
    ds_read_b128 v[120:123], v229 offset:43040
    v_cvt_pk_bf16_f32 v104, v96, v97
    v_cvt_pk_bf16_f32 v105, v98, v99
    v_exp_f32 v100, v84
    v_exp_f32 v101, v85
    v_exp_f32 v102, v86
    v_exp_f32 v103, v87
    v_mfma_f32_32x32x8_bf16 v[64:79], v[124:125], v[216:217], v[64:79]
    s_waitcnt lgkmcnt(2)
    v_cvt_pk_bf16_f32 v106, v100, v101
    v_cvt_pk_bf16_f32 v107, v102, v103
    v_exp_f32 v96, v88
    v_exp_f32 v97, v89
    v_exp_f32 v98, v90
    v_exp_f32 v99, v91
    v_mfma_f32_32x32x16_bf16 v[144:159], v[116:119], v[104:107], v[144:159]
    s_waitcnt lgkmcnt(1)
    ds_read_b128 v[116:119], v226 offset:43040
    v_cvt_pk_bf16_f32 v108, v96, v97
    v_cvt_pk_bf16_f32 v109, v98, v99
    v_exp_f32 v100, v92
    v_exp_f32 v101, v93
    v_exp_f32 v102, v94
    v_exp_f32 v103, v95
    v_mfma_f32_32x32x16_bf16 v[80:95], v[112:115], v[212:215], 0
    s_waitcnt lgkmcnt(1)
    ds_read_b128 v[112:115], v220 offset:15360
    v_cvt_pk_bf16_f32 v110, v100, v101
    v_cvt_pk_bf16_f32 v111, v102, v103
    v_exp_f32 v96, v64
    v_exp_f32 v97, v65
    v_exp_f32 v98, v66
    v_exp_f32 v99, v67
    v_mfma_f32_32x32x16_bf16 v[144:159], v[120:123], v[108:111], v[144:159]
    ds_read_b128 v[120:123], v227 offset:43040
    v_cvt_pk_bf16_f32 v104, v96, v97
    v_cvt_pk_bf16_f32 v105, v98, v99
    v_exp_f32 v100, v68
    v_exp_f32 v101, v69
    v_exp_f32 v102, v70
    v_exp_f32 v103, v71
    v_mfma_f32_32x32x8_bf16 v[80:95], v[124:125], v[218:219], v[80:95]
    s_waitcnt lgkmcnt(2)
    ds_read_b64 v[124:125], v221 offset:15616
    v_cvt_pk_bf16_f32 v106, v100, v101
    v_cvt_pk_bf16_f32 v107, v102, v103
    v_exp_f32 v96, v72
    v_exp_f32 v97, v73
    v_exp_f32 v98, v74
    v_exp_f32 v99, v75
    v_mfma_f32_32x32x16_bf16 v[128:143], v[116:119], v[104:107], v[128:143]
    s_waitcnt lgkmcnt(2)
    ds_read_b128 v[116:119], v230 offset:43040
    v_cvt_pk_bf16_f32 v108, v96, v97
    v_cvt_pk_bf16_f32 v109, v98, v99
    v_exp_f32 v100, v76
    v_exp_f32 v101, v77
    v_exp_f32 v102, v78
    v_exp_f32 v103, v79
    v_mfma_f32_32x32x16_bf16 v[64:79], v[112:115], v[208:211], 0
    s_waitcnt lgkmcnt(2)
    ds_read_b128 v[112:115], v220 offset:15744
    v_cvt_pk_bf16_f32 v110, v100, v101
    v_cvt_pk_bf16_f32 v111, v102, v103
    v_exp_f32 v96, v80
    v_exp_f32 v97, v81
    v_exp_f32 v98, v82
    v_exp_f32 v99, v83
    v_mfma_f32_32x32x16_bf16 v[128:143], v[120:123], v[108:111], v[128:143]
    s_waitcnt lgkmcnt(2)
    ds_read_b128 v[120:123], v231 offset:43040
    v_cvt_pk_bf16_f32 v104, v96, v97
    v_cvt_pk_bf16_f32 v105, v98, v99
    v_exp_f32 v100, v84
    v_exp_f32 v101, v85
    v_exp_f32 v102, v86
    v_exp_f32 v103, v87
    v_mfma_f32_32x32x8_bf16 v[64:79], v[124:125], v[216:217], v[64:79]
    s_waitcnt lgkmcnt(2)
    v_cvt_pk_bf16_f32 v106, v100, v101
    v_cvt_pk_bf16_f32 v107, v102, v103
    v_exp_f32 v96, v88
    v_exp_f32 v97, v89
    v_exp_f32 v98, v90
    v_exp_f32 v99, v91
    v_mfma_f32_32x32x16_bf16 v[144:159], v[116:119], v[104:107], v[144:159]
    s_waitcnt lgkmcnt(1)
    ds_read_b128 v[116:119], v224 offset:48176
    v_cvt_pk_bf16_f32 v108, v96, v97
    v_cvt_pk_bf16_f32 v109, v98, v99
    v_exp_f32 v100, v92
    v_exp_f32 v101, v93
    v_exp_f32 v102, v94
    v_exp_f32 v103, v95
    v_mfma_f32_32x32x16_bf16 v[80:95], v[112:115], v[212:215], 0
    s_waitcnt lgkmcnt(1)
    ds_read_b128 v[112:115], v220 offset:17920
    v_cvt_pk_bf16_f32 v110, v100, v101
    v_cvt_pk_bf16_f32 v111, v102, v103
    v_exp_f32 v96, v64
    v_exp_f32 v97, v65
    v_exp_f32 v98, v66
    v_exp_f32 v99, v67
    v_mfma_f32_32x32x16_bf16 v[144:159], v[120:123], v[108:111], v[144:159]
    ds_read_b128 v[120:123], v225 offset:48176
    v_cvt_pk_bf16_f32 v104, v96, v97
    v_cvt_pk_bf16_f32 v105, v98, v99
    v_exp_f32 v100, v68
    v_exp_f32 v101, v69
    v_exp_f32 v102, v70
    v_exp_f32 v103, v71
    v_mfma_f32_32x32x8_bf16 v[80:95], v[124:125], v[218:219], v[80:95]
    s_waitcnt lgkmcnt(2)
    ds_read_b64 v[124:125], v221 offset:18176
    v_cvt_pk_bf16_f32 v106, v100, v101
    v_cvt_pk_bf16_f32 v107, v102, v103
    v_exp_f32 v96, v72
    v_exp_f32 v97, v73
    v_exp_f32 v98, v74
    v_exp_f32 v99, v75
    v_mfma_f32_32x32x16_bf16 v[128:143], v[116:119], v[104:107], v[128:143]
    s_waitcnt lgkmcnt(2)
    ds_read_b128 v[116:119], v228 offset:48176
    v_cvt_pk_bf16_f32 v108, v96, v97
    v_cvt_pk_bf16_f32 v109, v98, v99
    v_exp_f32 v100, v76
    v_exp_f32 v101, v77
    v_exp_f32 v102, v78
    v_exp_f32 v103, v79
    v_mfma_f32_32x32x16_bf16 v[64:79], v[112:115], v[208:211], 0
    s_waitcnt lgkmcnt(2)
    ds_read_b128 v[112:115], v220 offset:18304
    v_cvt_pk_bf16_f32 v110, v100, v101
    v_cvt_pk_bf16_f32 v111, v102, v103
    v_exp_f32 v96, v80
    v_exp_f32 v97, v81
    v_exp_f32 v98, v82
    v_exp_f32 v99, v83
    v_mfma_f32_32x32x16_bf16 v[128:143], v[120:123], v[108:111], v[128:143]
    s_waitcnt lgkmcnt(2)
    ds_read_b128 v[120:123], v229 offset:48176
    v_cvt_pk_bf16_f32 v104, v96, v97
    v_cvt_pk_bf16_f32 v105, v98, v99
    v_exp_f32 v100, v84
    v_exp_f32 v101, v85
    v_exp_f32 v102, v86
    v_exp_f32 v103, v87
    v_mfma_f32_32x32x8_bf16 v[64:79], v[124:125], v[216:217], v[64:79]
    s_waitcnt lgkmcnt(2)
    v_cvt_pk_bf16_f32 v106, v100, v101
    v_cvt_pk_bf16_f32 v107, v102, v103
    v_exp_f32 v96, v88
    v_exp_f32 v97, v89
    v_exp_f32 v98, v90
    v_exp_f32 v99, v91
    v_mfma_f32_32x32x16_bf16 v[144:159], v[116:119], v[104:107], v[144:159]
    s_waitcnt lgkmcnt(1)
    ds_read_b128 v[116:119], v226 offset:48176
    v_cvt_pk_bf16_f32 v108, v96, v97
    v_cvt_pk_bf16_f32 v109, v98, v99
    v_exp_f32 v100, v92
    v_exp_f32 v101, v93
    v_exp_f32 v102, v94
    v_exp_f32 v103, v95
    v_mfma_f32_32x32x16_bf16 v[80:95], v[112:115], v[212:215], 0
    s_waitcnt lgkmcnt(1)
    ds_read_b128 v[112:115], v220 offset:20480
    v_cvt_pk_bf16_f32 v110, v100, v101
    v_cvt_pk_bf16_f32 v111, v102, v103
    v_exp_f32 v96, v64
    v_exp_f32 v97, v65
    v_exp_f32 v98, v66
    v_exp_f32 v99, v67
    v_mfma_f32_32x32x16_bf16 v[144:159], v[120:123], v[108:111], v[144:159]
    ds_read_b128 v[120:123], v227 offset:48176
    v_cvt_pk_bf16_f32 v104, v96, v97
    v_cvt_pk_bf16_f32 v105, v98, v99
    v_exp_f32 v100, v68
    v_exp_f32 v101, v69
    v_exp_f32 v102, v70
    v_exp_f32 v103, v71
    v_mfma_f32_32x32x8_bf16 v[80:95], v[124:125], v[218:219], v[80:95]
    s_waitcnt lgkmcnt(2)
    ds_read_b64 v[124:125], v221 offset:20736
    v_cvt_pk_bf16_f32 v106, v100, v101
    v_cvt_pk_bf16_f32 v107, v102, v103
    v_exp_f32 v96, v72
    v_exp_f32 v97, v73
    v_exp_f32 v98, v74
    v_exp_f32 v99, v75
    v_mfma_f32_32x32x16_bf16 v[128:143], v[116:119], v[104:107], v[128:143]
    s_waitcnt lgkmcnt(2)
    ds_read_b128 v[116:119], v230 offset:48176
    v_cvt_pk_bf16_f32 v108, v96, v97
    v_cvt_pk_bf16_f32 v109, v98, v99
    v_exp_f32 v100, v76
    v_exp_f32 v101, v77
    v_exp_f32 v102, v78
    v_exp_f32 v103, v79
    v_mfma_f32_32x32x16_bf16 v[64:79], v[112:115], v[208:211], v[176:191]
    s_waitcnt lgkmcnt(2)
    ds_read_b128 v[112:115], v220 offset:20864
    v_cvt_pk_bf16_f32 v110, v100, v101
    v_cvt_pk_bf16_f32 v111, v102, v103
    v_exp_f32 v96, v80
    v_exp_f32 v97, v81
    v_exp_f32 v98, v82
    v_exp_f32 v99, v83
    v_mfma_f32_32x32x16_bf16 v[128:143], v[120:123], v[108:111], v[128:143]
    s_waitcnt lgkmcnt(2)
    ds_read_b128 v[120:123], v231 offset:48176
    v_cvt_pk_bf16_f32 v104, v96, v97
    v_cvt_pk_bf16_f32 v105, v98, v99
    v_exp_f32 v100, v84
    v_exp_f32 v101, v85
    v_exp_f32 v102, v86
    v_exp_f32 v103, v87
    v_mfma_f32_32x32x8_bf16 v[64:79], v[124:125], v[216:217], v[64:79]
    s_waitcnt lgkmcnt(2)
    v_cvt_pk_bf16_f32 v106, v100, v101
    v_cvt_pk_bf16_f32 v107, v102, v103
    v_exp_f32 v96, v88
    v_exp_f32 v97, v89
    v_exp_f32 v98, v90
    v_exp_f32 v99, v91
    v_mfma_f32_32x32x16_bf16 v[144:159], v[116:119], v[104:107], v[144:159]
    s_waitcnt lgkmcnt(1)
    ds_read_b128 v[116:119], v224 offset:53312
    v_cvt_pk_bf16_f32 v108, v96, v97
    v_cvt_pk_bf16_f32 v109, v98, v99
    v_exp_f32 v100, v92
    v_exp_f32 v101, v93
    v_exp_f32 v102, v94
    v_exp_f32 v103, v95
    v_mfma_f32_32x32x16_bf16 v[80:95], v[112:115], v[212:215], v[176:191]
    s_waitcnt lgkmcnt(1)
    v_cvt_pk_bf16_f32 v110, v100, v101
    v_cvt_pk_bf16_f32 v111, v102, v103
    v_exp_f32 v96, v64
    v_exp_f32 v97, v65
    v_exp_f32 v98, v66
    v_exp_f32 v99, v67
    v_mfma_f32_32x32x16_bf16 v[144:159], v[120:123], v[108:111], v[144:159]
    ds_read_b128 v[120:123], v225 offset:53312
    v_cvt_pk_bf16_f32 v104, v96, v97
    v_cvt_pk_bf16_f32 v105, v98, v99
    v_exp_f32 v100, v68
    v_exp_f32 v101, v69
    v_exp_f32 v102, v70
    v_exp_f32 v103, v71
    v_mfma_f32_32x32x8_bf16 v[80:95], v[124:125], v[218:219], v[80:95]
    s_waitcnt lgkmcnt(1)
    v_cvt_pk_bf16_f32 v106, v100, v101
    v_cvt_pk_bf16_f32 v107, v102, v103
    v_exp_f32 v96, v72
    v_exp_f32 v97, v73
    v_exp_f32 v98, v74
    v_exp_f32 v99, v75
    v_mfma_f32_32x32x16_bf16 v[128:143], v[116:119], v[104:107], v[128:143]
    s_waitcnt lgkmcnt(0)
    ds_read_b128 v[116:119], v228 offset:53312
    v_cvt_pk_bf16_f32 v108, v96, v97
    v_cvt_pk_bf16_f32 v109, v98, v99
    v_exp_f32 v100, v76
    v_exp_f32 v101, v77
    v_exp_f32 v102, v78
    v_exp_f32 v103, v79
    v_cvt_pk_bf16_f32 v110, v100, v101
    v_cvt_pk_bf16_f32 v111, v102, v103
    v_exp_f32 v96, v80
    v_exp_f32 v97, v81
    v_exp_f32 v98, v82
    v_exp_f32 v99, v83
    v_mfma_f32_32x32x16_bf16 v[128:143], v[120:123], v[108:111], v[128:143]
    s_waitcnt lgkmcnt(0)
    ds_read_b128 v[120:123], v229 offset:53312
    v_cvt_pk_bf16_f32 v104, v96, v97
    v_cvt_pk_bf16_f32 v105, v98, v99
    v_exp_f32 v100, v84
    v_exp_f32 v101, v85
    v_exp_f32 v102, v86
    v_exp_f32 v103, v87
    v_cvt_pk_bf16_f32 v106, v100, v101
    v_cvt_pk_bf16_f32 v107, v102, v103
    v_exp_f32 v96, v88
    v_exp_f32 v97, v89
    v_exp_f32 v98, v90
    v_exp_f32 v99, v91
    v_mfma_f32_32x32x16_bf16 v[144:159], v[116:119], v[104:107], v[144:159]
    s_waitcnt lgkmcnt(0)
    v_cvt_pk_bf16_f32 v108, v96, v97
    v_cvt_pk_bf16_f32 v109, v98, v99
    v_exp_f32 v100, v92
    v_exp_f32 v101, v93
    v_exp_f32 v102, v94
    v_exp_f32 v103, v95
    v_cvt_pk_bf16_f32 v110, v100, v101
    v_cvt_pk_bf16_f32 v111, v102, v103
    s_nop 1
    v_mfma_f32_32x32x16_bf16 v[144:159], v[120:123], v[108:111], v[144:159]
    s_branch L_p2_3

L_code_end:
L_slow_17:
    s_nop 15
    s_sub_u32 s76, 8, s75
    s_max_i32 s76, s76, 0
    s_mov_b32 s77, s76
    s_mul_i32 s78, s76, 2560
    v_add_u32 v4, s78, v220
    v_add_u32 v5, s78, v221
    v_mov_b32 v7, 0xff800000
L_sl_19:
    ds_read_b128 v[112:115], v4 offset:0
    ds_read_b64 v[124:125], v5 offset:256
    s_lshr_b32 s79, s77, 1
    s_mul_i32 s79, s79, 5136
    s_bitcmp1_b32 s77, 0
    s_cselect_b64 vcc, -1, 0
    v_cndmask_b32 v6, v224, v226, vcc
    v_add_u32 v6, s79, v6
    ds_read_b128 v[116:119], v6 offset:32768
    v_cndmask_b32 v6, v225, v227, vcc
    v_add_u32 v6, s79, v6
    ds_read_b128 v[120:123], v6 offset:32768
    s_waitcnt lgkmcnt(0)
    v_mfma_f32_32x32x16_bf16 v[64:79], v[112:115], v[208:211], 0
    v_mfma_f32_32x32x8_bf16 v[64:79], v[124:125], v[216:217], v[64:79]
    s_nop 15
    v_mov_b32 v2, 0xff800000
    s_cmp_lg_u32 s77, 0
    s_cbranch_scc1 L_nm_20
    v_cmp_eq_f32 vcc, 0, v160
    s_nop 1
    v_cndmask_b32 v64, v2, v64, vcc
    v_cmp_eq_f32 vcc, 0, v161
    s_nop 1
    v_cndmask_b32 v65, v2, v65, vcc
    v_cmp_eq_f32 vcc, 0, v162
    s_nop 1
    v_cndmask_b32 v66, v2, v66, vcc
    v_cmp_eq_f32 vcc, 0, v163
    s_nop 1
    v_cndmask_b32 v67, v2, v67, vcc
    v_cmp_eq_f32 vcc, 0, v164
    s_nop 1
    v_cndmask_b32 v68, v2, v68, vcc
    v_cmp_eq_f32 vcc, 0, v165
    s_nop 1
    v_cndmask_b32 v69, v2, v69, vcc
    v_cmp_eq_f32 vcc, 0, v166
    s_nop 1
    v_cndmask_b32 v70, v2, v70, vcc
    v_cmp_eq_f32 vcc, 0, v167
    s_nop 1
    v_cndmask_b32 v71, v2, v71, vcc
    v_cmp_eq_f32 vcc, 0, v168
    s_nop 1
    v_cndmask_b32 v72, v2, v72, vcc
    v_cmp_eq_f32 vcc, 0, v169
    s_nop 1
    v_cndmask_b32 v73, v2, v73, vcc
    v_cmp_eq_f32 vcc, 0, v170
    s_nop 1
    v_cndmask_b32 v74, v2, v74, vcc
    v_cmp_eq_f32 vcc, 0, v171
    s_nop 1
    v_cndmask_b32 v75, v2, v75, vcc
    v_cmp_eq_f32 vcc, 0, v172
    s_nop 1
    v_cndmask_b32 v76, v2, v76, vcc
    v_cmp_eq_f32 vcc, 0, v173
    s_nop 1
    v_cndmask_b32 v77, v2, v77, vcc
    v_cmp_eq_f32 vcc, 0, v174
    s_nop 1
    v_cndmask_b32 v78, v2, v78, vcc
    v_cmp_eq_f32 vcc, 0, v175
    s_nop 1
    v_cndmask_b32 v79, v2, v79, vcc
L_nm_20:
    s_cmp_lg_u32 s77, 8
    s_cbranch_scc1 L_nm2_21
    v_cmp_eq_f32 vcc, 0, v176
    s_nop 1
    v_cndmask_b32 v64, v2, v64, vcc
    v_cmp_eq_f32 vcc, 0, v177
    s_nop 1
    v_cndmask_b32 v65, v2, v65, vcc
    v_cmp_eq_f32 vcc, 0, v178
    s_nop 1
    v_cndmask_b32 v66, v2, v66, vcc
    v_cmp_eq_f32 vcc, 0, v179
    s_nop 1
    v_cndmask_b32 v67, v2, v67, vcc
    v_cmp_eq_f32 vcc, 0, v180
    s_nop 1
    v_cndmask_b32 v68, v2, v68, vcc
    v_cmp_eq_f32 vcc, 0, v181
    s_nop 1
    v_cndmask_b32 v69, v2, v69, vcc
    v_cmp_eq_f32 vcc, 0, v182
    s_nop 1
    v_cndmask_b32 v70, v2, v70, vcc
    v_cmp_eq_f32 vcc, 0, v183
    s_nop 1
    v_cndmask_b32 v71, v2, v71, vcc
    v_cmp_eq_f32 vcc, 0, v184
    s_nop 1
    v_cndmask_b32 v72, v2, v72, vcc
    v_cmp_eq_f32 vcc, 0, v185
    s_nop 1
    v_cndmask_b32 v73, v2, v73, vcc
    v_cmp_eq_f32 vcc, 0, v186
    s_nop 1
    v_cndmask_b32 v74, v2, v74, vcc
    v_cmp_eq_f32 vcc, 0, v187
    s_nop 1
    v_cndmask_b32 v75, v2, v75, vcc
    v_cmp_eq_f32 vcc, 0, v188
    s_nop 1
    v_cndmask_b32 v76, v2, v76, vcc
    v_cmp_eq_f32 vcc, 0, v189
    s_nop 1
    v_cndmask_b32 v77, v2, v77, vcc
    v_cmp_eq_f32 vcc, 0, v190
    s_nop 1
    v_cndmask_b32 v78, v2, v78, vcc
    v_cmp_eq_f32 vcc, 0, v191
    s_nop 1
    v_cndmask_b32 v79, v2, v79, vcc
L_nm2_21:
    v_max3_f32 v7, v64, v65, v7
    v_max3_f32 v7, v66, v67, v7
    v_max3_f32 v7, v68, v69, v7
    v_max3_f32 v7, v70, v71, v7
    v_max3_f32 v7, v72, v73, v7
    v_max3_f32 v7, v74, v75, v7
    v_max3_f32 v7, v76, v77, v7
    v_max3_f32 v7, v78, v79, v7
    v_add_u32 v4, 2560, v4
    v_add_u32 v5, 2560, v5
    s_add_u32 s77, s77, 1
    s_cmp_lt_u32 s77, 9
    s_cbranch_scc1 L_sl_19
    v_mov_b32 v2, v7
    s_nop 1
    v_permlane32_swap_b32 v2, v7
    v_max_f32 v7, v2, v7
    s_mov_b32 s77, s76
    s_mul_i32 s78, s76, 2560
    v_add_u32 v4, s78, v220
    v_add_u32 v5, s78, v221
    v_mov_b32 v128, 0
    v_mov_b32 v129, 0
    v_mov_b32 v130, 0
    v_mov_b32 v131, 0
    v_mov_b32 v132, 0
    v_mov_b32 v133, 0
    v_mov_b32 v134, 0
    v_mov_b32 v135, 0
    v_mov_b32 v136, 0
    v_mov_b32 v137, 0
    v_mov_b32 v138, 0
    v_mov_b32 v139, 0
    v_mov_b32 v140, 0
    v_mov_b32 v141, 0
    v_mov_b32 v142, 0
    v_mov_b32 v143, 0
L_sl_22:
    ds_read_b128 v[112:115], v4 offset:0
    ds_read_b64 v[124:125], v5 offset:256
    s_lshr_b32 s79, s77, 1
    s_mul_i32 s79, s79, 5136
    s_bitcmp1_b32 s77, 0
    s_cselect_b64 vcc, -1, 0
    v_cndmask_b32 v6, v224, v226, vcc
    v_add_u32 v6, s79, v6
    ds_read_b128 v[116:119], v6 offset:32768
    v_cndmask_b32 v6, v225, v227, vcc
    v_add_u32 v6, s79, v6
    ds_read_b128 v[120:123], v6 offset:32768
    s_waitcnt lgkmcnt(0)
    v_mfma_f32_32x32x16_bf16 v[64:79], v[112:115], v[208:211], 0
    v_mfma_f32_32x32x8_bf16 v[64:79], v[124:125], v[216:217], v[64:79]
    s_nop 15
    v_mov_b32 v2, 0xff800000
    s_cmp_lg_u32 s77, 0
    s_cbranch_scc1 L_nm_23
    v_cmp_eq_f32 vcc, 0, v160
    s_nop 1
    v_cndmask_b32 v64, v2, v64, vcc
    v_cmp_eq_f32 vcc, 0, v161
    s_nop 1
    v_cndmask_b32 v65, v2, v65, vcc
    v_cmp_eq_f32 vcc, 0, v162
    s_nop 1
    v_cndmask_b32 v66, v2, v66, vcc
    v_cmp_eq_f32 vcc, 0, v163
    s_nop 1
    v_cndmask_b32 v67, v2, v67, vcc
    v_cmp_eq_f32 vcc, 0, v164
    s_nop 1
    v_cndmask_b32 v68, v2, v68, vcc
    v_cmp_eq_f32 vcc, 0, v165
    s_nop 1
    v_cndmask_b32 v69, v2, v69, vcc
    v_cmp_eq_f32 vcc, 0, v166
    s_nop 1
    v_cndmask_b32 v70, v2, v70, vcc
    v_cmp_eq_f32 vcc, 0, v167
    s_nop 1
    v_cndmask_b32 v71, v2, v71, vcc
    v_cmp_eq_f32 vcc, 0, v168
    s_nop 1
    v_cndmask_b32 v72, v2, v72, vcc
    v_cmp_eq_f32 vcc, 0, v169
    s_nop 1
    v_cndmask_b32 v73, v2, v73, vcc
    v_cmp_eq_f32 vcc, 0, v170
    s_nop 1
    v_cndmask_b32 v74, v2, v74, vcc
    v_cmp_eq_f32 vcc, 0, v171
    s_nop 1
    v_cndmask_b32 v75, v2, v75, vcc
    v_cmp_eq_f32 vcc, 0, v172
    s_nop 1
    v_cndmask_b32 v76, v2, v76, vcc
    v_cmp_eq_f32 vcc, 0, v173
    s_nop 1
    v_cndmask_b32 v77, v2, v77, vcc
    v_cmp_eq_f32 vcc, 0, v174
    s_nop 1
    v_cndmask_b32 v78, v2, v78, vcc
    v_cmp_eq_f32 vcc, 0, v175
    s_nop 1
    v_cndmask_b32 v79, v2, v79, vcc
L_nm_23:
    s_cmp_lg_u32 s77, 8
    s_cbranch_scc1 L_nm2_24
    v_cmp_eq_f32 vcc, 0, v176
    s_nop 1
    v_cndmask_b32 v64, v2, v64, vcc
    v_cmp_eq_f32 vcc, 0, v177
    s_nop 1
    v_cndmask_b32 v65, v2, v65, vcc
    v_cmp_eq_f32 vcc, 0, v178
    s_nop 1
    v_cndmask_b32 v66, v2, v66, vcc
    v_cmp_eq_f32 vcc, 0, v179
    s_nop 1
    v_cndmask_b32 v67, v2, v67, vcc
    v_cmp_eq_f32 vcc, 0, v180
    s_nop 1
    v_cndmask_b32 v68, v2, v68, vcc
    v_cmp_eq_f32 vcc, 0, v181
    s_nop 1
    v_cndmask_b32 v69, v2, v69, vcc
    v_cmp_eq_f32 vcc, 0, v182
    s_nop 1
    v_cndmask_b32 v70, v2, v70, vcc
    v_cmp_eq_f32 vcc, 0, v183
    s_nop 1
    v_cndmask_b32 v71, v2, v71, vcc
    v_cmp_eq_f32 vcc, 0, v184
    s_nop 1
    v_cndmask_b32 v72, v2, v72, vcc
    v_cmp_eq_f32 vcc, 0, v185
    s_nop 1
    v_cndmask_b32 v73, v2, v73, vcc
    v_cmp_eq_f32 vcc, 0, v186
    s_nop 1
    v_cndmask_b32 v74, v2, v74, vcc
    v_cmp_eq_f32 vcc, 0, v187
    s_nop 1
    v_cndmask_b32 v75, v2, v75, vcc
    v_cmp_eq_f32 vcc, 0, v188
    s_nop 1
    v_cndmask_b32 v76, v2, v76, vcc
    v_cmp_eq_f32 vcc, 0, v189
    s_nop 1
    v_cndmask_b32 v77, v2, v77, vcc
    v_cmp_eq_f32 vcc, 0, v190
    s_nop 1
    v_cndmask_b32 v78, v2, v78, vcc
    v_cmp_eq_f32 vcc, 0, v191
    s_nop 1
    v_cndmask_b32 v79, v2, v79, vcc
L_nm2_24:
    v_sub_f32 v64, v64, v7
    v_exp_f32 v64, v64
    v_sub_f32 v65, v65, v7
    v_exp_f32 v65, v65
    v_sub_f32 v66, v66, v7
    v_exp_f32 v66, v66
    v_sub_f32 v67, v67, v7
    v_exp_f32 v67, v67
    v_sub_f32 v68, v68, v7
    v_exp_f32 v68, v68
    v_sub_f32 v69, v69, v7
    v_exp_f32 v69, v69
    v_sub_f32 v70, v70, v7
    v_exp_f32 v70, v70
    v_sub_f32 v71, v71, v7
    v_exp_f32 v71, v71
    v_sub_f32 v72, v72, v7
    v_exp_f32 v72, v72
    v_sub_f32 v73, v73, v7
    v_exp_f32 v73, v73
    v_sub_f32 v74, v74, v7
    v_exp_f32 v74, v74
    v_sub_f32 v75, v75, v7
    v_exp_f32 v75, v75
    v_sub_f32 v76, v76, v7
    v_exp_f32 v76, v76
    v_sub_f32 v77, v77, v7
    v_exp_f32 v77, v77
    v_sub_f32 v78, v78, v7
    v_exp_f32 v78, v78
    v_sub_f32 v79, v79, v7
    v_exp_f32 v79, v79
    v_cvt_pk_bf16_f32 v104, v64, v65
    v_cvt_pk_bf16_f32 v105, v66, v67
    v_cvt_pk_bf16_f32 v106, v68, v69
    v_cvt_pk_bf16_f32 v107, v70, v71
    v_cvt_pk_bf16_f32 v108, v72, v73
    v_cvt_pk_bf16_f32 v109, v74, v75
    v_cvt_pk_bf16_f32 v110, v76, v77
    v_cvt_pk_bf16_f32 v111, v78, v79
    v_mfma_f32_32x32x16_bf16 v[128:143], v[116:119], v[104:107], v[128:143]
    s_nop 0
    v_mfma_f32_32x32x16_bf16 v[128:143], v[120:123], v[108:111], v[128:143]
    v_add_u32 v4, 2560, v4
    v_add_u32 v5, 2560, v5
    s_add_u32 s77, s77, 1
    s_cmp_lt_u32 s77, 9
    s_cbranch_scc1 L_sl_22
    s_mov_b32 s77, s76
    s_mul_i32 s78, s76, 2560
    v_add_u32 v4, s78, v220
    v_add_u32 v5, s78, v221
    v_mov_b32 v7, 0xff800000
L_sl_25:
    ds_read_b128 v[112:115], v4 offset:384
    ds_read_b64 v[124:125], v5 offset:256
    s_lshr_b32 s79, s77, 1
    s_mul_i32 s79, s79, 5136
    s_bitcmp1_b32 s77, 0
    s_cselect_b64 vcc, -1, 0
    v_cndmask_b32 v6, v228, v230, vcc
    v_add_u32 v6, s79, v6
    ds_read_b128 v[116:119], v6 offset:32768
    v_cndmask_b32 v6, v229, v231, vcc
    v_add_u32 v6, s79, v6
    ds_read_b128 v[120:123], v6 offset:32768
    s_waitcnt lgkmcnt(0)
    v_mfma_f32_32x32x16_bf16 v[64:79], v[112:115], v[212:215], 0
    v_mfma_f32_32x32x8_bf16 v[64:79], v[124:125], v[218:219], v[64:79]
    s_nop 15
    v_mov_b32 v2, 0xff800000
    s_cmp_lg_u32 s77, 0
    s_cbranch_scc1 L_nm_26
    v_cmp_eq_f32 vcc, 0, v160
    s_nop 1
    v_cndmask_b32 v64, v2, v64, vcc
    v_cmp_eq_f32 vcc, 0, v161
    s_nop 1
    v_cndmask_b32 v65, v2, v65, vcc
    v_cmp_eq_f32 vcc, 0, v162
    s_nop 1
    v_cndmask_b32 v66, v2, v66, vcc
    v_cmp_eq_f32 vcc, 0, v163
    s_nop 1
    v_cndmask_b32 v67, v2, v67, vcc
    v_cmp_eq_f32 vcc, 0, v164
    s_nop 1
    v_cndmask_b32 v68, v2, v68, vcc
    v_cmp_eq_f32 vcc, 0, v165
    s_nop 1
    v_cndmask_b32 v69, v2, v69, vcc
    v_cmp_eq_f32 vcc, 0, v166
    s_nop 1
    v_cndmask_b32 v70, v2, v70, vcc
    v_cmp_eq_f32 vcc, 0, v167
    s_nop 1
    v_cndmask_b32 v71, v2, v71, vcc
    v_cmp_eq_f32 vcc, 0, v168
    s_nop 1
    v_cndmask_b32 v72, v2, v72, vcc
    v_cmp_eq_f32 vcc, 0, v169
    s_nop 1
    v_cndmask_b32 v73, v2, v73, vcc
    v_cmp_eq_f32 vcc, 0, v170
    s_nop 1
    v_cndmask_b32 v74, v2, v74, vcc
    v_cmp_eq_f32 vcc, 0, v171
    s_nop 1
    v_cndmask_b32 v75, v2, v75, vcc
    v_cmp_eq_f32 vcc, 0, v172
    s_nop 1
    v_cndmask_b32 v76, v2, v76, vcc
    v_cmp_eq_f32 vcc, 0, v173
    s_nop 1
    v_cndmask_b32 v77, v2, v77, vcc
    v_cmp_eq_f32 vcc, 0, v174
    s_nop 1
    v_cndmask_b32 v78, v2, v78, vcc
    v_cmp_eq_f32 vcc, 0, v175
    s_nop 1
    v_cndmask_b32 v79, v2, v79, vcc
L_nm_26:
    s_cmp_lg_u32 s77, 8
    s_cbranch_scc1 L_nm2_27
    v_cmp_eq_f32 vcc, 0, v176
    s_nop 1
    v_cndmask_b32 v64, v2, v64, vcc
    v_cmp_eq_f32 vcc, 0, v177
    s_nop 1
    v_cndmask_b32 v65, v2, v65, vcc
    v_cmp_eq_f32 vcc, 0, v178
    s_nop 1
    v_cndmask_b32 v66, v2, v66, vcc
    v_cmp_eq_f32 vcc, 0, v179
    s_nop 1
    v_cndmask_b32 v67, v2, v67, vcc
    v_cmp_eq_f32 vcc, 0, v180
    s_nop 1
    v_cndmask_b32 v68, v2, v68, vcc
    v_cmp_eq_f32 vcc, 0, v181
    s_nop 1
    v_cndmask_b32 v69, v2, v69, vcc
    v_cmp_eq_f32 vcc, 0, v182
    s_nop 1
    v_cndmask_b32 v70, v2, v70, vcc
    v_cmp_eq_f32 vcc, 0, v183
    s_nop 1
    v_cndmask_b32 v71, v2, v71, vcc
    v_cmp_eq_f32 vcc, 0, v184
    s_nop 1
    v_cndmask_b32 v72, v2, v72, vcc
    v_cmp_eq_f32 vcc, 0, v185
    s_nop 1
    v_cndmask_b32 v73, v2, v73, vcc
    v_cmp_eq_f32 vcc, 0, v186
    s_nop 1
    v_cndmask_b32 v74, v2, v74, vcc
    v_cmp_eq_f32 vcc, 0, v187
    s_nop 1
    v_cndmask_b32 v75, v2, v75, vcc
    v_cmp_eq_f32 vcc, 0, v188
    s_nop 1
    v_cndmask_b32 v76, v2, v76, vcc
    v_cmp_eq_f32 vcc, 0, v189
    s_nop 1
    v_cndmask_b32 v77, v2, v77, vcc
    v_cmp_eq_f32 vcc, 0, v190
    s_nop 1
    v_cndmask_b32 v78, v2, v78, vcc
    v_cmp_eq_f32 vcc, 0, v191
    s_nop 1
    v_cndmask_b32 v79, v2, v79, vcc
L_nm2_27:
    v_max3_f32 v7, v64, v65, v7
    v_max3_f32 v7, v66, v67, v7
    v_max3_f32 v7, v68, v69, v7
    v_max3_f32 v7, v70, v71, v7
    v_max3_f32 v7, v72, v73, v7
    v_max3_f32 v7, v74, v75, v7
    v_max3_f32 v7, v76, v77, v7
    v_max3_f32 v7, v78, v79, v7
    v_add_u32 v4, 2560, v4
    v_add_u32 v5, 2560, v5
    s_add_u32 s77, s77, 1
    s_cmp_lt_u32 s77, 9
    s_cbranch_scc1 L_sl_25
    v_mov_b32 v2, v7
    s_nop 1
    v_permlane32_swap_b32 v2, v7
    v_max_f32 v7, v2, v7
    s_mov_b32 s77, s76
    s_mul_i32 s78, s76, 2560
    v_add_u32 v4, s78, v220
    v_add_u32 v5, s78, v221
    v_mov_b32 v144, 0
    v_mov_b32 v145, 0
    v_mov_b32 v146, 0
    v_mov_b32 v147, 0
    v_mov_b32 v148, 0
    v_mov_b32 v149, 0
    v_mov_b32 v150, 0
    v_mov_b32 v151, 0
    v_mov_b32 v152, 0
    v_mov_b32 v153, 0
    v_mov_b32 v154, 0
    v_mov_b32 v155, 0
    v_mov_b32 v156, 0
    v_mov_b32 v157, 0
    v_mov_b32 v158, 0
    v_mov_b32 v159, 0
L_sl_28:
    ds_read_b128 v[112:115], v4 offset:384
    ds_read_b64 v[124:125], v5 offset:256
    s_lshr_b32 s79, s77, 1
    s_mul_i32 s79, s79, 5136
    s_bitcmp1_b32 s77, 0
    s_cselect_b64 vcc, -1, 0
    v_cndmask_b32 v6, v228, v230, vcc
    v_add_u32 v6, s79, v6
    ds_read_b128 v[116:119], v6 offset:32768
    v_cndmask_b32 v6, v229, v231, vcc
    v_add_u32 v6, s79, v6
    ds_read_b128 v[120:123], v6 offset:32768
    s_waitcnt lgkmcnt(0)
    v_mfma_f32_32x32x16_bf16 v[64:79], v[112:115], v[212:215], 0
    v_mfma_f32_32x32x8_bf16 v[64:79], v[124:125], v[218:219], v[64:79]
    s_nop 15
    v_mov_b32 v2, 0xff800000
    s_cmp_lg_u32 s77, 0
    s_cbranch_scc1 L_nm_29
    v_cmp_eq_f32 vcc, 0, v160
    s_nop 1
    v_cndmask_b32 v64, v2, v64, vcc
    v_cmp_eq_f32 vcc, 0, v161
    s_nop 1
    v_cndmask_b32 v65, v2, v65, vcc
    v_cmp_eq_f32 vcc, 0, v162
    s_nop 1
    v_cndmask_b32 v66, v2, v66, vcc
    v_cmp_eq_f32 vcc, 0, v163
    s_nop 1
    v_cndmask_b32 v67, v2, v67, vcc
    v_cmp_eq_f32 vcc, 0, v164
    s_nop 1
    v_cndmask_b32 v68, v2, v68, vcc
    v_cmp_eq_f32 vcc, 0, v165
    s_nop 1
    v_cndmask_b32 v69, v2, v69, vcc
    v_cmp_eq_f32 vcc, 0, v166
    s_nop 1
    v_cndmask_b32 v70, v2, v70, vcc
    v_cmp_eq_f32 vcc, 0, v167
    s_nop 1
    v_cndmask_b32 v71, v2, v71, vcc
    v_cmp_eq_f32 vcc, 0, v168
    s_nop 1
    v_cndmask_b32 v72, v2, v72, vcc
    v_cmp_eq_f32 vcc, 0, v169
    s_nop 1
    v_cndmask_b32 v73, v2, v73, vcc
    v_cmp_eq_f32 vcc, 0, v170
    s_nop 1
    v_cndmask_b32 v74, v2, v74, vcc
    v_cmp_eq_f32 vcc, 0, v171
    s_nop 1
    v_cndmask_b32 v75, v2, v75, vcc
    v_cmp_eq_f32 vcc, 0, v172
    s_nop 1
    v_cndmask_b32 v76, v2, v76, vcc
    v_cmp_eq_f32 vcc, 0, v173
    s_nop 1
    v_cndmask_b32 v77, v2, v77, vcc
    v_cmp_eq_f32 vcc, 0, v174
    s_nop 1
    v_cndmask_b32 v78, v2, v78, vcc
    v_cmp_eq_f32 vcc, 0, v175
    s_nop 1
    v_cndmask_b32 v79, v2, v79, vcc
L_nm_29:
    s_cmp_lg_u32 s77, 8
    s_cbranch_scc1 L_nm2_30
    v_cmp_eq_f32 vcc, 0, v176
    s_nop 1
    v_cndmask_b32 v64, v2, v64, vcc
    v_cmp_eq_f32 vcc, 0, v177
    s_nop 1
    v_cndmask_b32 v65, v2, v65, vcc
    v_cmp_eq_f32 vcc, 0, v178
    s_nop 1
    v_cndmask_b32 v66, v2, v66, vcc
    v_cmp_eq_f32 vcc, 0, v179
    s_nop 1
    v_cndmask_b32 v67, v2, v67, vcc
    v_cmp_eq_f32 vcc, 0, v180
    s_nop 1
    v_cndmask_b32 v68, v2, v68, vcc
    v_cmp_eq_f32 vcc, 0, v181
    s_nop 1
    v_cndmask_b32 v69, v2, v69, vcc
    v_cmp_eq_f32 vcc, 0, v182
    s_nop 1
    v_cndmask_b32 v70, v2, v70, vcc
    v_cmp_eq_f32 vcc, 0, v183
    s_nop 1
    v_cndmask_b32 v71, v2, v71, vcc
    v_cmp_eq_f32 vcc, 0, v184
    s_nop 1
    v_cndmask_b32 v72, v2, v72, vcc
    v_cmp_eq_f32 vcc, 0, v185
    s_nop 1
    v_cndmask_b32 v73, v2, v73, vcc
    v_cmp_eq_f32 vcc, 0, v186
    s_nop 1
    v_cndmask_b32 v74, v2, v74, vcc
    v_cmp_eq_f32 vcc, 0, v187
    s_nop 1
    v_cndmask_b32 v75, v2, v75, vcc
    v_cmp_eq_f32 vcc, 0, v188
    s_nop 1
    v_cndmask_b32 v76, v2, v76, vcc
    v_cmp_eq_f32 vcc, 0, v189
    s_nop 1
    v_cndmask_b32 v77, v2, v77, vcc
    v_cmp_eq_f32 vcc, 0, v190
    s_nop 1
    v_cndmask_b32 v78, v2, v78, vcc
    v_cmp_eq_f32 vcc, 0, v191
    s_nop 1
    v_cndmask_b32 v79, v2, v79, vcc
L_nm2_30:
    v_sub_f32 v64, v64, v7
    v_exp_f32 v64, v64
    v_sub_f32 v65, v65, v7
    v_exp_f32 v65, v65
    v_sub_f32 v66, v66, v7
    v_exp_f32 v66, v66
    v_sub_f32 v67, v67, v7
    v_exp_f32 v67, v67
    v_sub_f32 v68, v68, v7
    v_exp_f32 v68, v68
    v_sub_f32 v69, v69, v7
    v_exp_f32 v69, v69
    v_sub_f32 v70, v70, v7
    v_exp_f32 v70, v70
    v_sub_f32 v71, v71, v7
    v_exp_f32 v71, v71
    v_sub_f32 v72, v72, v7
    v_exp_f32 v72, v72
    v_sub_f32 v73, v73, v7
    v_exp_f32 v73, v73
    v_sub_f32 v74, v74, v7
    v_exp_f32 v74, v74
    v_sub_f32 v75, v75, v7
    v_exp_f32 v75, v75
    v_sub_f32 v76, v76, v7
    v_exp_f32 v76, v76
    v_sub_f32 v77, v77, v7
    v_exp_f32 v77, v77
    v_sub_f32 v78, v78, v7
    v_exp_f32 v78, v78
    v_sub_f32 v79, v79, v7
    v_exp_f32 v79, v79
    v_cvt_pk_bf16_f32 v104, v64, v65
    v_cvt_pk_bf16_f32 v105, v66, v67
    v_cvt_pk_bf16_f32 v106, v68, v69
    v_cvt_pk_bf16_f32 v107, v70, v71
    v_cvt_pk_bf16_f32 v108, v72, v73
    v_cvt_pk_bf16_f32 v109, v74, v75
    v_cvt_pk_bf16_f32 v110, v76, v77
    v_cvt_pk_bf16_f32 v111, v78, v79
    v_mfma_f32_32x32x16_bf16 v[144:159], v[116:119], v[104:107], v[144:159]
    s_nop 0
    v_mfma_f32_32x32x16_bf16 v[144:159], v[120:123], v[108:111], v[144:159]
    v_add_u32 v4, 2560, v4
    v_add_u32 v5, 2560, v5
    s_add_u32 s77, s77, 1
    s_cmp_lt_u32 s77, 9
    s_cbranch_scc1 L_sl_28
    s_nop 15
    s_branch L_norm_18

.section .rodata,"a"
.p2align 6
.amdhsa_kernel gated_mix__sliding_block__dense_activation_relu__prompt_kernel
  .amdhsa_next_free_vgpr 512
  .amdhsa_next_free_sgpr 102
  .amdhsa_accum_offset 256
  .amdhsa_group_segment_fixed_size 0
  .amdhsa_kernarg_size 80
  .amdhsa_user_sgpr_count 2
  .amdhsa_user_sgpr_kernarg_segment_ptr 1
  .amdhsa_system_sgpr_workgroup_id_x 1
  .amdhsa_float_denorm_mode_32 3
.end_amdhsa_kernel
```
